```python
import torch

def _softmax(x, axis=-1):
    return torch.softmax(x, dim=axis)

def _gelu(x):
    return torch.nn.functional.gelu(x, approximate='tanh')

def _silu(x):
    return torch.nn.functional.silu(x)

def _sigmoid(x):
    return torch.sigmoid(x)

def _layernorm(x, axis=-1, eps=1e-05):
    m = x.mean(dim=axis, keepdim=True)
    v = x.var(dim=axis, keepdim=True, unbiased=False)
    return (x - m) / torch.sqrt(v + eps)

def _scatter_add(tgt, idx, src, axis=0):
    return tgt.clone().index_add_(axis, idx, src)

def _segment_sum(src, seg, n):
    out = torch.zeros((n,) + src.shape[1:], dtype=src.dtype)
    return out.index_add_(0, seg, src)

def _pad(x, pw):
    flat = tuple((v for pair in reversed(pw) for v in pair))
    return torch.nn.functional.pad(x, flat)
kernel_name = 'adaLN_cond__linear_kernel_hedgehog__dense_activation_squared_relu__prompt'

def setup_inputs():

    _w = lambda a: (lambda t: t.to(torch.bfloat16) if t.is_floating_point() else t)(torch.as_tensor(a))

    def _A_setup():
        B, S, D, H = (1, 2048, 640, 32)
        Dh = D // H
        return {'x': _w((lambda *s: torch.randn(*s, dtype=torch.bfloat16) * 0.05)(B, S, D)), 'wqkv': _w((lambda *s: torch.randn(*s, dtype=torch.bfloat16) * 0.4)(D, 3 * D)), 'w_phi': _w((lambda *s: torch.randn(*s, dtype=torch.bfloat16) * 0.4)(H, Dh, Dh) * Dh ** (-0.5)), 'wo': _w((lambda *s: torch.randn(*s, dtype=torch.bfloat16) * 0.05)(D, D))}
    _A_in = _A_setup()

    def _B_setup():
        B, S, D, F = (1, 2048, 640, 1728)
        return {'x': _w((lambda *s: torch.randn(*s, dtype=torch.bfloat16) * 0.05)(B, S, D)), 'w1': _w((lambda *s: torch.randn(*s, dtype=torch.bfloat16) * 0.05)(D, F)), 'b1': _w((lambda *s: torch.randn(*s, dtype=torch.bfloat16) * 0.4)(F)), 'w2': _w((lambda *s: torch.randn(*s, dtype=torch.bfloat16) * 0.05)(F, D)), 'b2': _w((lambda *s: torch.randn(*s, dtype=torch.bfloat16) * 1.6)(D))}
    _B_in = _B_setup()
    return {'A_x': _A_in['x'], 'A_wqkv': _A_in['wqkv'], 'A_w_phi': _A_in['w_phi'], 'A_wo': _A_in['wo'], 'B_x': _B_in['x'], 'B_w1': _B_in['w1'], 'B_b1': _B_in['b1'], 'B_w2': _B_in['w2'], 'B_b2': _B_in['b2'], 'c': _w((lambda *s: torch.randn(*s, dtype=torch.bfloat16) * 0.1)(1, 640) * 8.0), 'w_mod': _w((lambda *s: torch.randn(*s, dtype=torch.bfloat16) * 0.1)(640, 6 * 640) * 640 ** (-0.5) * 8.0)}

def reference(A_x, A_wqkv, A_w_phi, A_wo, B_x, B_w1, B_b1, B_w2, B_b2, c, w_mod):

    def _A_ref(x, wqkv, w_phi, wo):
        B, S, D = x.shape
        H = 32
        Dh = D // H
        qkv = (lambda x, *d: x.permute(*d))((x @ wqkv).reshape(B, S, 3, H, Dh), 2, 0, 3, 1, 4)
        q, k, v = (qkv[0], qkv[1], qkv[2])
        pq = torch.einsum('bhsd,hdf->bhsf', q, w_phi)
        pk = torch.einsum('bhsd,hdf->bhsf', k, w_phi)
        phi_q = torch.concatenate([_softmax(pq, axis=-1), _softmax(-pq, axis=-1)], axis=-1)
        phi_k = torch.concatenate([_softmax(pk, axis=-1), _softmax(-pk, axis=-1)], axis=-1)
        kv = torch.einsum('bhsf,bhsd->bhfd', phi_k, v)
        z = torch.einsum('bhsf->bhf', phi_k)
        num = torch.einsum('bhqf,bhfd->bhqd', phi_q, kv)
        den = torch.einsum('bhqf,bhf->bhq', phi_q, z)[..., None] + 1e-06
        o = num / den
        return (lambda x, *d: x.permute(*d))(o, 0, 2, 1, 3).reshape(B, S, D) @ wo

    def _B_ref(x, w1, b1, w2, b2):
        h = torch.einsum('bsd,df->bsf', x, w1) + b1
        zero = torch.zeros_like(h)
        r = torch.where(h > zero, h, zero)
        h = r * r
        out = torch.einsum('bsf,fd->bsd', h, w2) + b2
        return out
    x = A_x
    mod = (_silu(c) @ w_mod).reshape(c.shape[0], 6, 1, -1)
    sa, ca, ga, sb, cb, gb = (mod[:, 0].clone(), mod[:, 1].clone(), mod[:, 2].clone(), mod[:, 3].clone(), mod[:, 4].clone(), mod[:, 5].clone())
    h = _layernorm(x, axis=-1) * (1 + ca) + sa
    x = x + ga * _A_ref(h, A_wqkv, A_w_phi, A_wo)
    h = _layernorm(x, axis=-1) * (1 + cb) + sb
    x = x + gb * _B_ref(h, B_w1, B_b1, B_w2, B_b2)
    return x
```

```asm
; @launch kernel=prep_kernel grid=(341,1,1) block=(256,1,1) lds=32768
; @launch kernel=qkv_kernel grid=(256,1,1) block=(256,1,1) lds=153600
; @launch kernel=tail_kernel grid=(256,1,1) block=(256,1,1) lds=163840
.amdgcn_target "amdgcn-amd-amdhsa--gfx950"
.text
.globl prep_kernel
.p2align 8
.type prep_kernel,@function
prep_kernel:
  s_cmp_ge_u32 s2, 341
  s_cbranch_scc1 L_k0_exit
  s_load_dwordx2 s[4:5], s[0:1], 104
  v_and_b32 v120, 63, v0
  v_lshlrev_b32 v120, 4, v120
  v_lshrrev_b32 v121, 6, v0
  s_lshr_b32 s60, s2, 3
  v_readfirstlane_b32 s61, v121
  s_lshl_b32 s62, s60, 2
  s_add_u32 s62, s62, s61
  s_getpc_b64 s[64:65]
L_pc_all_1:
  s_add_u32 s64, s64, prep_kernel-L_pc_all_1
  s_addc_u32 s65, s65, (prep_kernel-L_pc_all_1)>>32
  s_lshl_b32 s66, s62, 10
  v_add_u32 v124, s66, v120
  v_min_u32 v124, L_code_end-prep_kernel-16, v124
  global_load_dwordx4 v[124:127], v124, s[64:65]
  s_cmp_lt_u32 s2, 60
  s_cbranch_scc1 L_t1
  s_cmp_lt_u32 s2, 180
  s_cbranch_scc1 L_t2
  s_cmp_lt_u32 s2, 205
  s_cbranch_scc1 L_t3
  s_cmp_lt_u32 s2, 273
  s_cbranch_scc1 L_t4
L_t5:
  s_load_dwordx2 s[6:7], s[0:1], 56
  s_sub_u32 s20, s2, 273
  s_lshl_b32 s20, s20, 8
  v_add_u32 v1, s20, v0
  v_cmp_gt_u32 vcc, 17280, v1
  s_and_saveexec_b64 s[24:25], vcc
  s_cbranch_execz L_k0_end
  s_mov_b32 s21, 26215
  v_mul_lo_u32 v2, s21, v1
  v_lshrrev_b32 v2, 21, v2
  v_mul_u32_u24 v3, 80, v2
  v_sub_u32 v3, v1, v3
  v_lshrrev_b32 v4, 2, v2
  v_and_b32 v5, 3, v2
  v_lshlrev_b32 v6, 5, v4
  v_lshl_add_u32 v6, v5, 2, v6
  v_add_u32 v7, 16, v6
  s_mov_b32 s22, 1280
  v_mul_u32_u24 v6, s22, v6
  v_mul_u32_u24 v7, s22, v7
  v_lshl_add_u32 v6, v3, 4, v6
  v_lshl_add_u32 v7, v3, 4, v7
  s_waitcnt lgkmcnt(0)
  s_mov_b32 s12, s6
  s_mov_b32 s13, s7
  s_mov_b32 s14, 0x21c000
  s_mov_b32 s15, 0x00020000
  s_mov_b32 s23, 0
  buffer_load_dwordx4 v[16:19], v6, s[12:15], s23 offen
  buffer_load_dwordx4 v[32:35], v7, s[12:15], s23 offen
  s_mov_b32 s23, 1280
  buffer_load_dwordx4 v[20:23], v6, s[12:15], s23 offen
  buffer_load_dwordx4 v[36:39], v7, s[12:15], s23 offen
  s_mov_b32 s23, 2560
  buffer_load_dwordx4 v[24:27], v6, s[12:15], s23 offen
  buffer_load_dwordx4 v[40:43], v7, s[12:15], s23 offen
  s_mov_b32 s23, 3840
  buffer_load_dwordx4 v[28:31], v6, s[12:15], s23 offen
  buffer_load_dwordx4 v[44:47], v7, s[12:15], s23 offen
  v_lshrrev_b32 v4, 2, v2
  v_and_b32 v5, 3, v2
  v_and_b32 v8, 1, v3
  v_lshlrev_b32 v8, 7, v8
  v_lshl_add_u32 v8, v5, 8, v8
  s_mov_b32 s22, 103
  v_mul_u32_u24 v9, s22, v3
  v_lshrrev_b32 v9, 10, v9
  v_mul_u32_u24 v10, 10, v9
  v_sub_u32 v10, v3, v10
  v_lshrrev_b32 v10, 1, v10
  v_mul_u32_u24 v11, 5, v4
  v_add_u32 v10, v10, v11
  v_cmp_le_u32 vcc, 14, v4
  v_add_u32 v11, 3, v10
  s_nop 0
  v_cndmask_b32 v10, v10, v11, vcc
  v_cmp_le_u32 vcc, 28, v4
  v_add_u32 v11, 3, v10
  s_nop 0
  v_cndmask_b32 v10, v10, v11, vcc
  v_cmp_le_u32 vcc, 40, v4
  v_add_u32 v11, 1, v10
  s_nop 0
  v_cndmask_b32 v10, v10, v11, vcc
  v_lshl_add_u32 v8, v10, 10, v8
  s_mov_b32 s22, 286720
  v_mul_u32_u24 v9, s22, v9
  v_add_u32 v8, v8, v9
  s_add_u32 s16, s4, 0x54c000
  s_addc_u32 s17, s5, 0
  s_mov_b32 s18, 0x230000
  s_mov_b32 s19, 0x00020000
  s_mov_b32 s26, 0x05040100
  s_mov_b32 s27, 0x07060302
  s_waitcnt vmcnt(0)
  v_perm_b32 v48, v20, v16, s26
  v_perm_b32 v49, v28, v24, s26
  v_perm_b32 v50, v36, v32, s26
  v_perm_b32 v51, v44, v40, s26
  buffer_store_dwordx4 v[48:51], v8, s[16:19], 0 offen offset:0
  v_perm_b32 v52, v20, v16, s27
  v_perm_b32 v53, v28, v24, s27
  v_perm_b32 v54, v36, v32, s27
  v_perm_b32 v55, v44, v40, s27
  buffer_store_dwordx4 v[52:55], v8, s[16:19], 0 offen offset:16
  v_perm_b32 v56, v21, v17, s26
  v_perm_b32 v57, v29, v25, s26
  v_perm_b32 v58, v37, v33, s26
  v_perm_b32 v59, v45, v41, s26
  buffer_store_dwordx4 v[56:59], v8, s[16:19], 0 offen offset:32
  v_perm_b32 v60, v21, v17, s27
  v_perm_b32 v61, v29, v25, s27
  v_perm_b32 v62, v37, v33, s27
  v_perm_b32 v63, v45, v41, s27
  buffer_store_dwordx4 v[60:63], v8, s[16:19], 0 offen offset:48
  v_perm_b32 v64, v22, v18, s26
  v_perm_b32 v65, v30, v26, s26
  v_perm_b32 v66, v38, v34, s26
  v_perm_b32 v67, v46, v42, s26
  buffer_store_dwordx4 v[64:67], v8, s[16:19], 0 offen offset:64
  v_perm_b32 v68, v22, v18, s27
  v_perm_b32 v69, v30, v26, s27
  v_perm_b32 v70, v38, v34, s27
  v_perm_b32 v71, v46, v42, s27
  buffer_store_dwordx4 v[68:71], v8, s[16:19], 0 offen offset:80
  v_perm_b32 v72, v23, v19, s26
  v_perm_b32 v73, v31, v27, s26
  v_perm_b32 v74, v39, v35, s26
  v_perm_b32 v75, v47, v43, s26
  buffer_store_dwordx4 v[72:75], v8, s[16:19], 0 offen offset:96
  v_perm_b32 v76, v23, v19, s27
  v_perm_b32 v77, v31, v27, s27
  v_perm_b32 v78, v39, v35, s27
  v_perm_b32 v79, v47, v43, s27
  buffer_store_dwordx4 v[76:79], v8, s[16:19], 0 offen offset:112
  s_branch L_k0_end
L_t4:
  s_load_dwordx2 s[6:7], s[0:1], 40
  s_sub_u32 s20, s2, 205
  s_lshl_b32 s20, s20, 8
  v_add_u32 v1, s20, v0
  v_cmp_gt_u32 vcc, 17280, v1
  s_and_saveexec_b64 s[24:25], vcc
  s_cbranch_execz L_k0_end
  s_mov_b32 s21, 19419
  v_mul_lo_u32 v2, s21, v1
  v_lshrrev_b32 v2, 22, v2
  v_mul_u32_u24 v3, 216, v2
  v_sub_u32 v3, v1, v3
  v_lshrrev_b32 v4, 2, v2
  v_and_b32 v5, 3, v2
  v_lshlrev_b32 v6, 5, v4
  v_lshl_add_u32 v6, v5, 2, v6
  v_add_u32 v7, 16, v6
  s_mov_b32 s22, 3456
  v_mul_u32_u24 v6, s22, v6
  v_mul_u32_u24 v7, s22, v7
  v_lshl_add_u32 v6, v3, 4, v6
  v_lshl_add_u32 v7, v3, 4, v7
  s_waitcnt lgkmcnt(0)
  s_mov_b32 s12, s6
  s_mov_b32 s13, s7
  s_mov_b32 s14, 0x21c000
  s_mov_b32 s15, 0x00020000
  s_mov_b32 s23, 0
  buffer_load_dwordx4 v[16:19], v6, s[12:15], s23 offen
  buffer_load_dwordx4 v[32:35], v7, s[12:15], s23 offen
  s_mov_b32 s23, 3456
  buffer_load_dwordx4 v[20:23], v6, s[12:15], s23 offen
  buffer_load_dwordx4 v[36:39], v7, s[12:15], s23 offen
  s_mov_b32 s23, 6912
  buffer_load_dwordx4 v[24:27], v6, s[12:15], s23 offen
  buffer_load_dwordx4 v[40:43], v7, s[12:15], s23 offen
  s_mov_b32 s23, 10368
  buffer_load_dwordx4 v[28:31], v6, s[12:15], s23 offen
  buffer_load_dwordx4 v[44:47], v7, s[12:15], s23 offen
  v_lshrrev_b32 v4, 2, v2
  v_and_b32 v5, 3, v2
  v_and_b32 v8, 1, v3
  v_lshlrev_b32 v8, 7, v8
  v_lshl_add_u32 v8, v5, 8, v8
  v_lshrrev_b32 v9, 1, v3
  v_mul_u32_u24 v9, 20, v9
  v_add_u32 v9, v9, v4
  v_lshl_add_u32 v8, v9, 10, v8
  s_add_u32 s16, s4, 0x330000
  s_addc_u32 s17, s5, 0
  s_mov_b32 s18, 0x21c000
  s_mov_b32 s19, 0x00020000
  s_mov_b32 s26, 0x05040100
  s_mov_b32 s27, 0x07060302
  s_waitcnt vmcnt(0)
  v_perm_b32 v48, v20, v16, s26
  v_perm_b32 v49, v28, v24, s26
  v_perm_b32 v50, v36, v32, s26
  v_perm_b32 v51, v44, v40, s26
  buffer_store_dwordx4 v[48:51], v8, s[16:19], 0 offen offset:0
  v_perm_b32 v52, v20, v16, s27
  v_perm_b32 v53, v28, v24, s27
  v_perm_b32 v54, v36, v32, s27
  v_perm_b32 v55, v44, v40, s27
  buffer_store_dwordx4 v[52:55], v8, s[16:19], 0 offen offset:16
  v_perm_b32 v56, v21, v17, s26
  v_perm_b32 v57, v29, v25, s26
  v_perm_b32 v58, v37, v33, s26
  v_perm_b32 v59, v45, v41, s26
  buffer_store_dwordx4 v[56:59], v8, s[16:19], 0 offen offset:32
  v_perm_b32 v60, v21, v17, s27
  v_perm_b32 v61, v29, v25, s27
  v_perm_b32 v62, v37, v33, s27
  v_perm_b32 v63, v45, v41, s27
  buffer_store_dwordx4 v[60:63], v8, s[16:19], 0 offen offset:48
  v_perm_b32 v64, v22, v18, s26
  v_perm_b32 v65, v30, v26, s26
  v_perm_b32 v66, v38, v34, s26
  v_perm_b32 v67, v46, v42, s26
  buffer_store_dwordx4 v[64:67], v8, s[16:19], 0 offen offset:64
  v_perm_b32 v68, v22, v18, s27
  v_perm_b32 v69, v30, v26, s27
  v_perm_b32 v70, v38, v34, s27
  v_perm_b32 v71, v46, v42, s27
  buffer_store_dwordx4 v[68:71], v8, s[16:19], 0 offen offset:80
  v_perm_b32 v72, v23, v19, s26
  v_perm_b32 v73, v31, v27, s26
  v_perm_b32 v74, v39, v35, s26
  v_perm_b32 v75, v47, v43, s26
  buffer_store_dwordx4 v[72:75], v8, s[16:19], 0 offen offset:96
  v_perm_b32 v76, v23, v19, s27
  v_perm_b32 v77, v31, v27, s27
  v_perm_b32 v78, v39, v35, s27
  v_perm_b32 v79, v47, v43, s27
  buffer_store_dwordx4 v[76:79], v8, s[16:19], 0 offen offset:112
  s_branch L_k0_end
L_t3:
  s_cmp_lg_u32 s2, 180
  s_cbranch_scc1 L_t3_go
  s_waitcnt lgkmcnt(0)
  s_add_u32 s12, s4, 0x2000
  s_addc_u32 s13, s5, 0
  s_mov_b32 s14, 0x4
  s_mov_b32 s15, 0x00020000
  v_mov_b32 v1, 0
  v_cmp_eq_u32 vcc, 0, v0
  s_and_saveexec_b64 s[24:25], vcc
  s_cbranch_execz L_t3_non
  buffer_load_dword v2, v1, s[12:15], 0 offen
  s_waitcnt vmcnt(0)
  v_add_u32 v2, 1, v2
  buffer_store_dword v2, v1, s[12:15], 0 offen
L_t3_non:
  s_mov_b64 exec, s[24:25]
L_t3_go:
  s_load_dwordx2 s[6:7], s[0:1], 24
  s_sub_u32 s20, s2, 180
  s_lshl_b32 s20, s20, 8
  v_add_u32 v1, s20, v0
  v_cmp_gt_u32 vcc, 6400, v1
  s_and_saveexec_b64 s[24:25], vcc
  s_cbranch_execz L_k0_end
  s_mov_b32 s21, 3277
  v_mul_lo_u32 v2, s21, v1
  v_lshrrev_b32 v2, 18, v2
  v_mul_u32_u24 v3, 80, v2
  v_sub_u32 v3, v1, v3
  s_mov_b32 s22, 103
  v_mul_u32_u24 v4, s22, v2
  v_lshrrev_b32 v4, 9, v4
  v_mul_u32_u24 v5, 5, v4
  v_sub_u32 v5, v2, v5
  v_mul_u32_u24 v4, 40, v4
  v_lshlrev_b32 v6, 3, v5
  v_cmp_le_u32 vcc, 2, v5
  v_add_u32 v7, 4, v6
  s_nop 0
  v_cndmask_b32 v6, v6, v7, vcc
  v_add_u32 v7, 4, v6
  v_cmp_eq_u32 vcc, 4, v5
  v_mov_b32 v8, 16
  v_mov_b32 v9, 36
  v_cndmask_b32 v6, v6, v8, vcc
  v_cndmask_b32 v7, v7, v9, vcc
  v_add_u32 v6, v4, v6
  v_add_u32 v7, v4, v7
  s_mov_b32 s22, 1280
  v_mul_u32_u24 v6, s22, v6
  v_mul_u32_u24 v7, s22, v7
  v_lshl_add_u32 v6, v3, 4, v6
  v_lshl_add_u32 v7, v3, 4, v7
  s_waitcnt lgkmcnt(0)
  s_mov_b32 s12, s6
  s_mov_b32 s13, s7
  s_mov_b32 s14, 0xc8000
  s_mov_b32 s15, 0x00020000
  s_mov_b32 s23, 0
  buffer_load_dwordx4 v[16:19], v6, s[12:15], s23 offen
  buffer_load_dwordx4 v[32:35], v7, s[12:15], s23 offen
  s_mov_b32 s23, 1280
  buffer_load_dwordx4 v[20:23], v6, s[12:15], s23 offen
  buffer_load_dwordx4 v[36:39], v7, s[12:15], s23 offen
  s_mov_b32 s23, 2560
  buffer_load_dwordx4 v[24:27], v6, s[12:15], s23 offen
  buffer_load_dwordx4 v[40:43], v7, s[12:15], s23 offen
  s_mov_b32 s23, 3840
  buffer_load_dwordx4 v[28:31], v6, s[12:15], s23 offen
  buffer_load_dwordx4 v[44:47], v7, s[12:15], s23 offen
  v_lshrrev_b32 v4, 2, v2
  v_and_b32 v5, 3, v2
  v_and_b32 v8, 1, v3
  v_lshlrev_b32 v8, 7, v8
  v_lshl_add_u32 v8, v5, 8, v8
  s_mov_b32 s22, 103
  v_mul_u32_u24 v9, s22, v3
  v_lshrrev_b32 v9, 10, v9
  v_mul_u32_u24 v10, 10, v9
  v_sub_u32 v10, v3, v10
  v_lshrrev_b32 v10, 1, v10
  v_mul_u32_u24 v11, 5, v4
  v_add_u32 v10, v10, v11
  v_lshl_add_u32 v8, v10, 10, v8
  s_mov_b32 s22, 102400
  v_mul_u32_u24 v9, s22, v9
  v_add_u32 v8, v8, v9
  s_add_u32 s16, s4, 0x268000
  s_addc_u32 s17, s5, 0
  s_mov_b32 s18, 0xc8000
  s_mov_b32 s19, 0x00020000
  s_mov_b32 s26, 0x05040100
  s_mov_b32 s27, 0x07060302
  s_waitcnt vmcnt(0)
  v_perm_b32 v48, v20, v16, s26
  v_perm_b32 v49, v28, v24, s26
  v_perm_b32 v50, v36, v32, s26
  v_perm_b32 v51, v44, v40, s26
  buffer_store_dwordx4 v[48:51], v8, s[16:19], 0 offen offset:0
  v_perm_b32 v52, v20, v16, s27
  v_perm_b32 v53, v28, v24, s27
  v_perm_b32 v54, v36, v32, s27
  v_perm_b32 v55, v44, v40, s27
  buffer_store_dwordx4 v[52:55], v8, s[16:19], 0 offen offset:16
  v_perm_b32 v56, v21, v17, s26
  v_perm_b32 v57, v29, v25, s26
  v_perm_b32 v58, v37, v33, s26
  v_perm_b32 v59, v45, v41, s26
  buffer_store_dwordx4 v[56:59], v8, s[16:19], 0 offen offset:32
  v_perm_b32 v60, v21, v17, s27
  v_perm_b32 v61, v29, v25, s27
  v_perm_b32 v62, v37, v33, s27
  v_perm_b32 v63, v45, v41, s27
  buffer_store_dwordx4 v[60:63], v8, s[16:19], 0 offen offset:48
  v_perm_b32 v64, v22, v18, s26
  v_perm_b32 v65, v30, v26, s26
  v_perm_b32 v66, v38, v34, s26
  v_perm_b32 v67, v46, v42, s26
  buffer_store_dwordx4 v[64:67], v8, s[16:19], 0 offen offset:64
  v_perm_b32 v68, v22, v18, s27
  v_perm_b32 v69, v30, v26, s27
  v_perm_b32 v70, v38, v34, s27
  v_perm_b32 v71, v46, v42, s27
  buffer_store_dwordx4 v[68:71], v8, s[16:19], 0 offen offset:80
  v_perm_b32 v72, v23, v19, s26
  v_perm_b32 v73, v31, v27, s26
  v_perm_b32 v74, v39, v35, s26
  v_perm_b32 v75, v47, v43, s26
  buffer_store_dwordx4 v[72:75], v8, s[16:19], 0 offen offset:96
  v_perm_b32 v76, v23, v19, s27
  v_perm_b32 v77, v31, v27, s27
  v_perm_b32 v78, v39, v35, s27
  v_perm_b32 v79, v47, v43, s27
  buffer_store_dwordx4 v[76:79], v8, s[16:19], 0 offen offset:112
  s_branch L_k0_end
L_t2:
  s_load_dwordx2 s[6:7], s[0:1], 8
  s_load_dwordx2 s[8:9], s[0:1], 16
  s_sub_u32 s20, s2, 60
  s_mul_i32 s21, s20, 103
  s_lshr_b32 s21, s21, 11
  s_mul_i32 s22, s21, 20
  s_sub_u32 s22, s20, s22
  s_mul_i32 s23, s21, 3
  s_lshr_b32 s23, s23, 3
  s_mul_i32 s24, s23, 3
  s_sub_u32 s24, s21, s24
  s_mul_i32 s25, s24, 20
  s_add_u32 s26, s24, 1
  s_cmp_eq_u32 s24, 2
  s_cselect_b32 s26, 0, s26
  s_mul_i32 s26, s26, 1280
  v_lshrrev_b32 v1, 6, v0
  s_nop 0
  v_readfirstlane_b32 s27, v1
  v_and_b32 v2, 63, v0
  s_lshl_b32 s28, s23, 4
  s_lshl_b32 s29, s27, 2
  s_add_u32 s28, s28, s29
  v_and_b32 v3, 31, v2
  v_lshrrev_b32 v4, 4, v3
  v_lshlrev_b32 v4, 4, v4
  v_bfe_u32 v5, v3, 2, 1
  v_lshl_add_u32 v4, v5, 3, v4
  v_bfe_u32 v5, v3, 3, 1
  v_lshl_add_u32 v4, v5, 2, v4
  v_and_b32 v5, 3, v3
  v_add_u32 v4, v4, v5
  s_lshl_b32 s30, s22, 5
  v_add_u32 v4, s30, v4
  s_mov_b32 s31, 3840
  v_mul_u32_u24 v4, s31, v4
  v_lshrrev_b32 v5, 5, v2
  v_lshl_add_u32 v4, v5, 4, v4
  s_mul_i32 s31, s28, 40
  s_add_u32 s31, s31, s26
  v_add_u32 v4, s31, v4
  s_waitcnt lgkmcnt(0)
  s_mov_b32 s12, s6
  s_mov_b32 s13, s7
  s_mov_b32 s14, 0x258000
  s_mov_b32 s15, 0x00020000
  s_mov_b32 s16, s8
  s_mov_b32 s17, s9
  s_mov_b32 s18, 0x6400
  s_mov_b32 s19, 0x00020000
  buffer_load_dwordx4 v[32:35], v4, s[12:15], 0 offen offset:0
  buffer_load_dwordx4 v[36:39], v4, s[12:15], 0 offen offset:32
  buffer_load_dwordx4 v[40:43], v4, s[12:15], 0 offen offset:40
  buffer_load_dwordx4 v[44:47], v4, s[12:15], 0 offen offset:72
  buffer_load_dwordx4 v[48:51], v4, s[12:15], 0 offen offset:80
  buffer_load_dwordx4 v[52:55], v4, s[12:15], 0 offen offset:112
  buffer_load_dwordx4 v[56:59], v4, s[12:15], 0 offen offset:120
  buffer_load_dwordx4 v[60:63], v4, s[12:15], 0 offen offset:152
  s_mul_i32 s31, s28, 800
  v_lshlrev_b32 v6, 3, v2
  v_add_u32 v6, s31, v6
  s_cmp_eq_u32 s24, 1
  s_cbranch_scc1 L_t2_nophi
  buffer_load_dwordx2 v[64:65], v6, s[16:19], 0 offen offset:0
  buffer_load_dwordx2 v[66:67], v6, s[16:19], 0 offen offset:512
  buffer_load_dwordx2 v[68:69], v6, s[16:19], 0 offen offset:1024
  buffer_load_dwordx2 v[70:71], v6, s[16:19], 0 offen offset:1536
  buffer_load_dwordx2 v[72:73], v6, s[16:19], 0 offen offset:2048
  buffer_load_dwordx2 v[74:75], v6, s[16:19], 0 offen offset:2560
  buffer_load_dwordx2 v[76:77], v6, s[16:19], 0 offen offset:3072
L_t2_nophi:
  s_lshl_b32 s33, s27, 13
  v_lshlrev_b32 v7, 4, v2
  v_add_u32 v7, s33, v7
  v_mov_b32 v80, 0
  v_mov_b32 v81, 0
  v_mov_b32 v82, 0
  v_mov_b32 v83, 0
  ds_write_b128 v7, v[80:83] offset:0
  ds_write_b128 v7, v[80:83] offset:1024
  ds_write_b128 v7, v[80:83] offset:2048
  ds_write_b128 v7, v[80:83] offset:3072
  ds_write_b128 v7, v[80:83] offset:4096
  ds_write_b128 v7, v[80:83] offset:5120
  ds_write_b128 v7, v[80:83] offset:6144
  ds_write_b128 v7, v[80:83] offset:7168
  s_cmp_eq_u32 s24, 1
  s_cbranch_scc1 L_t2_ident
  v_add_u32 v8, 0, v2
  s_mov_b32 s34, 41
  v_mul_u32_u24 v9, s34, v8
  v_lshrrev_b32 v9, 12, v9
  v_mul_u32_u24 v10, 100, v9
  v_sub_u32 v10, v8, v10
  s_mov_b32 s34, 103
  v_mul_u32_u24 v11, s34, v10
  v_lshrrev_b32 v11, 9, v11
  v_mul_u32_u24 v12, 5, v11
  v_sub_u32 v12, v10, v12
  v_lshlrev_b32 v9, 11, v9
  v_lshl_add_u32 v9, v11, 6, v9
  v_lshl_add_u32 v9, v12, 3, v9
  v_add_u32 v9, s33, v9
  s_waitcnt vmcnt(6)
  ds_write_b64 v9, v[64:65]
  v_add_u32 v8, 64, v2
  s_mov_b32 s34, 41
  v_mul_u32_u24 v9, s34, v8
  v_lshrrev_b32 v9, 12, v9
  v_mul_u32_u24 v10, 100, v9
  v_sub_u32 v10, v8, v10
  s_mov_b32 s34, 103
  v_mul_u32_u24 v11, s34, v10
  v_lshrrev_b32 v11, 9, v11
  v_mul_u32_u24 v12, 5, v11
  v_sub_u32 v12, v10, v12
  v_lshlrev_b32 v9, 11, v9
  v_lshl_add_u32 v9, v11, 6, v9
  v_lshl_add_u32 v9, v12, 3, v9
  v_add_u32 v9, s33, v9
  s_waitcnt vmcnt(5)
  ds_write_b64 v9, v[66:67]
  v_add_u32 v8, 128, v2
  s_mov_b32 s34, 41
  v_mul_u32_u24 v9, s34, v8
  v_lshrrev_b32 v9, 12, v9
  v_mul_u32_u24 v10, 100, v9
  v_sub_u32 v10, v8, v10
  s_mov_b32 s34, 103
  v_mul_u32_u24 v11, s34, v10
  v_lshrrev_b32 v11, 9, v11
  v_mul_u32_u24 v12, 5, v11
  v_sub_u32 v12, v10, v12
  v_lshlrev_b32 v9, 11, v9
  v_lshl_add_u32 v9, v11, 6, v9
  v_lshl_add_u32 v9, v12, 3, v9
  v_add_u32 v9, s33, v9
  s_waitcnt vmcnt(4)
  ds_write_b64 v9, v[68:69]
  v_add_u32 v8, 192, v2
  s_mov_b32 s34, 41
  v_mul_u32_u24 v9, s34, v8
  v_lshrrev_b32 v9, 12, v9
  v_mul_u32_u24 v10, 100, v9
  v_sub_u32 v10, v8, v10
  s_mov_b32 s34, 103
  v_mul_u32_u24 v11, s34, v10
  v_lshrrev_b32 v11, 9, v11
  v_mul_u32_u24 v12, 5, v11
  v_sub_u32 v12, v10, v12
  v_lshlrev_b32 v9, 11, v9
  v_lshl_add_u32 v9, v11, 6, v9
  v_lshl_add_u32 v9, v12, 3, v9
  v_add_u32 v9, s33, v9
  s_waitcnt vmcnt(3)
  ds_write_b64 v9, v[70:71]
  v_add_u32 v8, 256, v2
  s_mov_b32 s34, 41
  v_mul_u32_u24 v9, s34, v8
  v_lshrrev_b32 v9, 12, v9
  v_mul_u32_u24 v10, 100, v9
  v_sub_u32 v10, v8, v10
  s_mov_b32 s34, 103
  v_mul_u32_u24 v11, s34, v10
  v_lshrrev_b32 v11, 9, v11
  v_mul_u32_u24 v12, 5, v11
  v_sub_u32 v12, v10, v12
  v_lshlrev_b32 v9, 11, v9
  v_lshl_add_u32 v9, v11, 6, v9
  v_lshl_add_u32 v9, v12, 3, v9
  v_add_u32 v9, s33, v9
  s_waitcnt vmcnt(2)
  ds_write_b64 v9, v[72:73]
  v_add_u32 v8, 320, v2
  s_mov_b32 s34, 41
  v_mul_u32_u24 v9, s34, v8
  v_lshrrev_b32 v9, 12, v9
  v_mul_u32_u24 v10, 100, v9
  v_sub_u32 v10, v8, v10
  s_mov_b32 s34, 103
  v_mul_u32_u24 v11, s34, v10
  v_lshrrev_b32 v11, 9, v11
  v_mul_u32_u24 v12, 5, v11
  v_sub_u32 v12, v10, v12
  v_lshlrev_b32 v9, 11, v9
  v_lshl_add_u32 v9, v11, 6, v9
  v_lshl_add_u32 v9, v12, 3, v9
  v_add_u32 v9, s33, v9
  s_waitcnt vmcnt(1)
  ds_write_b64 v9, v[74:75]
  v_add_u32 v8, 384, v2
  s_mov_b32 s34, 41
  v_mul_u32_u24 v9, s34, v8
  v_lshrrev_b32 v9, 12, v9
  v_mul_u32_u24 v10, 100, v9
  v_sub_u32 v10, v8, v10
  s_mov_b32 s34, 103
  v_mul_u32_u24 v11, s34, v10
  v_lshrrev_b32 v11, 9, v11
  v_mul_u32_u24 v12, 5, v11
  v_sub_u32 v12, v10, v12
  v_lshlrev_b32 v9, 11, v9
  v_lshl_add_u32 v9, v11, 6, v9
  v_lshl_add_u32 v9, v12, 3, v9
  v_add_u32 v9, s33, v9
  v_cmp_gt_u32 vcc, 16, v2
  s_and_saveexec_b64 s[36:37], vcc
  s_waitcnt vmcnt(0)
  ds_write_b64 v9, v[76:77]
  s_mov_b64 exec, s[36:37]
  s_branch L_t2_go
L_t2_ident:
  v_mul_u32_u24 v9, 66, v2
  v_add_u32 v9, s33, v9
  v_mov_b32 v10, 0x3f80
  v_cmp_gt_u32 vcc, 20, v2
  s_and_saveexec_b64 s[36:37], vcc
  ds_write_b16 v9, v10 offset:0
  ds_write_b16 v9, v10 offset:2048
  ds_write_b16 v9, v10 offset:4096
  ds_write_b16 v9, v10 offset:6144
  s_mov_b64 exec, s[36:37]
L_t2_go:
  v_lshrrev_b32 v8, 5, v2
  v_lshlrev_b32 v8, 3, v8
  v_bfe_u32 v9, v2, 2, 2
  v_add_u32 v8, v8, v9
  v_lshlrev_b32 v8, 6, v8
  v_bfe_u32 v9, v2, 4, 1
  v_lshl_add_u32 v8, v9, 5, v8
  v_and_b32 v9, 3, v2
  v_lshl_add_u32 v8, v9, 3, v8
  v_add_u32 v8, s33, v8
  v_and_b32 v3, 31, v2
  v_add_u32 v9, s25, v3
  v_lshrrev_b32 v10, 4, v9
  v_bfe_u32 v11, v9, 2, 2
  v_lshlrev_b32 v11, 3, v11
  v_and_b32 v12, 3, v9
  v_add_u32 v11, v11, v12
  v_lshrrev_b32 v12, 5, v2
  v_cmp_eq_u32 vcc, 3, v10
  v_mov_b32 v13, 32
  v_mov_b32 v14, 24
  v_cndmask_b32 v13, v13, v14, vcc
  v_mul_u32_u24 v12, v12, v13
  v_add_u32 v11, v11, v12
  v_lshlrev_b32 v11, 4, v11
  s_mul_i32 s35, s22, 6144
  v_lshl_add_u32 v15, v10, 10, s35
  s_mul_i32 s35, s22, 1536
  s_add_u32 s35, s35, 122880
  v_mov_b32 v14, s35
  v_cndmask_b32 v15, v15, v14, vcc
  v_add_u32 v11, v11, v15
  v_mov_b32 v13, 3072
  v_mov_b32 v14, 768
  v_cndmask_b32 v13, v13, v14, vcc
  v_add_u32 v15, v11, v13
  s_lshr_b32 s34, s28, 1
  s_mul_i32 s34, s34, 153600
  s_mov_b32 s38, 1.0
  s_mov_b32 s39, 0x3fb8aa3b
  s_cmp_eq_u32 s24, 1
  s_cselect_b32 s38, s38, s39
  s_add_u32 s16, s4, 0x10000
  s_addc_u32 s17, s5, 0
  s_mov_b32 s18, 0x258000
  s_mov_b32 s19, 0x00020000
  s_waitcnt lgkmcnt(0)
  ds_read_b64_tr_b16 v[84:85], v8 offset:0
  ds_read_b64_tr_b16 v[86:87], v8 offset:256
  ds_read_b64_tr_b16 v[88:89], v8 offset:1024
  ds_read_b64_tr_b16 v[90:91], v8 offset:1280
  s_waitcnt vmcnt(0) lgkmcnt(0)
  v_mfma_f32_32x32x16_bf16 v[96:111], v[32:35], v[84:87], 0
  v_mfma_f32_32x32x16_bf16 v[96:111], v[36:39], v[88:91], v[96:111]
  s_nop 15
  v_mul_f32 v96, s38, v96
  v_mul_f32 v97, s38, v97
  v_mul_f32 v98, s38, v98
  v_mul_f32 v99, s38, v99
  v_mul_f32 v100, s38, v100
  v_mul_f32 v101, s38, v101
  v_mul_f32 v102, s38, v102
  v_mul_f32 v103, s38, v103
  v_mul_f32 v104, s38, v104
  v_mul_f32 v105, s38, v105
  v_mul_f32 v106, s38, v106
  v_mul_f32 v107, s38, v107
  v_mul_f32 v108, s38, v108
  v_mul_f32 v109, s38, v109
  v_mul_f32 v110, s38, v110
  v_mul_f32 v111, s38, v111
  v_cvt_pk_bf16_f32 v112, v96, v97
  v_cvt_pk_bf16_f32 v113, v98, v99
  v_cvt_pk_bf16_f32 v114, v100, v101
  v_cvt_pk_bf16_f32 v115, v102, v103
  v_cvt_pk_bf16_f32 v116, v104, v105
  v_cvt_pk_bf16_f32 v117, v106, v107
  v_cvt_pk_bf16_f32 v118, v108, v109
  v_cvt_pk_bf16_f32 v119, v110, v111
  v_cmp_gt_u32 vcc, 20, v3
  s_and_saveexec_b64 s[36:37], vcc
  buffer_store_dwordx4 v[112:115], v11, s[16:19], s34 offen offset:0
  buffer_store_dwordx4 v[116:119], v15, s[16:19], s34 offen offset:0
  s_mov_b64 exec, s[36:37]
  s_nop 1
  ds_read_b64_tr_b16 v[84:85], v8 offset:2048
  ds_read_b64_tr_b16 v[86:87], v8 offset:2304
  ds_read_b64_tr_b16 v[88:89], v8 offset:3072
  ds_read_b64_tr_b16 v[90:91], v8 offset:3328
  s_waitcnt lgkmcnt(0)
  v_mfma_f32_32x32x16_bf16 v[96:111], v[40:43], v[84:87], 0
  v_mfma_f32_32x32x16_bf16 v[96:111], v[44:47], v[88:91], v[96:111]
  s_nop 15
  v_mul_f32 v96, s38, v96
  v_mul_f32 v97, s38, v97
  v_mul_f32 v98, s38, v98
  v_mul_f32 v99, s38, v99
  v_mul_f32 v100, s38, v100
  v_mul_f32 v101, s38, v101
  v_mul_f32 v102, s38, v102
  v_mul_f32 v103, s38, v103
  v_mul_f32 v104, s38, v104
  v_mul_f32 v105, s38, v105
  v_mul_f32 v106, s38, v106
  v_mul_f32 v107, s38, v107
  v_mul_f32 v108, s38, v108
  v_mul_f32 v109, s38, v109
  v_mul_f32 v110, s38, v110
  v_mul_f32 v111, s38, v111
  v_cvt_pk_bf16_f32 v112, v96, v97
  v_cvt_pk_bf16_f32 v113, v98, v99
  v_cvt_pk_bf16_f32 v114, v100, v101
  v_cvt_pk_bf16_f32 v115, v102, v103
  v_cvt_pk_bf16_f32 v116, v104, v105
  v_cvt_pk_bf16_f32 v117, v106, v107
  v_cvt_pk_bf16_f32 v118, v108, v109
  v_cvt_pk_bf16_f32 v119, v110, v111
  v_cmp_gt_u32 vcc, 20, v3
  s_and_saveexec_b64 s[36:37], vcc
  buffer_store_dwordx4 v[112:115], v11, s[16:19], s34 offen offset:64
  buffer_store_dwordx4 v[116:119], v15, s[16:19], s34 offen offset:64
  s_mov_b64 exec, s[36:37]
  s_nop 1
  ds_read_b64_tr_b16 v[84:85], v8 offset:4096
  ds_read_b64_tr_b16 v[86:87], v8 offset:4352
  ds_read_b64_tr_b16 v[88:89], v8 offset:5120
  ds_read_b64_tr_b16 v[90:91], v8 offset:5376
  s_waitcnt lgkmcnt(0)
  v_mfma_f32_32x32x16_bf16 v[96:111], v[48:51], v[84:87], 0
  v_mfma_f32_32x32x16_bf16 v[96:111], v[52:55], v[88:91], v[96:111]
  s_nop 15
  v_mul_f32 v96, s38, v96
  v_mul_f32 v97, s38, v97
  v_mul_f32 v98, s38, v98
  v_mul_f32 v99, s38, v99
  v_mul_f32 v100, s38, v100
  v_mul_f32 v101, s38, v101
  v_mul_f32 v102, s38, v102
  v_mul_f32 v103, s38, v103
  v_mul_f32 v104, s38, v104
  v_mul_f32 v105, s38, v105
  v_mul_f32 v106, s38, v106
  v_mul_f32 v107, s38, v107
  v_mul_f32 v108, s38, v108
  v_mul_f32 v109, s38, v109
  v_mul_f32 v110, s38, v110
  v_mul_f32 v111, s38, v111
  v_cvt_pk_bf16_f32 v112, v96, v97
  v_cvt_pk_bf16_f32 v113, v98, v99
  v_cvt_pk_bf16_f32 v114, v100, v101
  v_cvt_pk_bf16_f32 v115, v102, v103
  v_cvt_pk_bf16_f32 v116, v104, v105
  v_cvt_pk_bf16_f32 v117, v106, v107
  v_cvt_pk_bf16_f32 v118, v108, v109
  v_cvt_pk_bf16_f32 v119, v110, v111
  v_cmp_gt_u32 vcc, 20, v3
  s_and_saveexec_b64 s[36:37], vcc
  s_add_u32 s34, s34, 153600
  buffer_store_dwordx4 v[112:115], v11, s[16:19], s34 offen offset:0
  buffer_store_dwordx4 v[116:119], v15, s[16:19], s34 offen offset:0
  s_mov_b64 exec, s[36:37]
  s_nop 1
  ds_read_b64_tr_b16 v[84:85], v8 offset:6144
  ds_read_b64_tr_b16 v[86:87], v8 offset:6400
  ds_read_b64_tr_b16 v[88:89], v8 offset:7168
  ds_read_b64_tr_b16 v[90:91], v8 offset:7424
  s_waitcnt lgkmcnt(0)
  v_mfma_f32_32x32x16_bf16 v[96:111], v[56:59], v[84:87], 0
  v_mfma_f32_32x32x16_bf16 v[96:111], v[60:63], v[88:91], v[96:111]
  s_nop 15
  v_mul_f32 v96, s38, v96
  v_mul_f32 v97, s38, v97
  v_mul_f32 v98, s38, v98
  v_mul_f32 v99, s38, v99
  v_mul_f32 v100, s38, v100
  v_mul_f32 v101, s38, v101
  v_mul_f32 v102, s38, v102
  v_mul_f32 v103, s38, v103
  v_mul_f32 v104, s38, v104
  v_mul_f32 v105, s38, v105
  v_mul_f32 v106, s38, v106
  v_mul_f32 v107, s38, v107
  v_mul_f32 v108, s38, v108
  v_mul_f32 v109, s38, v109
  v_mul_f32 v110, s38, v110
  v_mul_f32 v111, s38, v111
  v_cvt_pk_bf16_f32 v112, v96, v97
  v_cvt_pk_bf16_f32 v113, v98, v99
  v_cvt_pk_bf16_f32 v114, v100, v101
  v_cvt_pk_bf16_f32 v115, v102, v103
  v_cvt_pk_bf16_f32 v116, v104, v105
  v_cvt_pk_bf16_f32 v117, v106, v107
  v_cvt_pk_bf16_f32 v118, v108, v109
  v_cvt_pk_bf16_f32 v119, v110, v111
  v_cmp_gt_u32 vcc, 20, v3
  s_and_saveexec_b64 s[36:37], vcc
  buffer_store_dwordx4 v[112:115], v11, s[16:19], s34 offen offset:64
  buffer_store_dwordx4 v[116:119], v15, s[16:19], s34 offen offset:64
  s_mov_b64 exec, s[36:37]
  s_nop 1
  s_branch L_k0_end
L_t1:
  s_load_dwordx2 s[6:7], s[0:1], 72
  s_load_dwordx2 s[8:9], s[0:1], 80
  v_lshrrev_b32 v1, 6, v0
  v_and_b32 v2, 63, v0
  v_lshrrev_b32 v3, 3, v2
  v_and_b32 v4, 7, v2
  v_mul_u32_u24 v5, 160, v1
  v_add_u32 v5, v5, v3
  s_mov_b32 s20, 7680
  v_mul_u32_u24 v6, s20, v5
  v_lshl_add_u32 v6, v4, 4, v6
  s_lshl_b32 s21, s2, 7
  v_add_u32 v6, s21, v6
  v_lshlrev_b32 v7, 1, v5
  s_waitcnt lgkmcnt(0)
  s_mov_b32 s12, s6
  s_mov_b32 s13, s7
  s_mov_b32 s14, 0x500
  s_mov_b32 s15, 0x00020000
  s_mov_b32 s16, s8
  s_mov_b32 s17, s9
  s_mov_b32 s18, 0x4b0000
  s_mov_b32 s19, 0x00020000
  buffer_load_ushort v16, v7, s[12:15], 0 offen offset:0
  buffer_load_ushort v17, v7, s[12:15], 0 offen offset:16
  buffer_load_ushort v18, v7, s[12:15], 0 offen offset:32
  buffer_load_ushort v19, v7, s[12:15], 0 offen offset:48
  buffer_load_ushort v20, v7, s[12:15], 0 offen offset:64
  buffer_load_ushort v21, v7, s[12:15], 0 offen offset:80
  buffer_load_ushort v22, v7, s[12:15], 0 offen offset:96
  buffer_load_ushort v23, v7, s[12:15], 0 offen offset:112
  buffer_load_ushort v24, v7, s[12:15], 0 offen offset:128
  buffer_load_ushort v25, v7, s[12:15], 0 offen offset:144
  buffer_load_ushort v26, v7, s[12:15], 0 offen offset:160
  buffer_load_ushort v27, v7, s[12:15], 0 offen offset:176
  buffer_load_ushort v28, v7, s[12:15], 0 offen offset:192
  buffer_load_ushort v29, v7, s[12:15], 0 offen offset:208
  buffer_load_ushort v30, v7, s[12:15], 0 offen offset:224
  buffer_load_ushort v31, v7, s[12:15], 0 offen offset:240
  buffer_load_ushort v32, v7, s[12:15], 0 offen offset:256
  buffer_load_ushort v33, v7, s[12:15], 0 offen offset:272
  buffer_load_ushort v34, v7, s[12:15], 0 offen offset:288
  buffer_load_ushort v35, v7, s[12:15], 0 offen offset:304
  s_mov_b32 s22, 0
  buffer_load_dwordx4 v[40:43], v6, s[16:19], s22 offen
  s_add_u32 s22, s22, 61440
  buffer_load_dwordx4 v[44:47], v6, s[16:19], s22 offen
  s_add_u32 s22, s22, 61440
  buffer_load_dwordx4 v[48:51], v6, s[16:19], s22 offen
  s_add_u32 s22, s22, 61440
  buffer_load_dwordx4 v[52:55], v6, s[16:19], s22 offen
  s_add_u32 s22, s22, 61440
  buffer_load_dwordx4 v[56:59], v6, s[16:19], s22 offen
  s_add_u32 s22, s22, 61440
  buffer_load_dwordx4 v[60:63], v6, s[16:19], s22 offen
  s_add_u32 s22, s22, 61440
  buffer_load_dwordx4 v[64:67], v6, s[16:19], s22 offen
  s_add_u32 s22, s22, 61440
  buffer_load_dwordx4 v[68:71], v6, s[16:19], s22 offen
  s_add_u32 s22, s22, 61440
  buffer_load_dwordx4 v[72:75], v6, s[16:19], s22 offen
  s_add_u32 s22, s22, 61440
  buffer_load_dwordx4 v[76:79], v6, s[16:19], s22 offen
  s_add_u32 s22, s22, 61440
  buffer_load_dwordx4 v[80:83], v6, s[16:19], s22 offen
  s_add_u32 s22, s22, 61440
  buffer_load_dwordx4 v[84:87], v6, s[16:19], s22 offen
  s_add_u32 s22, s22, 61440
  buffer_load_dwordx4 v[88:91], v6, s[16:19], s22 offen
  s_add_u32 s22, s22, 61440
  buffer_load_dwordx4 v[92:95], v6, s[16:19], s22 offen
  s_add_u32 s22, s22, 61440
  buffer_load_dwordx4 v[96:99], v6, s[16:19], s22 offen
  s_add_u32 s22, s22, 61440
  buffer_load_dwordx4 v[100:103], v6, s[16:19], s22 offen
  s_add_u32 s22, s22, 61440
  buffer_load_dwordx4 v[104:107], v6, s[16:19], s22 offen
  s_add_u32 s22, s22, 61440
  buffer_load_dwordx4 v[108:111], v6, s[16:19], s22 offen
  s_add_u32 s22, s22, 61440
  buffer_load_dwordx4 v[112:115], v6, s[16:19], s22 offen
  s_add_u32 s22, s22, 61440
  buffer_load_dwordx4 v[116:119], v6, s[16:19], s22 offen
  v_mov_b32 v8, 0
  v_mov_b32 v9, 0
  v_mov_b32 v10, 0
  v_mov_b32 v11, 0
  v_mov_b32 v12, 0
  v_mov_b32 v13, 0
  v_mov_b32 v14, 0
  v_mov_b32 v15, 0
  s_waitcnt vmcnt(20)
  v_lshlrev_b32 v16, 16, v16
  v_mul_f32 v36, 0xbfb8aa3b, v16
  v_exp_f32 v36, v36
  s_nop 0
  v_add_f32 v36, 1.0, v36
  v_rcp_f32 v36, v36
  s_nop 0
  v_mul_f32 v36, v16, v36
  v_cvt_pk_bf16_f32 v16, v36, 0
  v_lshlrev_b32 v17, 16, v17
  v_mul_f32 v36, 0xbfb8aa3b, v17
  v_exp_f32 v36, v36
  s_nop 0
  v_add_f32 v36, 1.0, v36
  v_rcp_f32 v36, v36
  s_nop 0
  v_mul_f32 v36, v17, v36
  v_cvt_pk_bf16_f32 v17, v36, 0
  v_lshlrev_b32 v18, 16, v18
  v_mul_f32 v36, 0xbfb8aa3b, v18
  v_exp_f32 v36, v36
  s_nop 0
  v_add_f32 v36, 1.0, v36
  v_rcp_f32 v36, v36
  s_nop 0
  v_mul_f32 v36, v18, v36
  v_cvt_pk_bf16_f32 v18, v36, 0
  v_lshlrev_b32 v19, 16, v19
  v_mul_f32 v36, 0xbfb8aa3b, v19
  v_exp_f32 v36, v36
  s_nop 0
  v_add_f32 v36, 1.0, v36
  v_rcp_f32 v36, v36
  s_nop 0
  v_mul_f32 v36, v19, v36
  v_cvt_pk_bf16_f32 v19, v36, 0
  v_lshlrev_b32 v20, 16, v20
  v_mul_f32 v36, 0xbfb8aa3b, v20
  v_exp_f32 v36, v36
  s_nop 0
  v_add_f32 v36, 1.0, v36
  v_rcp_f32 v36, v36
  s_nop 0
  v_mul_f32 v36, v20, v36
  v_cvt_pk_bf16_f32 v20, v36, 0
  v_lshlrev_b32 v21, 16, v21
  v_mul_f32 v36, 0xbfb8aa3b, v21
  v_exp_f32 v36, v36
  s_nop 0
  v_add_f32 v36, 1.0, v36
  v_rcp_f32 v36, v36
  s_nop 0
  v_mul_f32 v36, v21, v36
  v_cvt_pk_bf16_f32 v21, v36, 0
  v_lshlrev_b32 v22, 16, v22
  v_mul_f32 v36, 0xbfb8aa3b, v22
  v_exp_f32 v36, v36
  s_nop 0
  v_add_f32 v36, 1.0, v36
  v_rcp_f32 v36, v36
  s_nop 0
  v_mul_f32 v36, v22, v36
  v_cvt_pk_bf16_f32 v22, v36, 0
  v_lshlrev_b32 v23, 16, v23
  v_mul_f32 v36, 0xbfb8aa3b, v23
  v_exp_f32 v36, v36
  s_nop 0
  v_add_f32 v36, 1.0, v36
  v_rcp_f32 v36, v36
  s_nop 0
  v_mul_f32 v36, v23, v36
  v_cvt_pk_bf16_f32 v23, v36, 0
  v_lshlrev_b32 v24, 16, v24
  v_mul_f32 v36, 0xbfb8aa3b, v24
  v_exp_f32 v36, v36
  s_nop 0
  v_add_f32 v36, 1.0, v36
  v_rcp_f32 v36, v36
  s_nop 0
  v_mul_f32 v36, v24, v36
  v_cvt_pk_bf16_f32 v24, v36, 0
  v_lshlrev_b32 v25, 16, v25
  v_mul_f32 v36, 0xbfb8aa3b, v25
  v_exp_f32 v36, v36
  s_nop 0
  v_add_f32 v36, 1.0, v36
  v_rcp_f32 v36, v36
  s_nop 0
  v_mul_f32 v36, v25, v36
  v_cvt_pk_bf16_f32 v25, v36, 0
  v_lshlrev_b32 v26, 16, v26
  v_mul_f32 v36, 0xbfb8aa3b, v26
  v_exp_f32 v36, v36
  s_nop 0
  v_add_f32 v36, 1.0, v36
  v_rcp_f32 v36, v36
  s_nop 0
  v_mul_f32 v36, v26, v36
  v_cvt_pk_bf16_f32 v26, v36, 0
  v_lshlrev_b32 v27, 16, v27
  v_mul_f32 v36, 0xbfb8aa3b, v27
  v_exp_f32 v36, v36
  s_nop 0
  v_add_f32 v36, 1.0, v36
  v_rcp_f32 v36, v36
  s_nop 0
  v_mul_f32 v36, v27, v36
  v_cvt_pk_bf16_f32 v27, v36, 0
  v_lshlrev_b32 v28, 16, v28
  v_mul_f32 v36, 0xbfb8aa3b, v28
  v_exp_f32 v36, v36
  s_nop 0
  v_add_f32 v36, 1.0, v36
  v_rcp_f32 v36, v36
  s_nop 0
  v_mul_f32 v36, v28, v36
  v_cvt_pk_bf16_f32 v28, v36, 0
  v_lshlrev_b32 v29, 16, v29
  v_mul_f32 v36, 0xbfb8aa3b, v29
  v_exp_f32 v36, v36
  s_nop 0
  v_add_f32 v36, 1.0, v36
  v_rcp_f32 v36, v36
  s_nop 0
  v_mul_f32 v36, v29, v36
  v_cvt_pk_bf16_f32 v29, v36, 0
  v_lshlrev_b32 v30, 16, v30
  v_mul_f32 v36, 0xbfb8aa3b, v30
  v_exp_f32 v36, v36
  s_nop 0
  v_add_f32 v36, 1.0, v36
  v_rcp_f32 v36, v36
  s_nop 0
  v_mul_f32 v36, v30, v36
  v_cvt_pk_bf16_f32 v30, v36, 0
  v_lshlrev_b32 v31, 16, v31
  v_mul_f32 v36, 0xbfb8aa3b, v31
  v_exp_f32 v36, v36
  s_nop 0
  v_add_f32 v36, 1.0, v36
  v_rcp_f32 v36, v36
  s_nop 0
  v_mul_f32 v36, v31, v36
  v_cvt_pk_bf16_f32 v31, v36, 0
  v_lshlrev_b32 v32, 16, v32
  v_mul_f32 v36, 0xbfb8aa3b, v32
  v_exp_f32 v36, v36
  s_nop 0
  v_add_f32 v36, 1.0, v36
  v_rcp_f32 v36, v36
  s_nop 0
  v_mul_f32 v36, v32, v36
  v_cvt_pk_bf16_f32 v32, v36, 0
  v_lshlrev_b32 v33, 16, v33
  v_mul_f32 v36, 0xbfb8aa3b, v33
  v_exp_f32 v36, v36
  s_nop 0
  v_add_f32 v36, 1.0, v36
  v_rcp_f32 v36, v36
  s_nop 0
  v_mul_f32 v36, v33, v36
  v_cvt_pk_bf16_f32 v33, v36, 0
  v_lshlrev_b32 v34, 16, v34
  v_mul_f32 v36, 0xbfb8aa3b, v34
  v_exp_f32 v36, v36
  s_nop 0
  v_add_f32 v36, 1.0, v36
  v_rcp_f32 v36, v36
  s_nop 0
  v_mul_f32 v36, v34, v36
  v_cvt_pk_bf16_f32 v34, v36, 0
  v_lshlrev_b32 v35, 16, v35
  v_mul_f32 v36, 0xbfb8aa3b, v35
  v_exp_f32 v36, v36
  s_nop 0
  v_add_f32 v36, 1.0, v36
  v_rcp_f32 v36, v36
  s_nop 0
  v_mul_f32 v36, v35, v36
  v_cvt_pk_bf16_f32 v35, v36, 0
  s_waitcnt vmcnt(19)
  v_lshlrev_b32 v37, 16, v16
  v_dot2_f32_bf16 v8, v40, v16, v8
  v_dot2_f32_bf16 v9, v40, v37, v9
  v_dot2_f32_bf16 v10, v41, v16, v10
  v_dot2_f32_bf16 v11, v41, v37, v11
  v_dot2_f32_bf16 v12, v42, v16, v12
  v_dot2_f32_bf16 v13, v42, v37, v13
  v_dot2_f32_bf16 v14, v43, v16, v14
  v_dot2_f32_bf16 v15, v43, v37, v15
  s_waitcnt vmcnt(18)
  v_lshlrev_b32 v37, 16, v17
  v_dot2_f32_bf16 v8, v44, v17, v8
  v_dot2_f32_bf16 v9, v44, v37, v9
  v_dot2_f32_bf16 v10, v45, v17, v10
  v_dot2_f32_bf16 v11, v45, v37, v11
  v_dot2_f32_bf16 v12, v46, v17, v12
  v_dot2_f32_bf16 v13, v46, v37, v13
  v_dot2_f32_bf16 v14, v47, v17, v14
  v_dot2_f32_bf16 v15, v47, v37, v15
  s_waitcnt vmcnt(17)
  v_lshlrev_b32 v37, 16, v18
  v_dot2_f32_bf16 v8, v48, v18, v8
  v_dot2_f32_bf16 v9, v48, v37, v9
  v_dot2_f32_bf16 v10, v49, v18, v10
  v_dot2_f32_bf16 v11, v49, v37, v11
  v_dot2_f32_bf16 v12, v50, v18, v12
  v_dot2_f32_bf16 v13, v50, v37, v13
  v_dot2_f32_bf16 v14, v51, v18, v14
  v_dot2_f32_bf16 v15, v51, v37, v15
  s_waitcnt vmcnt(16)
  v_lshlrev_b32 v37, 16, v19
  v_dot2_f32_bf16 v8, v52, v19, v8
  v_dot2_f32_bf16 v9, v52, v37, v9
  v_dot2_f32_bf16 v10, v53, v19, v10
  v_dot2_f32_bf16 v11, v53, v37, v11
  v_dot2_f32_bf16 v12, v54, v19, v12
  v_dot2_f32_bf16 v13, v54, v37, v13
  v_dot2_f32_bf16 v14, v55, v19, v14
  v_dot2_f32_bf16 v15, v55, v37, v15
  s_waitcnt vmcnt(15)
  v_lshlrev_b32 v37, 16, v20
  v_dot2_f32_bf16 v8, v56, v20, v8
  v_dot2_f32_bf16 v9, v56, v37, v9
  v_dot2_f32_bf16 v10, v57, v20, v10
  v_dot2_f32_bf16 v11, v57, v37, v11
  v_dot2_f32_bf16 v12, v58, v20, v12
  v_dot2_f32_bf16 v13, v58, v37, v13
  v_dot2_f32_bf16 v14, v59, v20, v14
  v_dot2_f32_bf16 v15, v59, v37, v15
  s_waitcnt vmcnt(14)
  v_lshlrev_b32 v37, 16, v21
  v_dot2_f32_bf16 v8, v60, v21, v8
  v_dot2_f32_bf16 v9, v60, v37, v9
  v_dot2_f32_bf16 v10, v61, v21, v10
  v_dot2_f32_bf16 v11, v61, v37, v11
  v_dot2_f32_bf16 v12, v62, v21, v12
  v_dot2_f32_bf16 v13, v62, v37, v13
  v_dot2_f32_bf16 v14, v63, v21, v14
  v_dot2_f32_bf16 v15, v63, v37, v15
  s_waitcnt vmcnt(13)
  v_lshlrev_b32 v37, 16, v22
  v_dot2_f32_bf16 v8, v64, v22, v8
  v_dot2_f32_bf16 v9, v64, v37, v9
  v_dot2_f32_bf16 v10, v65, v22, v10
  v_dot2_f32_bf16 v11, v65, v37, v11
  v_dot2_f32_bf16 v12, v66, v22, v12
  v_dot2_f32_bf16 v13, v66, v37, v13
  v_dot2_f32_bf16 v14, v67, v22, v14
  v_dot2_f32_bf16 v15, v67, v37, v15
  s_waitcnt vmcnt(12)
  v_lshlrev_b32 v37, 16, v23
  v_dot2_f32_bf16 v8, v68, v23, v8
  v_dot2_f32_bf16 v9, v68, v37, v9
  v_dot2_f32_bf16 v10, v69, v23, v10
  v_dot2_f32_bf16 v11, v69, v37, v11
  v_dot2_f32_bf16 v12, v70, v23, v12
  v_dot2_f32_bf16 v13, v70, v37, v13
  v_dot2_f32_bf16 v14, v71, v23, v14
  v_dot2_f32_bf16 v15, v71, v37, v15
  s_waitcnt vmcnt(11)
  v_lshlrev_b32 v37, 16, v24
  v_dot2_f32_bf16 v8, v72, v24, v8
  v_dot2_f32_bf16 v9, v72, v37, v9
  v_dot2_f32_bf16 v10, v73, v24, v10
  v_dot2_f32_bf16 v11, v73, v37, v11
  v_dot2_f32_bf16 v12, v74, v24, v12
  v_dot2_f32_bf16 v13, v74, v37, v13
  v_dot2_f32_bf16 v14, v75, v24, v14
  v_dot2_f32_bf16 v15, v75, v37, v15
  s_waitcnt vmcnt(10)
  v_lshlrev_b32 v37, 16, v25
  v_dot2_f32_bf16 v8, v76, v25, v8
  v_dot2_f32_bf16 v9, v76, v37, v9
  v_dot2_f32_bf16 v10, v77, v25, v10
  v_dot2_f32_bf16 v11, v77, v37, v11
  v_dot2_f32_bf16 v12, v78, v25, v12
  v_dot2_f32_bf16 v13, v78, v37, v13
  v_dot2_f32_bf16 v14, v79, v25, v14
  v_dot2_f32_bf16 v15, v79, v37, v15
  s_waitcnt vmcnt(9)
  v_lshlrev_b32 v37, 16, v26
  v_dot2_f32_bf16 v8, v80, v26, v8
  v_dot2_f32_bf16 v9, v80, v37, v9
  v_dot2_f32_bf16 v10, v81, v26, v10
  v_dot2_f32_bf16 v11, v81, v37, v11
  v_dot2_f32_bf16 v12, v82, v26, v12
  v_dot2_f32_bf16 v13, v82, v37, v13
  v_dot2_f32_bf16 v14, v83, v26, v14
  v_dot2_f32_bf16 v15, v83, v37, v15
  s_waitcnt vmcnt(8)
  v_lshlrev_b32 v37, 16, v27
  v_dot2_f32_bf16 v8, v84, v27, v8
  v_dot2_f32_bf16 v9, v84, v37, v9
  v_dot2_f32_bf16 v10, v85, v27, v10
  v_dot2_f32_bf16 v11, v85, v37, v11
  v_dot2_f32_bf16 v12, v86, v27, v12
  v_dot2_f32_bf16 v13, v86, v37, v13
  v_dot2_f32_bf16 v14, v87, v27, v14
  v_dot2_f32_bf16 v15, v87, v37, v15
  s_waitcnt vmcnt(7)
  v_lshlrev_b32 v37, 16, v28
  v_dot2_f32_bf16 v8, v88, v28, v8
  v_dot2_f32_bf16 v9, v88, v37, v9
  v_dot2_f32_bf16 v10, v89, v28, v10
  v_dot2_f32_bf16 v11, v89, v37, v11
  v_dot2_f32_bf16 v12, v90, v28, v12
  v_dot2_f32_bf16 v13, v90, v37, v13
  v_dot2_f32_bf16 v14, v91, v28, v14
  v_dot2_f32_bf16 v15, v91, v37, v15
  s_waitcnt vmcnt(6)
  v_lshlrev_b32 v37, 16, v29
  v_dot2_f32_bf16 v8, v92, v29, v8
  v_dot2_f32_bf16 v9, v92, v37, v9
  v_dot2_f32_bf16 v10, v93, v29, v10
  v_dot2_f32_bf16 v11, v93, v37, v11
  v_dot2_f32_bf16 v12, v94, v29, v12
  v_dot2_f32_bf16 v13, v94, v37, v13
  v_dot2_f32_bf16 v14, v95, v29, v14
  v_dot2_f32_bf16 v15, v95, v37, v15
  s_waitcnt vmcnt(5)
  v_lshlrev_b32 v37, 16, v30
  v_dot2_f32_bf16 v8, v96, v30, v8
  v_dot2_f32_bf16 v9, v96, v37, v9
  v_dot2_f32_bf16 v10, v97, v30, v10
  v_dot2_f32_bf16 v11, v97, v37, v11
  v_dot2_f32_bf16 v12, v98, v30, v12
  v_dot2_f32_bf16 v13, v98, v37, v13
  v_dot2_f32_bf16 v14, v99, v30, v14
  v_dot2_f32_bf16 v15, v99, v37, v15
  s_waitcnt vmcnt(4)
  v_lshlrev_b32 v37, 16, v31
  v_dot2_f32_bf16 v8, v100, v31, v8
  v_dot2_f32_bf16 v9, v100, v37, v9
  v_dot2_f32_bf16 v10, v101, v31, v10
  v_dot2_f32_bf16 v11, v101, v37, v11
  v_dot2_f32_bf16 v12, v102, v31, v12
  v_dot2_f32_bf16 v13, v102, v37, v13
  v_dot2_f32_bf16 v14, v103, v31, v14
  v_dot2_f32_bf16 v15, v103, v37, v15
  s_waitcnt vmcnt(3)
  v_lshlrev_b32 v37, 16, v32
  v_dot2_f32_bf16 v8, v104, v32, v8
  v_dot2_f32_bf16 v9, v104, v37, v9
  v_dot2_f32_bf16 v10, v105, v32, v10
  v_dot2_f32_bf16 v11, v105, v37, v11
  v_dot2_f32_bf16 v12, v106, v32, v12
  v_dot2_f32_bf16 v13, v106, v37, v13
  v_dot2_f32_bf16 v14, v107, v32, v14
  v_dot2_f32_bf16 v15, v107, v37, v15
  s_waitcnt vmcnt(2)
  v_lshlrev_b32 v37, 16, v33
  v_dot2_f32_bf16 v8, v108, v33, v8
  v_dot2_f32_bf16 v9, v108, v37, v9
  v_dot2_f32_bf16 v10, v109, v33, v10
  v_dot2_f32_bf16 v11, v109, v37, v11
  v_dot2_f32_bf16 v12, v110, v33, v12
  v_dot2_f32_bf16 v13, v110, v37, v13
  v_dot2_f32_bf16 v14, v111, v33, v14
  v_dot2_f32_bf16 v15, v111, v37, v15
  s_waitcnt vmcnt(1)
  v_lshlrev_b32 v37, 16, v34
  v_dot2_f32_bf16 v8, v112, v34, v8
  v_dot2_f32_bf16 v9, v112, v37, v9
  v_dot2_f32_bf16 v10, v113, v34, v10
  v_dot2_f32_bf16 v11, v113, v37, v11
  v_dot2_f32_bf16 v12, v114, v34, v12
  v_dot2_f32_bf16 v13, v114, v37, v13
  v_dot2_f32_bf16 v14, v115, v34, v14
  v_dot2_f32_bf16 v15, v115, v37, v15
  s_waitcnt vmcnt(0)
  v_lshlrev_b32 v37, 16, v35
  v_dot2_f32_bf16 v8, v116, v35, v8
  v_dot2_f32_bf16 v9, v116, v37, v9
  v_dot2_f32_bf16 v10, v117, v35, v10
  v_dot2_f32_bf16 v11, v117, v37, v11
  v_dot2_f32_bf16 v12, v118, v35, v12
  v_dot2_f32_bf16 v13, v118, v37, v13
  v_dot2_f32_bf16 v14, v119, v35, v14
  v_dot2_f32_bf16 v15, v119, v37, v15
  v_lshl_add_u32 v5, v1, 3, v3
  v_lshlrev_b32 v5, 8, v5
  v_lshl_add_u32 v5, v4, 5, v5
  s_nop 2
  ds_write_b128 v5, v[8:11]
  ds_write_b128 v5, v[12:15] offset:16
  s_waitcnt lgkmcnt(0)
  s_barrier
  v_cmp_gt_u32 vcc, 64, v0
  s_and_saveexec_b64 s[24:25], vcc
  s_cbranch_execz L_k0_end
  v_lshlrev_b32 v5, 2, v0
  ds_read_b32 v40, v5 offset:0
  ds_read_b32 v41, v5 offset:256
  ds_read_b32 v42, v5 offset:512
  ds_read_b32 v43, v5 offset:768
  ds_read_b32 v44, v5 offset:1024
  ds_read_b32 v45, v5 offset:1280
  ds_read_b32 v46, v5 offset:1536
  ds_read_b32 v47, v5 offset:1792
  ds_read_b32 v48, v5 offset:2048
  ds_read_b32 v49, v5 offset:2304
  ds_read_b32 v50, v5 offset:2560
  ds_read_b32 v51, v5 offset:2816
  ds_read_b32 v52, v5 offset:3072
  ds_read_b32 v53, v5 offset:3328
  ds_read_b32 v54, v5 offset:3584
  ds_read_b32 v55, v5 offset:3840
  ds_read_b32 v56, v5 offset:4096
  ds_read_b32 v57, v5 offset:4352
  ds_read_b32 v58, v5 offset:4608
  ds_read_b32 v59, v5 offset:4864
  ds_read_b32 v60, v5 offset:5120
  ds_read_b32 v61, v5 offset:5376
  ds_read_b32 v62, v5 offset:5632
  ds_read_b32 v63, v5 offset:5888
  ds_read_b32 v64, v5 offset:6144
  ds_read_b32 v65, v5 offset:6400
  ds_read_b32 v66, v5 offset:6656
  ds_read_b32 v67, v5 offset:6912
  ds_read_b32 v68, v5 offset:7168
  ds_read_b32 v69, v5 offset:7424
  ds_read_b32 v70, v5 offset:7680
  ds_read_b32 v71, v5 offset:7936
  s_waitcnt lgkmcnt(15)
  v_add_f32 v40, v40, v41
  v_add_f32 v40, v40, v42
  v_add_f32 v40, v40, v43
  v_add_f32 v40, v40, v44
  v_add_f32 v40, v40, v45
  v_add_f32 v40, v40, v46
  v_add_f32 v40, v40, v47
  s_waitcnt lgkmcnt(15)
  v_add_f32 v40, v40, v48
  v_add_f32 v40, v40, v49
  v_add_f32 v40, v40, v50
  v_add_f32 v40, v40, v51
  v_add_f32 v40, v40, v52
  v_add_f32 v40, v40, v53
  v_add_f32 v40, v40, v54
  v_add_f32 v40, v40, v55
  s_waitcnt lgkmcnt(8)
  v_add_f32 v40, v40, v56
  v_add_f32 v40, v40, v57
  v_add_f32 v40, v40, v58
  v_add_f32 v40, v40, v59
  v_add_f32 v40, v40, v60
  v_add_f32 v40, v40, v61
  v_add_f32 v40, v40, v62
  v_add_f32 v40, v40, v63
  s_waitcnt lgkmcnt(0)
  v_add_f32 v40, v40, v64
  v_add_f32 v40, v40, v65
  v_add_f32 v40, v40, v66
  v_add_f32 v40, v40, v67
  v_add_f32 v40, v40, v68
  v_add_f32 v40, v40, v69
  v_add_f32 v40, v40, v70
  v_add_f32 v40, v40, v71
  v_cvt_pk_bf16_f32 v41, v40, 0
  s_mul_i32 s26, s2, 13
  s_lshr_b32 s26, s26, 7
  s_cmp_eq_u32 s26, 1
  s_cselect_b32 s27, 1, 0
  s_cmp_eq_u32 s26, 4
  s_cselect_b32 s27, 1, s27
  s_cmp_eq_u32 s27, 0
  s_cbranch_scc1 L_t1_store
  v_lshlrev_b32 v41, 16, v41
  v_add_f32 v41, 1.0, v41
  v_cvt_pk_bf16_f32 v41, v41, 0
L_t1_store:
  v_lshlrev_b32 v5, 1, v0
  v_add_u32 v5, s21, v5
  s_mov_b32 s12, s4
  s_mov_b32 s13, s5
  s_mov_b32 s14, 0x1e00
  s_mov_b32 s15, 0x00020000
  buffer_store_short v41, v5, s[12:15], 0 offen
  s_branch L_k0_end
L_k0_end:
L_k0_exit:
  s_endpgm
.globl qkv_kernel
.p2align 8
.type qkv_kernel,@function
qkv_kernel:
  s_cmp_ge_u32 s2, 256
  s_cbranch_scc1 L_k1_end
  s_load_dwordx2 s[4:5], s[0:1], 104
  s_load_dwordx2 s[6:7], s[0:1], 0
  s_getreg_b32 s27, hwreg(HW_REG_XCC_ID, 0, 4)
  s_and_b32 s20, s2, 7
  s_lshr_b32 s21, s2, 7
  s_bfe_u32 s22, s2, 0x40003
  s_lshl_b32 s23, s20, 1
  s_add_u32 s23, s23, s21
  v_lshrrev_b32 v1, 6, v0
  v_and_b32 v2, 63, v0
  v_readfirstlane_b32 s24, v1
  v_lshlrev_b32 v3, 4, v2
  s_waitcnt lgkmcnt(0)
  s_load_dword s25, s[4:5], 8192
  s_cmp_ge_u32 s24, 2
  s_cbranch_scc1 L_k1_dma
  s_mov_b32 s8, s6
  s_mov_b32 s9, s7
  s_mov_b32 s10, 0x280000
  s_mov_b32 s11, 0x00020000
  s_mov_b32 s12, s4
  s_mov_b32 s13, s5
  s_mov_b32 s14, 0x1e00
  s_mov_b32 s15, 0x00020000
  v_and_b32 v4, 15, v2
  v_lshrrev_b32 v5, 4, v2
  s_lshl_b32 s28, s23, 7
  s_lshl_b32 s29, s22, 3
  s_add_u32 s28, s28, s29
  s_lshl_b32 s29, s24, 2
  s_add_u32 s28, s28, s29
  v_add_u32 v6, s28, v5
  s_mov_b32 s29, 1280
  v_mul_u32_u24 v6, s29, v6
  v_lshlrev_b32 v7, 4, v4
  v_add_u32 v6, v6, v7
  buffer_load_dwordx4 v[128:131], v6, s[8:11], 0 offen offset:0
  buffer_load_dwordx4 v[132:135], v6, s[8:11], 0 offen offset:256
  buffer_load_dwordx4 v[136:139], v6, s[8:11], 0 offen offset:512
  buffer_load_dwordx4 v[140:143], v6, s[8:11], 0 offen offset:768
  buffer_load_dwordx4 v[144:147], v6, s[8:11], 0 offen offset:1024
  buffer_load_dwordx4 v[148:151], v7, s[12:15], 0 offen offset:1280
  buffer_load_dwordx4 v[152:155], v7, s[12:15], 0 offen offset:1536
  buffer_load_dwordx4 v[156:159], v7, s[12:15], 0 offen offset:1792
  buffer_load_dwordx4 v[160:163], v7, s[12:15], 0 offen offset:2048
  buffer_load_dwordx4 v[164:167], v7, s[12:15], 0 offen offset:2304
  buffer_load_dwordx4 v[168:171], v7, s[12:15], 0 offen offset:0
  buffer_load_dwordx4 v[172:175], v7, s[12:15], 0 offen offset:256
  buffer_load_dwordx4 v[176:179], v7, s[12:15], 0 offen offset:512
  buffer_load_dwordx4 v[180:183], v7, s[12:15], 0 offen offset:768
  buffer_load_dwordx4 v[184:187], v7, s[12:15], 0 offen offset:1024
  s_add_u32 s16, s4, 0x3000
  s_addc_u32 s17, s5, 0
  s_mov_b32 s18, 0x800
  s_mov_b32 s19, 0x00020000
  s_lshl_b32 s30, s23, 7
  s_lshl_b32 s31, s22, 3
  s_add_u32 s31, s31, s30
  s_waitcnt lgkmcnt(0)
  s_cmp_lg_u32 s24, 0
  s_cbranch_scc1 L_k1_noxt
  v_mov_b32 v8, s31
  v_mov_b32 v10, s25
  v_mov_b32 v11, s27
  s_mov_b64 exec, 1
  buffer_store_dwordx2 v[10:11], v8, s[16:19], 0 offen sc1
  s_mov_b64 exec, -1
L_k1_noxt:
  s_lshr_b32 s32, s22, 2
  s_mul_i32 s32, s32, 41984
  s_mul_i32 s33, s23, 655360
  s_add_u32 s32, s32, s33
  s_and_b32 s33, s22, 3
  s_lshl_b32 s33, s33, 3
  s_lshl_b32 s34, s33, 4
  s_add_u32 s34, s34, s32
  s_lshl_b32 s43, s24, 15
  s_add_u32 s34, s34, s43
  v_lshlrev_b32 v13, 9, v2
  v_add_u32 v13, s34, v13
  s_lshl_b32 s34, s24, 2
  s_add_u32 s33, s33, s34
  v_add_u32 v9, s33, v5
  v_lshlrev_b32 v9, 4, v9
  v_lshrrev_b32 v12, 1, v4
  v_lshl_add_u32 v9, v12, 10, v9
  v_and_b32 v12, 1, v4
  v_lshl_add_u32 v9, v12, 9, v9
  v_add_u32 v9, s32, v9
  s_add_u32 s36, s4, 0x88c000
  s_addc_u32 s37, s5, 0
  s_mov_b32 s38, 0xa00000
  s_mov_b32 s39, 0x00020000
  s_cmp_eq_u32 s24, 0
  s_cselect_b32 s34, 64, 16
  v_cmp_gt_u32 vcc, s34, v2
  v_mov_b32 v12, 0x7ffffff0
  s_nop 0
  v_cndmask_b32 v13, v12, v13, vcc
  buffer_load_dword v23, v13, s[36:39], 0 offen
  s_mov_b32 s35, 0xffff0000
  s_cmp_eq_u32 s24, 0
  s_cbranch_scc1 L_k1_w0wait
  s_waitcnt vmcnt(11)
  s_branch L_k1_waited
L_k1_w0wait:
  s_waitcnt vmcnt(12)
L_k1_waited:
  v_lshlrev_b32 v188, 16, v128
  v_and_b32 v189, s35, v128
  v_lshlrev_b32 v190, 16, v129
  v_and_b32 v191, s35, v129
  v_lshlrev_b32 v192, 16, v130
  v_and_b32 v193, s35, v130
  v_lshlrev_b32 v194, 16, v131
  v_and_b32 v195, s35, v131
  v_lshlrev_b32 v196, 16, v132
  v_and_b32 v197, s35, v132
  v_lshlrev_b32 v198, 16, v133
  v_and_b32 v199, s35, v133
  v_lshlrev_b32 v200, 16, v134
  v_and_b32 v201, s35, v134
  v_lshlrev_b32 v202, 16, v135
  v_and_b32 v203, s35, v135
  v_lshlrev_b32 v204, 16, v136
  v_and_b32 v205, s35, v136
  v_lshlrev_b32 v206, 16, v137
  v_and_b32 v207, s35, v137
  v_lshlrev_b32 v208, 16, v138
  v_and_b32 v209, s35, v138
  v_lshlrev_b32 v210, 16, v139
  v_and_b32 v211, s35, v139
  v_lshlrev_b32 v212, 16, v140
  v_and_b32 v213, s35, v140
  v_lshlrev_b32 v214, 16, v141
  v_and_b32 v215, s35, v141
  v_lshlrev_b32 v216, 16, v142
  v_and_b32 v217, s35, v142
  v_lshlrev_b32 v218, 16, v143
  v_and_b32 v219, s35, v143
  v_lshlrev_b32 v220, 16, v144
  v_and_b32 v221, s35, v144
  v_lshlrev_b32 v222, 16, v145
  v_and_b32 v223, s35, v145
  v_lshlrev_b32 v224, 16, v146
  v_and_b32 v225, s35, v146
  v_lshlrev_b32 v226, 16, v147
  v_and_b32 v227, s35, v147
  v_pk_add_f32 v[14:15], v[188:189], v[190:191]
  v_pk_add_f32 v[14:15], v[14:15], v[192:193]
  v_pk_add_f32 v[14:15], v[14:15], v[194:195]
  v_pk_add_f32 v[14:15], v[14:15], v[196:197]
  v_pk_add_f32 v[14:15], v[14:15], v[198:199]
  v_pk_add_f32 v[14:15], v[14:15], v[200:201]
  v_pk_add_f32 v[14:15], v[14:15], v[202:203]
  v_pk_add_f32 v[14:15], v[14:15], v[204:205]
  v_pk_add_f32 v[14:15], v[14:15], v[206:207]
  v_pk_add_f32 v[14:15], v[14:15], v[208:209]
  v_pk_add_f32 v[14:15], v[14:15], v[210:211]
  v_pk_add_f32 v[14:15], v[14:15], v[212:213]
  v_pk_add_f32 v[14:15], v[14:15], v[214:215]
  v_pk_add_f32 v[14:15], v[14:15], v[216:217]
  v_pk_add_f32 v[14:15], v[14:15], v[218:219]
  v_pk_add_f32 v[14:15], v[14:15], v[220:221]
  v_pk_add_f32 v[14:15], v[14:15], v[222:223]
  v_pk_add_f32 v[14:15], v[14:15], v[224:225]
  v_pk_add_f32 v[14:15], v[14:15], v[226:227]
  v_add_f32 v14, v14, v15
  s_nop 1
  v_add_f32_dpp v14, v14, v14 quad_perm:[1,0,3,2] row_mask:0xf bank_mask:0xf
  s_nop 1
  v_add_f32_dpp v14, v14, v14 quad_perm:[2,3,0,1] row_mask:0xf bank_mask:0xf
  s_nop 1
  v_add_f32_dpp v14, v14, v14 row_half_mirror row_mask:0xf bank_mask:0xf
  s_nop 1
  v_add_f32_dpp v14, v14, v14 row_mirror row_mask:0xf bank_mask:0xf
  v_mul_f32 v14, 0x3acccccd, v14
  v_pk_add_f32 v[188:189], v[188:189], v[14:15] op_sel_hi:[1,0] neg_lo:[0,1] neg_hi:[0,1]
  v_pk_add_f32 v[190:191], v[190:191], v[14:15] op_sel_hi:[1,0] neg_lo:[0,1] neg_hi:[0,1]
  v_pk_add_f32 v[192:193], v[192:193], v[14:15] op_sel_hi:[1,0] neg_lo:[0,1] neg_hi:[0,1]
  v_pk_add_f32 v[194:195], v[194:195], v[14:15] op_sel_hi:[1,0] neg_lo:[0,1] neg_hi:[0,1]
  v_pk_add_f32 v[196:197], v[196:197], v[14:15] op_sel_hi:[1,0] neg_lo:[0,1] neg_hi:[0,1]
  v_pk_add_f32 v[198:199], v[198:199], v[14:15] op_sel_hi:[1,0] neg_lo:[0,1] neg_hi:[0,1]
  v_pk_add_f32 v[200:201], v[200:201], v[14:15] op_sel_hi:[1,0] neg_lo:[0,1] neg_hi:[0,1]
  v_pk_add_f32 v[202:203], v[202:203], v[14:15] op_sel_hi:[1,0] neg_lo:[0,1] neg_hi:[0,1]
  v_pk_add_f32 v[204:205], v[204:205], v[14:15] op_sel_hi:[1,0] neg_lo:[0,1] neg_hi:[0,1]
  v_pk_add_f32 v[206:207], v[206:207], v[14:15] op_sel_hi:[1,0] neg_lo:[0,1] neg_hi:[0,1]
  v_pk_add_f32 v[208:209], v[208:209], v[14:15] op_sel_hi:[1,0] neg_lo:[0,1] neg_hi:[0,1]
  v_pk_add_f32 v[210:211], v[210:211], v[14:15] op_sel_hi:[1,0] neg_lo:[0,1] neg_hi:[0,1]
  v_pk_add_f32 v[212:213], v[212:213], v[14:15] op_sel_hi:[1,0] neg_lo:[0,1] neg_hi:[0,1]
  v_pk_add_f32 v[214:215], v[214:215], v[14:15] op_sel_hi:[1,0] neg_lo:[0,1] neg_hi:[0,1]
  v_pk_add_f32 v[216:217], v[216:217], v[14:15] op_sel_hi:[1,0] neg_lo:[0,1] neg_hi:[0,1]
  v_pk_add_f32 v[218:219], v[218:219], v[14:15] op_sel_hi:[1,0] neg_lo:[0,1] neg_hi:[0,1]
  v_pk_add_f32 v[220:221], v[220:221], v[14:15] op_sel_hi:[1,0] neg_lo:[0,1] neg_hi:[0,1]
  v_pk_add_f32 v[222:223], v[222:223], v[14:15] op_sel_hi:[1,0] neg_lo:[0,1] neg_hi:[0,1]
  v_pk_add_f32 v[224:225], v[224:225], v[14:15] op_sel_hi:[1,0] neg_lo:[0,1] neg_hi:[0,1]
  v_pk_add_f32 v[226:227], v[226:227], v[14:15] op_sel_hi:[1,0] neg_lo:[0,1] neg_hi:[0,1]
  v_pk_mul_f32 v[16:17], v[188:189], v[188:189]
  v_pk_fma_f32 v[16:17], v[190:191], v[190:191], v[16:17]
  v_pk_fma_f32 v[16:17], v[192:193], v[192:193], v[16:17]
  v_pk_fma_f32 v[16:17], v[194:195], v[194:195], v[16:17]
  v_pk_fma_f32 v[16:17], v[196:197], v[196:197], v[16:17]
  v_pk_fma_f32 v[16:17], v[198:199], v[198:199], v[16:17]
  v_pk_fma_f32 v[16:17], v[200:201], v[200:201], v[16:17]
  v_pk_fma_f32 v[16:17], v[202:203], v[202:203], v[16:17]
  v_pk_fma_f32 v[16:17], v[204:205], v[204:205], v[16:17]
  v_pk_fma_f32 v[16:17], v[206:207], v[206:207], v[16:17]
  v_pk_fma_f32 v[16:17], v[208:209], v[208:209], v[16:17]
  v_pk_fma_f32 v[16:17], v[210:211], v[210:211], v[16:17]
  v_pk_fma_f32 v[16:17], v[212:213], v[212:213], v[16:17]
  v_pk_fma_f32 v[16:17], v[214:215], v[214:215], v[16:17]
  v_pk_fma_f32 v[16:17], v[216:217], v[216:217], v[16:17]
  v_pk_fma_f32 v[16:17], v[218:219], v[218:219], v[16:17]
  v_pk_fma_f32 v[16:17], v[220:221], v[220:221], v[16:17]
  v_pk_fma_f32 v[16:17], v[222:223], v[222:223], v[16:17]
  v_pk_fma_f32 v[16:17], v[224:225], v[224:225], v[16:17]
  v_pk_fma_f32 v[16:17], v[226:227], v[226:227], v[16:17]
  v_add_f32 v16, v16, v17
  s_nop 1
  v_add_f32_dpp v16, v16, v16 quad_perm:[1,0,3,2] row_mask:0xf bank_mask:0xf
  s_nop 1
  v_add_f32_dpp v16, v16, v16 quad_perm:[2,3,0,1] row_mask:0xf bank_mask:0xf
  s_nop 1
  v_add_f32_dpp v16, v16, v16 row_half_mirror row_mask:0xf bank_mask:0xf
  s_nop 1
  v_add_f32_dpp v16, v16, v16 row_mirror row_mask:0xf bank_mask:0xf
  v_mov_b32 v17, 0x3727c5ac
  v_fmac_f32 v17, 0x3acccccd, v16
  v_rsq_f32 v16, v17
  s_nop 0
  v_pk_mul_f32 v[188:189], v[188:189], v[16:17] op_sel_hi:[1,0]
  v_pk_mul_f32 v[190:191], v[190:191], v[16:17] op_sel_hi:[1,0]
  v_pk_mul_f32 v[192:193], v[192:193], v[16:17] op_sel_hi:[1,0]
  v_pk_mul_f32 v[194:195], v[194:195], v[16:17] op_sel_hi:[1,0]
  v_pk_mul_f32 v[196:197], v[196:197], v[16:17] op_sel_hi:[1,0]
  v_pk_mul_f32 v[198:199], v[198:199], v[16:17] op_sel_hi:[1,0]
  v_pk_mul_f32 v[200:201], v[200:201], v[16:17] op_sel_hi:[1,0]
  v_pk_mul_f32 v[202:203], v[202:203], v[16:17] op_sel_hi:[1,0]
  v_pk_mul_f32 v[204:205], v[204:205], v[16:17] op_sel_hi:[1,0]
  v_pk_mul_f32 v[206:207], v[206:207], v[16:17] op_sel_hi:[1,0]
  v_pk_mul_f32 v[208:209], v[208:209], v[16:17] op_sel_hi:[1,0]
  v_pk_mul_f32 v[210:211], v[210:211], v[16:17] op_sel_hi:[1,0]
  v_pk_mul_f32 v[212:213], v[212:213], v[16:17] op_sel_hi:[1,0]
  v_pk_mul_f32 v[214:215], v[214:215], v[16:17] op_sel_hi:[1,0]
  v_pk_mul_f32 v[216:217], v[216:217], v[16:17] op_sel_hi:[1,0]
  v_pk_mul_f32 v[218:219], v[218:219], v[16:17] op_sel_hi:[1,0]
  v_pk_mul_f32 v[220:221], v[220:221], v[16:17] op_sel_hi:[1,0]
  v_pk_mul_f32 v[222:223], v[222:223], v[16:17] op_sel_hi:[1,0]
  v_pk_mul_f32 v[224:225], v[224:225], v[16:17] op_sel_hi:[1,0]
  v_pk_mul_f32 v[226:227], v[226:227], v[16:17] op_sel_hi:[1,0]
  s_cmp_eq_u32 s24, 0
  s_cbranch_scc1 L_k1_w0wait2
  s_waitcnt vmcnt(1)
L_k1_w0wait2:
  s_waitcnt vmcnt(2)
  v_lshlrev_b32 v18, 16, v148
  v_and_b32 v19, s35, v148
  v_lshlrev_b32 v20, 16, v168
  v_and_b32 v21, s35, v168
  v_pk_fma_f32 v[18:19], v[188:189], v[18:19], v[20:21]
  v_cvt_pk_bf16_f32 v128, v18, v19
  v_lshlrev_b32 v18, 16, v149
  v_and_b32 v19, s35, v149
  v_lshlrev_b32 v20, 16, v169
  v_and_b32 v21, s35, v169
  v_pk_fma_f32 v[18:19], v[190:191], v[18:19], v[20:21]
  v_cvt_pk_bf16_f32 v129, v18, v19
  v_lshlrev_b32 v18, 16, v150
  v_and_b32 v19, s35, v150
  v_lshlrev_b32 v20, 16, v170
  v_and_b32 v21, s35, v170
  v_pk_fma_f32 v[18:19], v[192:193], v[18:19], v[20:21]
  v_cvt_pk_bf16_f32 v130, v18, v19
  v_lshlrev_b32 v18, 16, v151
  v_and_b32 v19, s35, v151
  v_lshlrev_b32 v20, 16, v171
  v_and_b32 v21, s35, v171
  v_pk_fma_f32 v[18:19], v[194:195], v[18:19], v[20:21]
  v_cvt_pk_bf16_f32 v131, v18, v19
  v_lshlrev_b32 v18, 16, v152
  v_and_b32 v19, s35, v152
  v_lshlrev_b32 v20, 16, v172
  v_and_b32 v21, s35, v172
  v_pk_fma_f32 v[18:19], v[196:197], v[18:19], v[20:21]
  v_cvt_pk_bf16_f32 v132, v18, v19
  v_lshlrev_b32 v18, 16, v153
  v_and_b32 v19, s35, v153
  v_lshlrev_b32 v20, 16, v173
  v_and_b32 v21, s35, v173
  v_pk_fma_f32 v[18:19], v[198:199], v[18:19], v[20:21]
  v_cvt_pk_bf16_f32 v133, v18, v19
  v_lshlrev_b32 v18, 16, v154
  v_and_b32 v19, s35, v154
  v_lshlrev_b32 v20, 16, v174
  v_and_b32 v21, s35, v174
  v_pk_fma_f32 v[18:19], v[200:201], v[18:19], v[20:21]
  v_cvt_pk_bf16_f32 v134, v18, v19
  v_lshlrev_b32 v18, 16, v155
  v_and_b32 v19, s35, v155
  v_lshlrev_b32 v20, 16, v175
  v_and_b32 v21, s35, v175
  v_pk_fma_f32 v[18:19], v[202:203], v[18:19], v[20:21]
  v_cvt_pk_bf16_f32 v135, v18, v19
  v_lshlrev_b32 v18, 16, v156
  v_and_b32 v19, s35, v156
  v_lshlrev_b32 v20, 16, v176
  v_and_b32 v21, s35, v176
  v_pk_fma_f32 v[18:19], v[204:205], v[18:19], v[20:21]
  v_cvt_pk_bf16_f32 v136, v18, v19
  v_lshlrev_b32 v18, 16, v157
  v_and_b32 v19, s35, v157
  v_lshlrev_b32 v20, 16, v177
  v_and_b32 v21, s35, v177
  v_pk_fma_f32 v[18:19], v[206:207], v[18:19], v[20:21]
  v_cvt_pk_bf16_f32 v137, v18, v19
  v_lshlrev_b32 v18, 16, v158
  v_and_b32 v19, s35, v158
  v_lshlrev_b32 v20, 16, v178
  v_and_b32 v21, s35, v178
  v_pk_fma_f32 v[18:19], v[208:209], v[18:19], v[20:21]
  v_cvt_pk_bf16_f32 v138, v18, v19
  v_lshlrev_b32 v18, 16, v159
  v_and_b32 v19, s35, v159
  v_lshlrev_b32 v20, 16, v179
  v_and_b32 v21, s35, v179
  v_pk_fma_f32 v[18:19], v[210:211], v[18:19], v[20:21]
  v_cvt_pk_bf16_f32 v139, v18, v19
  v_lshlrev_b32 v18, 16, v160
  v_and_b32 v19, s35, v160
  v_lshlrev_b32 v20, 16, v180
  v_and_b32 v21, s35, v180
  v_pk_fma_f32 v[18:19], v[212:213], v[18:19], v[20:21]
  v_cvt_pk_bf16_f32 v140, v18, v19
  v_lshlrev_b32 v18, 16, v161
  v_and_b32 v19, s35, v161
  v_lshlrev_b32 v20, 16, v181
  v_and_b32 v21, s35, v181
  v_pk_fma_f32 v[18:19], v[214:215], v[18:19], v[20:21]
  v_cvt_pk_bf16_f32 v141, v18, v19
  v_lshlrev_b32 v18, 16, v162
  v_and_b32 v19, s35, v162
  v_lshlrev_b32 v20, 16, v182
  v_and_b32 v21, s35, v182
  v_pk_fma_f32 v[18:19], v[216:217], v[18:19], v[20:21]
  v_cvt_pk_bf16_f32 v142, v18, v19
  v_lshlrev_b32 v18, 16, v163
  v_and_b32 v19, s35, v163
  v_lshlrev_b32 v20, 16, v183
  v_and_b32 v21, s35, v183
  v_pk_fma_f32 v[18:19], v[218:219], v[18:19], v[20:21]
  v_cvt_pk_bf16_f32 v143, v18, v19
  v_lshlrev_b32 v18, 16, v164
  v_and_b32 v19, s35, v164
  v_lshlrev_b32 v20, 16, v184
  v_and_b32 v21, s35, v184
  v_pk_fma_f32 v[18:19], v[220:221], v[18:19], v[20:21]
  v_cvt_pk_bf16_f32 v144, v18, v19
  v_lshlrev_b32 v18, 16, v165
  v_and_b32 v19, s35, v165
  v_lshlrev_b32 v20, 16, v185
  v_and_b32 v21, s35, v185
  v_pk_fma_f32 v[18:19], v[222:223], v[18:19], v[20:21]
  v_cvt_pk_bf16_f32 v145, v18, v19
  v_lshlrev_b32 v18, 16, v166
  v_and_b32 v19, s35, v166
  v_lshlrev_b32 v20, 16, v186
  v_and_b32 v21, s35, v186
  v_pk_fma_f32 v[18:19], v[224:225], v[18:19], v[20:21]
  v_cvt_pk_bf16_f32 v146, v18, v19
  v_lshlrev_b32 v18, 16, v167
  v_and_b32 v19, s35, v167
  v_lshlrev_b32 v20, 16, v187
  v_and_b32 v21, s35, v187
  v_pk_fma_f32 v[18:19], v[226:227], v[18:19], v[20:21]
  v_cvt_pk_bf16_f32 v147, v18, v19
  s_mov_b32 s34, 0
  buffer_store_dwordx4 v[128:131], v9, s[36:39], s34 offen
  s_add_u32 s34, s34, 8192
  buffer_store_dwordx4 v[132:135], v9, s[36:39], s34 offen
  s_add_u32 s34, s34, 8192
  buffer_store_dwordx4 v[136:139], v9, s[36:39], s34 offen
  s_add_u32 s34, s34, 8192
  buffer_store_dwordx4 v[140:143], v9, s[36:39], s34 offen
  s_add_u32 s34, s34, 8192
  buffer_store_dwordx4 v[144:147], v9, s[36:39], s34 offen
  s_cmp_lg_u32 s24, 0
  s_cbranch_scc1 L_k1_w1
  v_and_b32 v8, 15, v2
  v_lshlrev_b32 v8, 3, v8
  v_add_u32 v8, s30, v8
  s_mov_b32 s42, 0
L_poll_xt1_1:
  buffer_load_dwordx2 v[22:23], v8, s[16:19], 0 offen sc1
  s_waitcnt vmcnt(0)
  v_cmp_ne_u32 vcc, s25, v22
  s_add_u32 s42, s42, 1
  s_cmp_gt_u32 s42, 1048576
  s_cbranch_scc1 L_poll_xt1_1_done
  s_cmp_lg_u64 vcc, 0
  s_cbranch_scc1 L_poll_xt1_1
L_poll_xt1_1_done:
  v_cmp_ne_u32 vcc, s27, v23
  s_cmp_eq_u64 vcc, 0
  s_cselect_b32 s26, 1, 0
  s_barrier
  s_add_u32 s16, s4, 0x4000
  s_addc_u32 s17, s5, 0
  s_mov_b32 s18, 0x800
  s_mov_b32 s19, 0x00020000
  s_lshl_b32 s31, s22, 2
  s_add_u32 s31, s31, s30
  v_mov_b32 v10, s31
  v_mov_b32 v11, s25
  s_mov_b64 s[40:41], exec
  s_mov_b64 exec, 1
  s_cmp_eq_u32 s26, 0
  s_cbranch_scc1 L_slow_h_2
  buffer_store_dword v11, v10, s[16:19], 0 offen
  s_branch L_slow_h_2_d
L_slow_h_2:
  buffer_wbl2 sc1
  s_waitcnt vmcnt(0)
  buffer_store_dword v11, v10, s[16:19], 0 offen sc1
L_slow_h_2_d:
  s_mov_b64 exec, s[40:41]
  v_and_b32 v8, 15, v2
  v_lshlrev_b32 v8, 2, v8
  v_add_u32 v8, s30, v8
  s_mov_b32 s42, 0
L_poll_fl1_3:
  buffer_load_dword v22, v8, s[16:19], 0 offen sc1
  s_waitcnt vmcnt(0)
  v_cmp_ne_u32 vcc, s25, v22
  s_add_u32 s42, s42, 1
  s_cmp_gt_u32 s42, 1048576
  s_cbranch_scc1 L_poll_fl1_3_done
  s_cmp_lg_u64 vcc, 0
  s_cbranch_scc1 L_poll_fl1_3
L_poll_fl1_3_done:
  s_barrier
  s_branch L_k1_main
L_k1_w1:
  s_waitcnt vmcnt(0)
  s_barrier
  s_barrier
  s_branch L_k1_main
L_k1_dma:
  s_add_u32 s8, s4, 0x10000
  s_addc_u32 s9, s5, 0
  s_mov_b32 s10, 0x258000
  s_mov_b32 s11, 0x00020000
  s_mul_i32 s28, s22, 153600
  s_sub_u32 s29, s24, 2
  s_mul_i32 s29, s29, 76800
  s_add_u32 s28, s28, s29
  s_add_u32 m0, s29, 0
  s_nop 0
  buffer_load_dwordx4 v3, s[8:11], s28 offen offset:0 lds
  buffer_load_dwordx4 v3, s[8:11], s28 offen offset:1024 lds
  buffer_load_dwordx4 v3, s[8:11], s28 offen offset:2048 lds
  buffer_load_dwordx4 v3, s[8:11], s28 offen offset:3072 lds
  s_add_u32 m0, s29, 4096
  s_add_u32 s28, s28, 4096
  buffer_load_dwordx4 v3, s[8:11], s28 offen offset:0 lds
  buffer_load_dwordx4 v3, s[8:11], s28 offen offset:1024 lds
  buffer_load_dwordx4 v3, s[8:11], s28 offen offset:2048 lds
  buffer_load_dwordx4 v3, s[8:11], s28 offen offset:3072 lds
  s_add_u32 m0, s29, 8192
  s_add_u32 s28, s28, 4096
  buffer_load_dwordx4 v3, s[8:11], s28 offen offset:0 lds
  buffer_load_dwordx4 v3, s[8:11], s28 offen offset:1024 lds
  buffer_load_dwordx4 v3, s[8:11], s28 offen offset:2048 lds
  buffer_load_dwordx4 v3, s[8:11], s28 offen offset:3072 lds
  s_add_u32 m0, s29, 12288
  s_add_u32 s28, s28, 4096
  buffer_load_dwordx4 v3, s[8:11], s28 offen offset:0 lds
  buffer_load_dwordx4 v3, s[8:11], s28 offen offset:1024 lds
  buffer_load_dwordx4 v3, s[8:11], s28 offen offset:2048 lds
  buffer_load_dwordx4 v3, s[8:11], s28 offen offset:3072 lds
  s_add_u32 m0, s29, 16384
  s_add_u32 s28, s28, 4096
  buffer_load_dwordx4 v3, s[8:11], s28 offen offset:0 lds
  buffer_load_dwordx4 v3, s[8:11], s28 offen offset:1024 lds
  buffer_load_dwordx4 v3, s[8:11], s28 offen offset:2048 lds
  buffer_load_dwordx4 v3, s[8:11], s28 offen offset:3072 lds
  s_add_u32 m0, s29, 20480
  s_add_u32 s28, s28, 4096
  buffer_load_dwordx4 v3, s[8:11], s28 offen offset:0 lds
  buffer_load_dwordx4 v3, s[8:11], s28 offen offset:1024 lds
  buffer_load_dwordx4 v3, s[8:11], s28 offen offset:2048 lds
  buffer_load_dwordx4 v3, s[8:11], s28 offen offset:3072 lds
  s_add_u32 m0, s29, 24576
  s_add_u32 s28, s28, 4096
  buffer_load_dwordx4 v3, s[8:11], s28 offen offset:0 lds
  buffer_load_dwordx4 v3, s[8:11], s28 offen offset:1024 lds
  buffer_load_dwordx4 v3, s[8:11], s28 offen offset:2048 lds
  buffer_load_dwordx4 v3, s[8:11], s28 offen offset:3072 lds
  s_add_u32 m0, s29, 28672
  s_add_u32 s28, s28, 4096
  buffer_load_dwordx4 v3, s[8:11], s28 offen offset:0 lds
  buffer_load_dwordx4 v3, s[8:11], s28 offen offset:1024 lds
  buffer_load_dwordx4 v3, s[8:11], s28 offen offset:2048 lds
  buffer_load_dwordx4 v3, s[8:11], s28 offen offset:3072 lds
  s_add_u32 m0, s29, 32768
  s_add_u32 s28, s28, 4096
  buffer_load_dwordx4 v3, s[8:11], s28 offen offset:0 lds
  buffer_load_dwordx4 v3, s[8:11], s28 offen offset:1024 lds
  buffer_load_dwordx4 v3, s[8:11], s28 offen offset:2048 lds
  buffer_load_dwordx4 v3, s[8:11], s28 offen offset:3072 lds
  s_add_u32 m0, s29, 36864
  s_add_u32 s28, s28, 4096
  buffer_load_dwordx4 v3, s[8:11], s28 offen offset:0 lds
  buffer_load_dwordx4 v3, s[8:11], s28 offen offset:1024 lds
  buffer_load_dwordx4 v3, s[8:11], s28 offen offset:2048 lds
  buffer_load_dwordx4 v3, s[8:11], s28 offen offset:3072 lds
  s_add_u32 m0, s29, 40960
  s_add_u32 s28, s28, 4096
  buffer_load_dwordx4 v3, s[8:11], s28 offen offset:0 lds
  buffer_load_dwordx4 v3, s[8:11], s28 offen offset:1024 lds
  buffer_load_dwordx4 v3, s[8:11], s28 offen offset:2048 lds
  buffer_load_dwordx4 v3, s[8:11], s28 offen offset:3072 lds
  s_add_u32 m0, s29, 45056
  s_add_u32 s28, s28, 4096
  buffer_load_dwordx4 v3, s[8:11], s28 offen offset:0 lds
  buffer_load_dwordx4 v3, s[8:11], s28 offen offset:1024 lds
  buffer_load_dwordx4 v3, s[8:11], s28 offen offset:2048 lds
  buffer_load_dwordx4 v3, s[8:11], s28 offen offset:3072 lds
  s_add_u32 m0, s29, 49152
  s_add_u32 s28, s28, 4096
  buffer_load_dwordx4 v3, s[8:11], s28 offen offset:0 lds
  buffer_load_dwordx4 v3, s[8:11], s28 offen offset:1024 lds
  s_barrier
  buffer_load_dwordx4 v3, s[8:11], s28 offen offset:2048 lds
  buffer_load_dwordx4 v3, s[8:11], s28 offen offset:3072 lds
  s_add_u32 m0, s29, 53248
  s_add_u32 s28, s28, 4096
  buffer_load_dwordx4 v3, s[8:11], s28 offen offset:0 lds
  buffer_load_dwordx4 v3, s[8:11], s28 offen offset:1024 lds
  buffer_load_dwordx4 v3, s[8:11], s28 offen offset:2048 lds
  buffer_load_dwordx4 v3, s[8:11], s28 offen offset:3072 lds
  s_add_u32 m0, s29, 57344
  s_add_u32 s28, s28, 4096
  buffer_load_dwordx4 v3, s[8:11], s28 offen offset:0 lds
  buffer_load_dwordx4 v3, s[8:11], s28 offen offset:1024 lds
  buffer_load_dwordx4 v3, s[8:11], s28 offen offset:2048 lds
  buffer_load_dwordx4 v3, s[8:11], s28 offen offset:3072 lds
  s_add_u32 m0, s29, 61440
  s_add_u32 s28, s28, 4096
  buffer_load_dwordx4 v3, s[8:11], s28 offen offset:0 lds
  buffer_load_dwordx4 v3, s[8:11], s28 offen offset:1024 lds
  buffer_load_dwordx4 v3, s[8:11], s28 offen offset:2048 lds
  buffer_load_dwordx4 v3, s[8:11], s28 offen offset:3072 lds
  s_add_u32 m0, s29, 65536
  s_add_u32 s28, s28, 4096
  buffer_load_dwordx4 v3, s[8:11], s28 offen offset:0 lds
  buffer_load_dwordx4 v3, s[8:11], s28 offen offset:1024 lds
  buffer_load_dwordx4 v3, s[8:11], s28 offen offset:2048 lds
  buffer_load_dwordx4 v3, s[8:11], s28 offen offset:3072 lds
  s_add_u32 m0, s29, 69632
  s_add_u32 s28, s28, 4096
  buffer_load_dwordx4 v3, s[8:11], s28 offen offset:0 lds
  buffer_load_dwordx4 v3, s[8:11], s28 offen offset:1024 lds
  buffer_load_dwordx4 v3, s[8:11], s28 offen offset:2048 lds
  buffer_load_dwordx4 v3, s[8:11], s28 offen offset:3072 lds
  s_add_u32 m0, s29, 73728
  s_add_u32 s28, s28, 4096
  buffer_load_dwordx4 v3, s[8:11], s28 offen offset:0 lds
  buffer_load_dwordx4 v3, s[8:11], s28 offen offset:1024 lds
  buffer_load_dwordx4 v3, s[8:11], s28 offen offset:2048 lds
  s_waitcnt vmcnt(0) lgkmcnt(0)
  s_barrier
L_k1_main:
  s_add_u32 s36, s4, 0x88c000
  s_addc_u32 s37, s5, 0
  s_mov_b32 s38, 0xa00000
  s_mov_b32 s39, 0x00020000
  s_mul_i32 s28, s23, 655360
  s_mul_i32 s29, s24, 41984
  s_add_u32 s28, s28, s29
  buffer_load_dwordx4 a[0:3], v3, s[36:39], s28 offen offset:0 sc1
  buffer_load_dwordx4 a[4:7], v3, s[36:39], s28 offen offset:1024 sc1
  buffer_load_dwordx4 a[8:11], v3, s[36:39], s28 offen offset:2048 sc1
  buffer_load_dwordx4 a[12:15], v3, s[36:39], s28 offen offset:3072 sc1
  s_add_u32 s28, s28, 4096
  buffer_load_dwordx4 a[16:19], v3, s[36:39], s28 offen offset:0 sc1
  buffer_load_dwordx4 a[20:23], v3, s[36:39], s28 offen offset:1024 sc1
  v_and_b32 v4, 31, v2
  v_min_u32 v4, 23, v4
  v_lshrrev_b32 v5, 5, v2
  v_mul_u32_u24 v5, 24, v5
  v_add_u32 v4, v4, v5
  v_lshlrev_b32 v4, 4, v4
  v_add_u32 v4, 122880, v4
  v_mov_b32 v5, v3
  ds_read_b128 v[128:131], v5 offset:0
  ds_read_b128 v[132:135], v5 offset:1024
  ds_read_b128 v[136:139], v5 offset:2048
  s_waitcnt vmcnt(5) lgkmcnt(2)
  v_mfma_f32_32x32x16_bf16 v[64:79], v[128:131], a[0:3], 0
  ds_read_b128 v[144:147], v5 offset:3072
  s_waitcnt lgkmcnt(2)
  v_mfma_f32_32x32x16_bf16 v[80:95], v[132:135], a[0:3], 0
  ds_read_b128 v[148:151], v5 offset:4096
  buffer_load_dwordx4 a[24:27], v3, s[36:39], s28 offen offset:2048 sc1
  s_waitcnt lgkmcnt(2)
  v_mfma_f32_32x32x16_bf16 v[96:111], v[136:139], a[0:3], 0
  ds_read_b128 v[152:155], v5 offset:5120
  s_waitcnt vmcnt(5) lgkmcnt(2)
  v_mfma_f32_32x32x16_bf16 v[64:79], v[144:147], a[4:7], v[64:79]
  ds_read_b128 v[128:131], v5 offset:6144
  s_waitcnt lgkmcnt(2)
  v_mfma_f32_32x32x16_bf16 v[80:95], v[148:151], a[4:7], v[80:95]
  ds_read_b128 v[132:135], v5 offset:7168
  buffer_load_dwordx4 a[28:31], v3, s[36:39], s28 offen offset:3072 sc1
  s_waitcnt lgkmcnt(2)
  v_mfma_f32_32x32x16_bf16 v[96:111], v[152:155], a[4:7], v[96:111]
  ds_read_b128 v[136:139], v5 offset:8192
  s_waitcnt vmcnt(5) lgkmcnt(2)
  v_mfma_f32_32x32x16_bf16 v[64:79], v[128:131], a[8:11], v[64:79]
  ds_read_b128 v[144:147], v5 offset:9216
  s_waitcnt lgkmcnt(2)
  v_mfma_f32_32x32x16_bf16 v[80:95], v[132:135], a[8:11], v[80:95]
  ds_read_b128 v[148:151], v5 offset:10240
  s_add_u32 s28, s28, 4096
  buffer_load_dwordx4 a[32:35], v3, s[36:39], s28 offen offset:0 sc1
  s_waitcnt lgkmcnt(2)
  v_mfma_f32_32x32x16_bf16 v[96:111], v[136:139], a[8:11], v[96:111]
  ds_read_b128 v[152:155], v5 offset:11264
  s_waitcnt vmcnt(5) lgkmcnt(2)
  v_mfma_f32_32x32x16_bf16 v[64:79], v[144:147], a[12:15], v[64:79]
  ds_read_b128 v[128:131], v5 offset:12288
  s_waitcnt lgkmcnt(2)
  v_mfma_f32_32x32x16_bf16 v[80:95], v[148:151], a[12:15], v[80:95]
  ds_read_b128 v[132:135], v5 offset:13312
  buffer_load_dwordx4 a[36:39], v3, s[36:39], s28 offen offset:1024 sc1
  s_waitcnt lgkmcnt(2)
  v_mfma_f32_32x32x16_bf16 v[96:111], v[152:155], a[12:15], v[96:111]
  ds_read_b128 v[136:139], v5 offset:14336
  s_waitcnt vmcnt(5) lgkmcnt(2)
  v_mfma_f32_32x32x16_bf16 v[64:79], v[128:131], a[16:19], v[64:79]
  ds_read_b128 v[144:147], v5 offset:15360
  s_waitcnt lgkmcnt(2)
  v_mfma_f32_32x32x16_bf16 v[80:95], v[132:135], a[16:19], v[80:95]
  ds_read_b128 v[148:151], v5 offset:16384
  buffer_load_dwordx4 a[40:43], v3, s[36:39], s28 offen offset:2048 sc1
  s_waitcnt lgkmcnt(2)
  v_mfma_f32_32x32x16_bf16 v[96:111], v[136:139], a[16:19], v[96:111]
  ds_read_b128 v[152:155], v5 offset:17408
  s_waitcnt vmcnt(5) lgkmcnt(2)
  v_mfma_f32_32x32x16_bf16 v[64:79], v[144:147], a[20:23], v[64:79]
  ds_read_b128 v[128:131], v5 offset:18432
  s_waitcnt lgkmcnt(2)
  v_mfma_f32_32x32x16_bf16 v[80:95], v[148:151], a[20:23], v[80:95]
  ds_read_b128 v[132:135], v5 offset:19456
  buffer_load_dwordx4 a[44:47], v3, s[36:39], s28 offen offset:3072 sc1
  s_waitcnt lgkmcnt(2)
  v_mfma_f32_32x32x16_bf16 v[96:111], v[152:155], a[20:23], v[96:111]
  ds_read_b128 v[136:139], v5 offset:20480
  s_waitcnt vmcnt(5) lgkmcnt(2)
  v_mfma_f32_32x32x16_bf16 v[64:79], v[128:131], a[24:27], v[64:79]
  ds_read_b128 v[144:147], v5 offset:21504
  s_waitcnt lgkmcnt(2)
  v_mfma_f32_32x32x16_bf16 v[80:95], v[132:135], a[24:27], v[80:95]
  ds_read_b128 v[148:151], v5 offset:22528
  s_add_u32 s28, s28, 4096
  buffer_load_dwordx4 a[48:51], v3, s[36:39], s28 offen offset:0 sc1
  s_waitcnt lgkmcnt(2)
  v_mfma_f32_32x32x16_bf16 v[96:111], v[136:139], a[24:27], v[96:111]
  ds_read_b128 v[152:155], v5 offset:23552
  s_waitcnt vmcnt(5) lgkmcnt(2)
  v_mfma_f32_32x32x16_bf16 v[64:79], v[144:147], a[28:31], v[64:79]
  ds_read_b128 v[128:131], v5 offset:24576
  s_waitcnt lgkmcnt(2)
  v_mfma_f32_32x32x16_bf16 v[80:95], v[148:151], a[28:31], v[80:95]
  ds_read_b128 v[132:135], v5 offset:25600
  buffer_load_dwordx4 a[52:55], v3, s[36:39], s28 offen offset:1024 sc1
  s_waitcnt lgkmcnt(2)
  v_mfma_f32_32x32x16_bf16 v[96:111], v[152:155], a[28:31], v[96:111]
  ds_read_b128 v[136:139], v5 offset:26624
  s_waitcnt vmcnt(5) lgkmcnt(2)
  v_mfma_f32_32x32x16_bf16 v[64:79], v[128:131], a[32:35], v[64:79]
  ds_read_b128 v[144:147], v5 offset:27648
  s_waitcnt lgkmcnt(2)
  v_mfma_f32_32x32x16_bf16 v[80:95], v[132:135], a[32:35], v[80:95]
  ds_read_b128 v[148:151], v5 offset:28672
  buffer_load_dwordx4 a[56:59], v3, s[36:39], s28 offen offset:2048 sc1
  s_waitcnt lgkmcnt(2)
  v_mfma_f32_32x32x16_bf16 v[96:111], v[136:139], a[32:35], v[96:111]
  ds_read_b128 v[152:155], v5 offset:29696
  s_waitcnt vmcnt(5) lgkmcnt(2)
  v_mfma_f32_32x32x16_bf16 v[64:79], v[144:147], a[36:39], v[64:79]
  ds_read_b128 v[128:131], v5 offset:30720
  s_waitcnt lgkmcnt(2)
  v_mfma_f32_32x32x16_bf16 v[80:95], v[148:151], a[36:39], v[80:95]
  ds_read_b128 v[132:135], v5 offset:31744
  buffer_load_dwordx4 a[60:63], v3, s[36:39], s28 offen offset:3072 sc1
  s_waitcnt lgkmcnt(2)
  v_mfma_f32_32x32x16_bf16 v[96:111], v[152:155], a[36:39], v[96:111]
  ds_read_b128 v[136:139], v5 offset:32768
  s_waitcnt vmcnt(5) lgkmcnt(2)
  v_mfma_f32_32x32x16_bf16 v[64:79], v[128:131], a[40:43], v[64:79]
  ds_read_b128 v[144:147], v5 offset:33792
  s_waitcnt lgkmcnt(2)
  v_mfma_f32_32x32x16_bf16 v[80:95], v[132:135], a[40:43], v[80:95]
  ds_read_b128 v[148:151], v5 offset:34816
  s_add_u32 s28, s28, 4096
  buffer_load_dwordx4 a[64:67], v3, s[36:39], s28 offen offset:0 sc1
  s_waitcnt lgkmcnt(2)
  v_mfma_f32_32x32x16_bf16 v[96:111], v[136:139], a[40:43], v[96:111]
  ds_read_b128 v[152:155], v5 offset:35840
  s_waitcnt vmcnt(5) lgkmcnt(2)
  v_mfma_f32_32x32x16_bf16 v[64:79], v[144:147], a[44:47], v[64:79]
  ds_read_b128 v[128:131], v5 offset:36864
  s_waitcnt lgkmcnt(2)
  v_mfma_f32_32x32x16_bf16 v[80:95], v[148:151], a[44:47], v[80:95]
  ds_read_b128 v[132:135], v5 offset:37888
  buffer_load_dwordx4 a[68:71], v3, s[36:39], s28 offen offset:1024 sc1
  s_waitcnt lgkmcnt(2)
  v_mfma_f32_32x32x16_bf16 v[96:111], v[152:155], a[44:47], v[96:111]
  ds_read_b128 v[136:139], v5 offset:38912
  s_waitcnt vmcnt(5) lgkmcnt(2)
  v_mfma_f32_32x32x16_bf16 v[64:79], v[128:131], a[48:51], v[64:79]
  ds_read_b128 v[144:147], v5 offset:39936
  s_waitcnt lgkmcnt(2)
  v_mfma_f32_32x32x16_bf16 v[80:95], v[132:135], a[48:51], v[80:95]
  ds_read_b128 v[148:151], v5 offset:40960
  buffer_load_dwordx4 a[72:75], v3, s[36:39], s28 offen offset:2048 sc1
  s_waitcnt lgkmcnt(2)
  v_mfma_f32_32x32x16_bf16 v[96:111], v[136:139], a[48:51], v[96:111]
  ds_read_b128 v[152:155], v5 offset:41984
  s_waitcnt vmcnt(5) lgkmcnt(2)
  v_mfma_f32_32x32x16_bf16 v[64:79], v[144:147], a[52:55], v[64:79]
  ds_read_b128 v[128:131], v5 offset:43008
  s_waitcnt lgkmcnt(2)
  v_mfma_f32_32x32x16_bf16 v[80:95], v[148:151], a[52:55], v[80:95]
  ds_read_b128 v[132:135], v5 offset:44032
  buffer_load_dwordx4 a[76:79], v3, s[36:39], s28 offen offset:3072 sc1
  s_waitcnt lgkmcnt(2)
  v_mfma_f32_32x32x16_bf16 v[96:111], v[152:155], a[52:55], v[96:111]
  ds_read_b128 v[136:139], v5 offset:45056
  s_waitcnt vmcnt(5) lgkmcnt(2)
  v_mfma_f32_32x32x16_bf16 v[64:79], v[128:131], a[56:59], v[64:79]
  ds_read_b128 v[144:147], v5 offset:46080
  s_waitcnt lgkmcnt(2)
  v_mfma_f32_32x32x16_bf16 v[80:95], v[132:135], a[56:59], v[80:95]
  ds_read_b128 v[148:151], v5 offset:47104
  s_add_u32 s28, s28, 4096
  buffer_load_dwordx4 a[80:83], v3, s[36:39], s28 offen offset:0 sc1
  s_waitcnt lgkmcnt(2)
  v_mfma_f32_32x32x16_bf16 v[96:111], v[136:139], a[56:59], v[96:111]
  ds_read_b128 v[152:155], v5 offset:48128
  s_waitcnt vmcnt(5) lgkmcnt(2)
  v_mfma_f32_32x32x16_bf16 v[64:79], v[144:147], a[60:63], v[64:79]
  ds_read_b128 v[128:131], v5 offset:49152
  s_waitcnt lgkmcnt(2)
  v_mfma_f32_32x32x16_bf16 v[80:95], v[148:151], a[60:63], v[80:95]
  ds_read_b128 v[132:135], v5 offset:50176
  buffer_load_dwordx4 a[84:87], v3, s[36:39], s28 offen offset:1024 sc1
  s_waitcnt lgkmcnt(2)
  v_mfma_f32_32x32x16_bf16 v[96:111], v[152:155], a[60:63], v[96:111]
  ds_read_b128 v[136:139], v5 offset:51200
  s_waitcnt vmcnt(5) lgkmcnt(2)
  v_mfma_f32_32x32x16_bf16 v[64:79], v[128:131], a[64:67], v[64:79]
  ds_read_b128 v[144:147], v5 offset:52224
  s_waitcnt lgkmcnt(2)
  v_mfma_f32_32x32x16_bf16 v[80:95], v[132:135], a[64:67], v[80:95]
  ds_read_b128 v[148:151], v5 offset:53248
  buffer_load_dwordx4 a[88:91], v3, s[36:39], s28 offen offset:2048 sc1
  s_waitcnt lgkmcnt(2)
  v_mfma_f32_32x32x16_bf16 v[96:111], v[136:139], a[64:67], v[96:111]
  ds_read_b128 v[152:155], v5 offset:54272
  s_waitcnt vmcnt(5) lgkmcnt(2)
  v_mfma_f32_32x32x16_bf16 v[64:79], v[144:147], a[68:71], v[64:79]
  ds_read_b128 v[128:131], v5 offset:55296
  s_waitcnt lgkmcnt(2)
  v_mfma_f32_32x32x16_bf16 v[80:95], v[148:151], a[68:71], v[80:95]
  ds_read_b128 v[132:135], v5 offset:56320
  buffer_load_dwordx4 a[92:95], v3, s[36:39], s28 offen offset:3072 sc1
  s_waitcnt lgkmcnt(2)
  v_mfma_f32_32x32x16_bf16 v[96:111], v[152:155], a[68:71], v[96:111]
  ds_read_b128 v[136:139], v5 offset:57344
  s_waitcnt vmcnt(5) lgkmcnt(2)
  v_mfma_f32_32x32x16_bf16 v[64:79], v[128:131], a[72:75], v[64:79]
  ds_read_b128 v[144:147], v5 offset:58368
  s_waitcnt lgkmcnt(2)
  v_mfma_f32_32x32x16_bf16 v[80:95], v[132:135], a[72:75], v[80:95]
  ds_read_b128 v[148:151], v5 offset:59392
  s_add_u32 s28, s28, 4096
  buffer_load_dwordx4 a[96:99], v3, s[36:39], s28 offen offset:0 sc1
  s_waitcnt lgkmcnt(2)
  v_mfma_f32_32x32x16_bf16 v[96:111], v[136:139], a[72:75], v[96:111]
  ds_read_b128 v[152:155], v5 offset:60416
  s_waitcnt vmcnt(5) lgkmcnt(2)
  v_mfma_f32_32x32x16_bf16 v[64:79], v[144:147], a[76:79], v[64:79]
  v_add_u32 v5, 61440, v5
  ds_read_b128 v[128:131], v5 offset:0
  s_waitcnt lgkmcnt(2)
  v_mfma_f32_32x32x16_bf16 v[80:95], v[148:151], a[76:79], v[80:95]
  ds_read_b128 v[132:135], v5 offset:1024
  buffer_load_dwordx4 a[100:103], v3, s[36:39], s28 offen offset:1024 sc1
  s_waitcnt lgkmcnt(2)
  v_mfma_f32_32x32x16_bf16 v[96:111], v[152:155], a[76:79], v[96:111]
  ds_read_b128 v[136:139], v5 offset:2048
  s_waitcnt vmcnt(5) lgkmcnt(2)
  v_mfma_f32_32x32x16_bf16 v[64:79], v[128:131], a[80:83], v[64:79]
  ds_read_b128 v[144:147], v5 offset:3072
  s_waitcnt lgkmcnt(2)
  v_mfma_f32_32x32x16_bf16 v[80:95], v[132:135], a[80:83], v[80:95]
  ds_read_b128 v[148:151], v5 offset:4096
  buffer_load_dwordx4 a[104:107], v3, s[36:39], s28 offen offset:2048 sc1
  s_waitcnt lgkmcnt(2)
  v_mfma_f32_32x32x16_bf16 v[96:111], v[136:139], a[80:83], v[96:111]
  ds_read_b128 v[152:155], v5 offset:5120
  s_waitcnt vmcnt(5) lgkmcnt(2)
  v_mfma_f32_32x32x16_bf16 v[64:79], v[144:147], a[84:87], v[64:79]
  ds_read_b128 v[128:131], v5 offset:6144
  s_waitcnt lgkmcnt(2)
  v_mfma_f32_32x32x16_bf16 v[80:95], v[148:151], a[84:87], v[80:95]
  ds_read_b128 v[132:135], v5 offset:7168
  buffer_load_dwordx4 a[108:111], v3, s[36:39], s28 offen offset:3072 sc1
  s_waitcnt lgkmcnt(2)
  v_mfma_f32_32x32x16_bf16 v[96:111], v[152:155], a[84:87], v[96:111]
  ds_read_b128 v[136:139], v5 offset:8192
  s_waitcnt vmcnt(5) lgkmcnt(2)
  v_mfma_f32_32x32x16_bf16 v[64:79], v[128:131], a[88:91], v[64:79]
  ds_read_b128 v[144:147], v5 offset:9216
  s_waitcnt lgkmcnt(2)
  v_mfma_f32_32x32x16_bf16 v[80:95], v[132:135], a[88:91], v[80:95]
  ds_read_b128 v[148:151], v5 offset:10240
  s_add_u32 s28, s28, 4096
  buffer_load_dwordx4 a[112:115], v3, s[36:39], s28 offen offset:0 sc1
  s_waitcnt lgkmcnt(2)
  v_mfma_f32_32x32x16_bf16 v[96:111], v[136:139], a[88:91], v[96:111]
  ds_read_b128 v[152:155], v5 offset:11264
  s_waitcnt vmcnt(5) lgkmcnt(2)
  v_mfma_f32_32x32x16_bf16 v[64:79], v[144:147], a[92:95], v[64:79]
  ds_read_b128 v[128:131], v5 offset:12288
  s_waitcnt lgkmcnt(2)
  v_mfma_f32_32x32x16_bf16 v[80:95], v[148:151], a[92:95], v[80:95]
  ds_read_b128 v[132:135], v5 offset:13312
  buffer_load_dwordx4 a[116:119], v3, s[36:39], s28 offen offset:1024 sc1
  s_waitcnt lgkmcnt(2)
  v_mfma_f32_32x32x16_bf16 v[96:111], v[152:155], a[92:95], v[96:111]
  ds_read_b128 v[136:139], v5 offset:14336
  s_waitcnt vmcnt(5) lgkmcnt(2)
  v_mfma_f32_32x32x16_bf16 v[64:79], v[128:131], a[96:99], v[64:79]
  ds_read_b128 v[144:147], v5 offset:15360
  s_waitcnt lgkmcnt(2)
  v_mfma_f32_32x32x16_bf16 v[80:95], v[132:135], a[96:99], v[80:95]
  ds_read_b128 v[148:151], v5 offset:16384
  buffer_load_dwordx4 a[120:123], v3, s[36:39], s28 offen offset:2048 sc1
  s_waitcnt lgkmcnt(2)
  v_mfma_f32_32x32x16_bf16 v[96:111], v[136:139], a[96:99], v[96:111]
  ds_read_b128 v[152:155], v5 offset:17408
  s_waitcnt vmcnt(5) lgkmcnt(2)
  v_mfma_f32_32x32x16_bf16 v[64:79], v[144:147], a[100:103], v[64:79]
  ds_read_b128 v[128:131], v5 offset:18432
  s_waitcnt lgkmcnt(2)
  v_mfma_f32_32x32x16_bf16 v[80:95], v[148:151], a[100:103], v[80:95]
  ds_read_b128 v[132:135], v5 offset:19456
  buffer_load_dwordx4 a[124:127], v3, s[36:39], s28 offen offset:3072 sc1
  s_waitcnt lgkmcnt(2)
  v_mfma_f32_32x32x16_bf16 v[96:111], v[152:155], a[100:103], v[96:111]
  ds_read_b128 v[136:139], v5 offset:20480
  s_waitcnt vmcnt(5) lgkmcnt(2)
  v_mfma_f32_32x32x16_bf16 v[64:79], v[128:131], a[104:107], v[64:79]
  ds_read_b128 v[144:147], v5 offset:21504
  s_waitcnt lgkmcnt(2)
  v_mfma_f32_32x32x16_bf16 v[80:95], v[132:135], a[104:107], v[80:95]
  ds_read_b128 v[148:151], v5 offset:22528
  s_add_u32 s28, s28, 4096
  buffer_load_dwordx4 a[128:131], v3, s[36:39], s28 offen offset:0 sc1
  s_waitcnt lgkmcnt(2)
  v_mfma_f32_32x32x16_bf16 v[96:111], v[136:139], a[104:107], v[96:111]
  ds_read_b128 v[152:155], v5 offset:23552
  s_waitcnt vmcnt(5) lgkmcnt(2)
  v_mfma_f32_32x32x16_bf16 v[64:79], v[144:147], a[108:111], v[64:79]
  ds_read_b128 v[128:131], v5 offset:24576
  s_waitcnt lgkmcnt(2)
  v_mfma_f32_32x32x16_bf16 v[80:95], v[148:151], a[108:111], v[80:95]
  ds_read_b128 v[132:135], v5 offset:25600
  buffer_load_dwordx4 a[132:135], v3, s[36:39], s28 offen offset:1024 sc1
  s_waitcnt lgkmcnt(2)
  v_mfma_f32_32x32x16_bf16 v[96:111], v[152:155], a[108:111], v[96:111]
  ds_read_b128 v[136:139], v5 offset:26624
  s_waitcnt vmcnt(5) lgkmcnt(2)
  v_mfma_f32_32x32x16_bf16 v[64:79], v[128:131], a[112:115], v[64:79]
  ds_read_b128 v[144:147], v5 offset:27648
  s_waitcnt lgkmcnt(2)
  v_mfma_f32_32x32x16_bf16 v[80:95], v[132:135], a[112:115], v[80:95]
  ds_read_b128 v[148:151], v5 offset:28672
  buffer_load_dwordx4 a[136:139], v3, s[36:39], s28 offen offset:2048 sc1
  s_waitcnt lgkmcnt(2)
  v_mfma_f32_32x32x16_bf16 v[96:111], v[136:139], a[112:115], v[96:111]
  ds_read_b128 v[152:155], v5 offset:29696
  s_waitcnt vmcnt(5) lgkmcnt(2)
  v_mfma_f32_32x32x16_bf16 v[64:79], v[144:147], a[116:119], v[64:79]
  ds_read_b128 v[128:131], v5 offset:30720
  s_waitcnt lgkmcnt(2)
  v_mfma_f32_32x32x16_bf16 v[80:95], v[148:151], a[116:119], v[80:95]
  ds_read_b128 v[132:135], v5 offset:31744
  buffer_load_dwordx4 a[140:143], v3, s[36:39], s28 offen offset:3072 sc1
  s_waitcnt lgkmcnt(2)
  v_mfma_f32_32x32x16_bf16 v[96:111], v[152:155], a[116:119], v[96:111]
  ds_read_b128 v[136:139], v5 offset:32768
  s_waitcnt vmcnt(5) lgkmcnt(2)
  v_mfma_f32_32x32x16_bf16 v[64:79], v[128:131], a[120:123], v[64:79]
  ds_read_b128 v[144:147], v5 offset:33792
  s_waitcnt lgkmcnt(2)
  v_mfma_f32_32x32x16_bf16 v[80:95], v[132:135], a[120:123], v[80:95]
  ds_read_b128 v[148:151], v5 offset:34816
  s_add_u32 s28, s28, 4096
  buffer_load_dwordx4 a[144:147], v3, s[36:39], s28 offen offset:0 sc1
  s_waitcnt lgkmcnt(2)
  v_mfma_f32_32x32x16_bf16 v[96:111], v[136:139], a[120:123], v[96:111]
  ds_read_b128 v[152:155], v5 offset:35840
  s_waitcnt vmcnt(5) lgkmcnt(2)
  v_mfma_f32_32x32x16_bf16 v[64:79], v[144:147], a[124:127], v[64:79]
  ds_read_b128 v[128:131], v5 offset:36864
  s_waitcnt lgkmcnt(2)
  v_mfma_f32_32x32x16_bf16 v[80:95], v[148:151], a[124:127], v[80:95]
  ds_read_b128 v[132:135], v5 offset:37888
  buffer_load_dwordx4 a[148:151], v3, s[36:39], s28 offen offset:1024 sc1
  s_waitcnt lgkmcnt(2)
  v_mfma_f32_32x32x16_bf16 v[96:111], v[152:155], a[124:127], v[96:111]
  ds_read_b128 v[136:139], v5 offset:38912
  s_waitcnt vmcnt(5) lgkmcnt(2)
  v_mfma_f32_32x32x16_bf16 v[64:79], v[128:131], a[128:131], v[64:79]
  ds_read_b128 v[144:147], v5 offset:39936
  s_waitcnt lgkmcnt(2)
  v_mfma_f32_32x32x16_bf16 v[80:95], v[132:135], a[128:131], v[80:95]
  ds_read_b128 v[148:151], v5 offset:40960
  buffer_load_dwordx4 a[152:155], v3, s[36:39], s28 offen offset:2048 sc1
  s_waitcnt lgkmcnt(2)
  v_mfma_f32_32x32x16_bf16 v[96:111], v[136:139], a[128:131], v[96:111]
  ds_read_b128 v[152:155], v5 offset:41984
  s_waitcnt vmcnt(5) lgkmcnt(2)
  v_mfma_f32_32x32x16_bf16 v[64:79], v[144:147], a[132:135], v[64:79]
  ds_read_b128 v[128:131], v5 offset:43008
  s_waitcnt lgkmcnt(2)
  v_mfma_f32_32x32x16_bf16 v[80:95], v[148:151], a[132:135], v[80:95]
  ds_read_b128 v[132:135], v5 offset:44032
  buffer_load_dwordx4 a[156:159], v3, s[36:39], s28 offen offset:3072 sc1
  s_waitcnt lgkmcnt(2)
  v_mfma_f32_32x32x16_bf16 v[96:111], v[152:155], a[132:135], v[96:111]
  ds_read_b128 v[136:139], v5 offset:45056
  s_waitcnt vmcnt(5) lgkmcnt(2)
  v_mfma_f32_32x32x16_bf16 v[64:79], v[128:131], a[136:139], v[64:79]
  ds_read_b128 v[144:147], v5 offset:46080
  s_waitcnt lgkmcnt(2)
  v_mfma_f32_32x32x16_bf16 v[80:95], v[132:135], a[136:139], v[80:95]
  ds_read_b128 v[148:151], v5 offset:47104
  s_waitcnt lgkmcnt(2)
  v_mfma_f32_32x32x16_bf16 v[96:111], v[136:139], a[136:139], v[96:111]
  ds_read_b128 v[152:155], v5 offset:48128
  s_waitcnt vmcnt(4) lgkmcnt(2)
  v_mfma_f32_32x32x16_bf16 v[64:79], v[144:147], a[140:143], v[64:79]
  ds_read_b128 v[128:131], v5 offset:49152
  s_waitcnt lgkmcnt(2)
  v_mfma_f32_32x32x16_bf16 v[80:95], v[148:151], a[140:143], v[80:95]
  ds_read_b128 v[132:135], v5 offset:50176
  s_waitcnt lgkmcnt(2)
  v_mfma_f32_32x32x16_bf16 v[96:111], v[152:155], a[140:143], v[96:111]
  ds_read_b128 v[136:139], v5 offset:51200
  s_waitcnt vmcnt(3) lgkmcnt(2)
  v_mfma_f32_32x32x16_bf16 v[64:79], v[128:131], a[144:147], v[64:79]
  ds_read_b128 v[144:147], v5 offset:52224
  s_waitcnt lgkmcnt(2)
  v_mfma_f32_32x32x16_bf16 v[80:95], v[132:135], a[144:147], v[80:95]
  ds_read_b128 v[148:151], v5 offset:53248
  s_waitcnt lgkmcnt(2)
  v_mfma_f32_32x32x16_bf16 v[96:111], v[136:139], a[144:147], v[96:111]
  ds_read_b128 v[152:155], v5 offset:54272
  s_waitcnt vmcnt(2) lgkmcnt(2)
  v_mfma_f32_32x32x16_bf16 v[64:79], v[144:147], a[148:151], v[64:79]
  ds_read_b128 v[128:131], v5 offset:55296
  s_waitcnt lgkmcnt(2)
  v_mfma_f32_32x32x16_bf16 v[80:95], v[148:151], a[148:151], v[80:95]
  ds_read_b128 v[132:135], v5 offset:56320
  s_waitcnt lgkmcnt(2)
  v_mfma_f32_32x32x16_bf16 v[96:111], v[152:155], a[148:151], v[96:111]
  ds_read_b128 v[136:139], v5 offset:57344
  s_waitcnt vmcnt(1) lgkmcnt(2)
  v_mfma_f32_32x32x16_bf16 v[64:79], v[128:131], a[152:155], v[64:79]
  ds_read_b128 v[144:147], v5 offset:58368
  s_waitcnt lgkmcnt(2)
  v_mfma_f32_32x32x16_bf16 v[80:95], v[132:135], a[152:155], v[80:95]
  ds_read_b128 v[148:151], v5 offset:59392
  s_waitcnt lgkmcnt(2)
  v_mfma_f32_32x32x16_bf16 v[96:111], v[136:139], a[152:155], v[96:111]
  ds_read_b128 v[152:155], v5 offset:60416
  s_waitcnt vmcnt(0) lgkmcnt(2)
  v_mfma_f32_32x32x16_bf16 v[64:79], v[144:147], a[156:159], v[64:79]
  s_waitcnt lgkmcnt(1)
  v_mfma_f32_32x32x16_bf16 v[80:95], v[148:151], a[156:159], v[80:95]
  s_waitcnt lgkmcnt(0)
  v_mfma_f32_32x32x16_bf16 v[96:111], v[152:155], a[156:159], v[96:111]
  s_lshr_b32 s44, s2, 3
  s_lshl_b32 s45, s24, 5
  s_add_u32 s44, s44, s45
  s_getpc_b64 s[46:47]
L_pc_k2_4:
  s_add_u32 s46, s46, tail_kernel-L_pc_k2_4
  s_addc_u32 s47, s47, (tail_kernel-L_pc_k2_4)>>32
  s_lshl_b32 s48, s44, 10
  v_add_u32 v248, s48, v3
  v_min_u32 v248, L_code_end-tail_kernel-16, v248
  global_load_dwordx4 v[248:251], v248, s[46:47]
  s_mul_i32 s49, s23, 655360
  s_and_b32 s44, s22, 7
  s_mul_i32 s44, s44, 20480
  s_add_u32 s49, s49, s44
  s_cmp_lt_u32 s22, 8
  s_mov_b32 s44, 172032
  s_cselect_b32 s44, 483328, s44
  s_add_u32 s49, s49, s44
  s_mul_i32 s44, s24, 5120
  s_add_u32 s49, s49, s44
  v_min_u32 v252, 39, v2
  v_lshlrev_b32 v252, 7, v252
  buffer_load_dword v253, v252, s[36:39], s49 offen
  s_mul_i32 s44, s23, 655360
  s_mul_i32 s45, s22, 9216
  s_add_u32 s44, s44, s45
  s_mul_i32 s45, s24, 2304
  s_add_u32 s44, s44, s45
  s_add_u32 s44, s44, 335872
  v_min_u32 v252, 17, v2
  v_lshlrev_b32 v252, 7, v252
  buffer_load_dword v253, v252, s[36:39], s44 offen
  s_add_u32 s52, s4, 0x268000
  s_addc_u32 s53, s5, 0
  s_mov_b32 s54, 0xc8000
  s_mov_b32 s55, 0x00020000
  s_and_b32 s44, s22, 7
  s_mul_i32 s44, s44, 102400
  s_lshr_b32 s45, s22, 3
  s_lshl_b32 s50, s21, 1
  s_add_u32 s45, s45, s50
  s_mul_i32 s45, s45, 25600
  s_add_u32 s44, s44, s45
  s_mul_i32 s45, s24, 6400
  s_add_u32 s50, s44, s45
  s_add_u32 s56, s4, 0x330000
  s_addc_u32 s57, s5, 0
  s_mov_b32 s58, 0x21c000
  s_mov_b32 s59, 0x00020000
  s_lshr_b32 s44, s22, 2
  s_mul_i32 s44, s44, 27
  s_and_b32 s45, s22, 3
  s_mul_i32 s45, s45, 7
  s_add_u32 s44, s44, s45
  s_mul_i32 s44, s44, 20480
  s_mul_i32 s45, s21, 71680
  s_add_u32 s44, s44, s45
  s_mul_i32 s45, s24, 17920
  s_add_u32 s51, s44, s45
  ds_read_b128 v[128:131], v4 offset:0
  ds_read_b128 v[132:135], v4 offset:768
  ds_read_b128 v[136:139], v4 offset:1536
  s_barrier
  s_nop 3
  ds_read_b128 v[140:143], v4 offset:2304
  s_waitcnt lgkmcnt(3)
  v_mfma_f32_32x32x16_bf16 v[112:127], v[128:131], a[0:3], 0
  v_max3_f32 v24, v64, v65, v66
  v_min3_f32 v26, v64, v65, v66
  v_max3_f32 v24, v24, v67, v68
  v_min3_f32 v26, v26, v67, v68
  ds_read_b128 v[128:131], v4 offset:3072
  s_waitcnt lgkmcnt(3)
  v_mfma_f32_32x32x16_bf16 v[112:127], v[132:135], a[4:7], v[112:127]
  v_max3_f32 v24, v24, v69, v70
  v_min3_f32 v26, v26, v69, v70
  v_max3_f32 v24, v24, v71, v72
  v_min3_f32 v26, v26, v71, v72
  ds_read_b128 v[132:135], v4 offset:3840
  s_waitcnt lgkmcnt(3)
  v_mfma_f32_32x32x16_bf16 v[112:127], v[136:139], a[8:11], v[112:127]
  buffer_load_dwordx4 v[252:255], v3, s[52:55], s50 offen offset:0
  v_max3_f32 v24, v24, v73, v74
  v_min3_f32 v26, v26, v73, v74
  v_max3_f32 v24, v24, v75, v76
  ds_read_b128 v[136:139], v4 offset:4608
  s_waitcnt lgkmcnt(3)
  v_mfma_f32_32x32x16_bf16 v[112:127], v[140:143], a[12:15], v[112:127]
  v_min3_f32 v26, v26, v75, v76
  v_max3_f32 v24, v24, v77, v78
  v_min3_f32 v26, v26, v77, v78
  v_max3_f32 v24, v24, v79, v80
  ds_read_b128 v[140:143], v4 offset:5376
  s_waitcnt lgkmcnt(3)
  v_mfma_f32_32x32x16_bf16 v[112:127], v[128:131], a[16:19], v[112:127]
  v_min3_f32 v26, v26, v79, v80
  v_max3_f32 v24, v24, v81, v82
  v_min3_f32 v26, v26, v81, v82
  v_max_f32 v24, v24, v83
  ds_read_b128 v[128:131], v4 offset:6144
  s_waitcnt lgkmcnt(3)
  v_mfma_f32_32x32x16_bf16 v[112:127], v[132:135], a[20:23], v[112:127]
  buffer_load_dwordx4 v[252:255], v3, s[52:55], s50 offen offset:1024
  v_min_f32 v26, v26, v83
  v_pk_add_f32 v[160:161], v[64:65], v[24:25] op_sel_hi:[1,0] neg_lo:[0,1] neg_hi:[0,1]
  v_pk_add_f32 v[180:181], v[64:65], v[26:27] op_sel_hi:[1,0] neg_lo:[1,0] neg_hi:[1,0]
  ds_read_b128 v[132:135], v4 offset:6912
  s_waitcnt lgkmcnt(3)
  v_mfma_f32_32x32x16_bf16 v[112:127], v[136:139], a[24:27], v[112:127]
  v_pk_add_f32 v[162:163], v[66:67], v[24:25] op_sel_hi:[1,0] neg_lo:[0,1] neg_hi:[0,1]
  v_pk_add_f32 v[182:183], v[66:67], v[26:27] op_sel_hi:[1,0] neg_lo:[1,0] neg_hi:[1,0]
  v_pk_add_f32 v[164:165], v[68:69], v[24:25] op_sel_hi:[1,0] neg_lo:[0,1] neg_hi:[0,1]
  v_pk_add_f32 v[184:185], v[68:69], v[26:27] op_sel_hi:[1,0] neg_lo:[1,0] neg_hi:[1,0]
  ds_read_b128 v[136:139], v4 offset:7680
  s_waitcnt lgkmcnt(3)
  v_mfma_f32_32x32x16_bf16 v[112:127], v[140:143], a[28:31], v[112:127]
  v_pk_add_f32 v[166:167], v[70:71], v[24:25] op_sel_hi:[1,0] neg_lo:[0,1] neg_hi:[0,1]
  v_pk_add_f32 v[186:187], v[70:71], v[26:27] op_sel_hi:[1,0] neg_lo:[1,0] neg_hi:[1,0]
  v_pk_add_f32 v[168:169], v[72:73], v[24:25] op_sel_hi:[1,0] neg_lo:[0,1] neg_hi:[0,1]
  v_pk_add_f32 v[188:189], v[72:73], v[26:27] op_sel_hi:[1,0] neg_lo:[1,0] neg_hi:[1,0]
  ds_read_b128 v[140:143], v4 offset:8448
  s_waitcnt lgkmcnt(3)
  v_mfma_f32_32x32x16_bf16 v[112:127], v[128:131], a[32:35], v[112:127]
  buffer_load_dwordx4 v[252:255], v3, s[52:55], s50 offen offset:2048
  v_pk_add_f32 v[170:171], v[74:75], v[24:25] op_sel_hi:[1,0] neg_lo:[0,1] neg_hi:[0,1]
  v_pk_add_f32 v[190:191], v[74:75], v[26:27] op_sel_hi:[1,0] neg_lo:[1,0] neg_hi:[1,0]
  v_pk_add_f32 v[172:173], v[76:77], v[24:25] op_sel_hi:[1,0] neg_lo:[0,1] neg_hi:[0,1]
  ds_read_b128 v[128:131], v4 offset:9216
  s_waitcnt lgkmcnt(3)
  v_mfma_f32_32x32x16_bf16 v[112:127], v[132:135], a[36:39], v[112:127]
  v_pk_add_f32 v[192:193], v[76:77], v[26:27] op_sel_hi:[1,0] neg_lo:[1,0] neg_hi:[1,0]
  v_pk_add_f32 v[174:175], v[78:79], v[24:25] op_sel_hi:[1,0] neg_lo:[0,1] neg_hi:[0,1]
  v_pk_add_f32 v[194:195], v[78:79], v[26:27] op_sel_hi:[1,0] neg_lo:[1,0] neg_hi:[1,0]
  v_pk_add_f32 v[176:177], v[80:81], v[24:25] op_sel_hi:[1,0] neg_lo:[0,1] neg_hi:[0,1]
  ds_read_b128 v[132:135], v4 offset:9984
  s_waitcnt lgkmcnt(3)
  v_mfma_f32_32x32x16_bf16 v[112:127], v[136:139], a[40:43], v[112:127]
  v_pk_add_f32 v[196:197], v[80:81], v[26:27] op_sel_hi:[1,0] neg_lo:[1,0] neg_hi:[1,0]
  v_pk_add_f32 v[178:179], v[82:83], v[24:25] op_sel_hi:[1,0] neg_lo:[0,1] neg_hi:[0,1]
  v_pk_add_f32 v[198:199], v[82:83], v[26:27] op_sel_hi:[1,0] neg_lo:[1,0] neg_hi:[1,0]
  v_exp_f32 v160, v160
  ds_read_b128 v[136:139], v4 offset:10752
  s_waitcnt lgkmcnt(3)
  v_mfma_f32_32x32x16_bf16 v[112:127], v[140:143], a[44:47], v[112:127]
  buffer_load_dwordx4 v[252:255], v3, s[52:55], s50 offen offset:3072
  v_exp_f32 v161, v161
  v_exp_f32 v162, v162
  ds_read_b128 v[140:143], v4 offset:11520
  s_waitcnt lgkmcnt(3)
  v_mfma_f32_32x32x16_bf16 v[112:127], v[128:131], a[48:51], v[112:127]
  v_exp_f32 v163, v163
  v_exp_f32 v164, v164
  ds_read_b128 v[128:131], v4 offset:12288
  s_waitcnt lgkmcnt(3)
  v_mfma_f32_32x32x16_bf16 v[112:127], v[132:135], a[52:55], v[112:127]
  v_exp_f32 v165, v165
  v_exp_f32 v166, v166
  ds_read_b128 v[132:135], v4 offset:13056
  s_waitcnt lgkmcnt(3)
  v_mfma_f32_32x32x16_bf16 v[112:127], v[136:139], a[56:59], v[112:127]
  v_exp_f32 v167, v167
  v_exp_f32 v168, v168
  ds_read_b128 v[136:139], v4 offset:13824
  s_waitcnt lgkmcnt(3)
  v_mfma_f32_32x32x16_bf16 v[112:127], v[140:143], a[60:63], v[112:127]
  v_exp_f32 v169, v169
  v_exp_f32 v170, v170
  ds_read_b128 v[140:143], v4 offset:14592
  s_waitcnt lgkmcnt(3)
  v_mfma_f32_32x32x16_bf16 v[112:127], v[128:131], a[64:67], v[112:127]
  v_exp_f32 v171, v171
  s_add_u32 s50, s50, 4096
  v_exp_f32 v172, v172
  ds_read_b128 v[128:131], v4 offset:15360
  s_waitcnt lgkmcnt(3)
  v_mfma_f32_32x32x16_bf16 v[112:127], v[132:135], a[68:71], v[112:127]
  v_exp_f32 v173, v173
  v_exp_f32 v174, v174
  ds_read_b128 v[132:135], v4 offset:16128
  s_waitcnt lgkmcnt(3)
  v_mfma_f32_32x32x16_bf16 v[112:127], v[136:139], a[72:75], v[112:127]
  v_exp_f32 v175, v175
  v_exp_f32 v176, v176
  ds_read_b128 v[136:139], v4 offset:16896
  s_waitcnt lgkmcnt(3)
  v_mfma_f32_32x32x16_bf16 v[112:127], v[140:143], a[76:79], v[112:127]
  v_exp_f32 v177, v177
  v_exp_f32 v178, v178
  ds_read_b128 v[140:143], v4 offset:17664
  s_waitcnt lgkmcnt(3)
  v_mfma_f32_32x32x16_bf16 v[112:127], v[128:131], a[80:83], v[112:127]
  v_exp_f32 v179, v179
  v_exp_f32 v180, v180
  ds_read_b128 v[128:131], v4 offset:18432
  s_waitcnt lgkmcnt(3)
  v_mfma_f32_32x32x16_bf16 v[112:127], v[132:135], a[84:87], v[112:127]
  v_exp_f32 v181, v181
  v_exp_f32 v182, v182
  ds_read_b128 v[132:135], v4 offset:19200
  s_waitcnt lgkmcnt(3)
  v_mfma_f32_32x32x16_bf16 v[112:127], v[136:139], a[88:91], v[112:127]
  buffer_load_dwordx4 v[252:255], v3, s[52:55], s50 offen offset:0
  v_exp_f32 v183, v183
  v_exp_f32 v184, v184
  ds_read_b128 v[136:139], v4 offset:19968
  s_waitcnt lgkmcnt(3)
  v_mfma_f32_32x32x16_bf16 v[112:127], v[140:143], a[92:95], v[112:127]
  v_exp_f32 v185, v185
  v_exp_f32 v186, v186
  ds_read_b128 v[140:143], v4 offset:20736
  s_waitcnt lgkmcnt(3)
  v_mfma_f32_32x32x16_bf16 v[112:127], v[128:131], a[96:99], v[112:127]
  v_exp_f32 v187, v187
  v_exp_f32 v188, v188
  ds_read_b128 v[128:131], v4 offset:21504
  s_waitcnt lgkmcnt(3)
  v_mfma_f32_32x32x16_bf16 v[112:127], v[132:135], a[100:103], v[112:127]
  v_exp_f32 v189, v189
  v_exp_f32 v190, v190
  ds_read_b128 v[132:135], v4 offset:22272
  s_waitcnt lgkmcnt(3)
  v_mfma_f32_32x32x16_bf16 v[112:127], v[136:139], a[104:107], v[112:127]
  v_exp_f32 v191, v191
  v_exp_f32 v192, v192
  ds_read_b128 v[136:139], v4 offset:23040
  s_waitcnt lgkmcnt(3)
  v_mfma_f32_32x32x16_bf16 v[112:127], v[140:143], a[108:111], v[112:127]
  v_exp_f32 v193, v193
  buffer_load_dwordx4 v[252:255], v3, s[52:55], s50 offen offset:1024
  v_exp_f32 v194, v194
  ds_read_b128 v[140:143], v4 offset:23808
  s_waitcnt lgkmcnt(3)
  v_mfma_f32_32x32x16_bf16 v[112:127], v[128:131], a[112:115], v[112:127]
  v_exp_f32 v195, v195
  v_exp_f32 v196, v196
  ds_read_b128 v[128:131], v4 offset:24576
  s_waitcnt lgkmcnt(3)
  v_mfma_f32_32x32x16_bf16 v[112:127], v[132:135], a[116:119], v[112:127]
  v_exp_f32 v197, v197
  v_exp_f32 v198, v198
  ds_read_b128 v[132:135], v4 offset:25344
  s_waitcnt lgkmcnt(3)
  v_mfma_f32_32x32x16_bf16 v[112:127], v[136:139], a[120:123], v[112:127]
  v_exp_f32 v199, v199
  v_pk_add_f32 v[28:29], v[160:161], v[162:163]
  v_pk_add_f32 v[30:31], v[180:181], v[182:183]
  ds_read_b128 v[136:139], v4 offset:26112
  s_waitcnt lgkmcnt(3)
  v_mfma_f32_32x32x16_bf16 v[112:127], v[140:143], a[124:127], v[112:127]
  v_pk_add_f32 v[28:29], v[28:29], v[164:165]
  v_pk_add_f32 v[30:31], v[30:31], v[184:185]
  v_pk_add_f32 v[28:29], v[28:29], v[166:167]
  buffer_load_dwordx4 v[252:255], v3, s[52:55], s50 offen offset:2048
  ds_read_b128 v[140:143], v4 offset:26880
  s_waitcnt lgkmcnt(3)
  v_mfma_f32_32x32x16_bf16 v[112:127], v[128:131], a[128:131], v[112:127]
  v_pk_add_f32 v[30:31], v[30:31], v[186:187]
  v_pk_add_f32 v[28:29], v[28:29], v[168:169]
  v_pk_add_f32 v[30:31], v[30:31], v[188:189]
  v_pk_add_f32 v[28:29], v[28:29], v[170:171]
  ds_read_b128 v[128:131], v4 offset:27648
  s_waitcnt lgkmcnt(3)
  v_mfma_f32_32x32x16_bf16 v[112:127], v[132:135], a[132:135], v[112:127]
  v_pk_add_f32 v[30:31], v[30:31], v[190:191]
  v_pk_add_f32 v[28:29], v[28:29], v[172:173]
  v_pk_add_f32 v[30:31], v[30:31], v[192:193]
  v_pk_add_f32 v[28:29], v[28:29], v[174:175]
  ds_read_b128 v[132:135], v4 offset:28416
  s_waitcnt lgkmcnt(3)
  v_mfma_f32_32x32x16_bf16 v[112:127], v[136:139], a[136:139], v[112:127]
  v_pk_add_f32 v[30:31], v[30:31], v[194:195]
  v_pk_add_f32 v[28:29], v[28:29], v[176:177]
  v_pk_add_f32 v[30:31], v[30:31], v[196:197]
  v_pk_add_f32 v[28:29], v[28:29], v[178:179]
  ds_read_b128 v[136:139], v4 offset:29184
  s_waitcnt lgkmcnt(3)
  v_mfma_f32_32x32x16_bf16 v[112:127], v[140:143], a[140:143], v[112:127]
  v_pk_add_f32 v[30:31], v[30:31], v[198:199]
  v_add_f32 v28, v28, v29
  v_add_f32 v30, v30, v31
  v_rcp_f32 v28, v28
  ds_read_b128 v[140:143], v4 offset:29952
  s_waitcnt lgkmcnt(3)
  v_mfma_f32_32x32x16_bf16 v[112:127], v[128:131], a[144:147], v[112:127]
  v_rcp_f32 v30, v30
  s_nop 0
  v_pk_mul_f32 v[160:161], v[160:161], v[28:29] op_sel_hi:[1,0]
  s_waitcnt lgkmcnt(2)
  v_mfma_f32_32x32x16_bf16 v[112:127], v[132:135], a[148:151], v[112:127]
  v_pk_mul_f32 v[180:181], v[180:181], v[30:31] op_sel_hi:[1,0]
  v_pk_mul_f32 v[162:163], v[162:163], v[28:29] op_sel_hi:[1,0]
  v_pk_mul_f32 v[182:183], v[182:183], v[30:31] op_sel_hi:[1,0]
  v_pk_mul_f32 v[164:165], v[164:165], v[28:29] op_sel_hi:[1,0]
  s_waitcnt lgkmcnt(1)
  v_mfma_f32_32x32x16_bf16 v[112:127], v[136:139], a[152:155], v[112:127]
  v_pk_mul_f32 v[184:185], v[184:185], v[30:31] op_sel_hi:[1,0]
  v_pk_mul_f32 v[166:167], v[166:167], v[28:29] op_sel_hi:[1,0]
  v_pk_mul_f32 v[186:187], v[186:187], v[30:31] op_sel_hi:[1,0]
  v_pk_mul_f32 v[168:169], v[168:169], v[28:29] op_sel_hi:[1,0]
  s_waitcnt lgkmcnt(0)
  v_mfma_f32_32x32x16_bf16 v[112:127], v[140:143], a[156:159], v[112:127]
  v_pk_mul_f32 v[188:189], v[188:189], v[30:31] op_sel_hi:[1,0]
  v_pk_mul_f32 v[170:171], v[170:171], v[28:29] op_sel_hi:[1,0]
  v_pk_mul_f32 v[190:191], v[190:191], v[30:31] op_sel_hi:[1,0]
  v_pk_mul_f32 v[172:173], v[172:173], v[28:29] op_sel_hi:[1,0]
  v_pk_mul_f32 v[192:193], v[192:193], v[30:31] op_sel_hi:[1,0]
  v_pk_mul_f32 v[174:175], v[174:175], v[28:29] op_sel_hi:[1,0]
  v_pk_mul_f32 v[194:195], v[194:195], v[30:31] op_sel_hi:[1,0]
  v_pk_mul_f32 v[176:177], v[176:177], v[28:29] op_sel_hi:[1,0]
  v_pk_mul_f32 v[196:197], v[196:197], v[30:31] op_sel_hi:[1,0]
  v_pk_mul_f32 v[178:179], v[178:179], v[28:29] op_sel_hi:[1,0]
  v_pk_mul_f32 v[198:199], v[198:199], v[30:31] op_sel_hi:[1,0]
  v_cvt_pk_bf16_f32 v200, v160, v161
  v_cvt_pk_bf16_f32 v201, v162, v163
  v_cvt_pk_bf16_f32 v202, v164, v165
  v_cvt_pk_bf16_f32 v203, v166, v167
  v_cvt_pk_bf16_f32 v204, v168, v169
  v_cvt_pk_bf16_f32 v205, v170, v171
  v_cvt_pk_bf16_f32 v206, v172, v173
  v_cvt_pk_bf16_f32 v207, v174, v175
  v_cvt_pk_bf16_f32 v208, v176, v177
  v_cvt_pk_bf16_f32 v209, v178, v179
  v_cvt_pk_bf16_f32 v210, v180, v181
  v_cvt_pk_bf16_f32 v211, v182, v183
  v_cvt_pk_bf16_f32 v212, v184, v185
  v_cvt_pk_bf16_f32 v213, v186, v187
  v_cvt_pk_bf16_f32 v214, v188, v189
  v_cvt_pk_bf16_f32 v215, v190, v191
  v_cvt_pk_bf16_f32 v216, v192, v193
  v_cvt_pk_bf16_f32 v217, v194, v195
  v_cvt_pk_bf16_f32 v218, v196, v197
  v_cvt_pk_bf16_f32 v219, v198, v199
  v_cvt_pk_bf16_f32 v220, v84, v85
  v_cvt_pk_bf16_f32 v221, v86, v87
  v_cvt_pk_bf16_f32 v222, v88, v89
  v_cvt_pk_bf16_f32 v223, v90, v91
  v_cvt_pk_bf16_f32 v224, v92, v93
  v_cvt_pk_bf16_f32 v225, v94, v95
  v_cvt_pk_bf16_f32 v226, v96, v97
  v_cvt_pk_bf16_f32 v227, v98, v99
  v_cvt_pk_bf16_f32 v228, v100, v101
  v_cvt_pk_bf16_f32 v229, v102, v103
  v_mov_b32 v230, 0x3f80
  v_mov_b32 v231, 0
  v_and_b32 v6, 31, v2
  v_lshl_add_u32 v6, s24, 5, v6
  v_mul_u32_u24 v6, 144, v6
  v_lshrrev_b32 v7, 5, v2
  v_mul_u32_u24 v7, 18432, v7
  v_add_u32 v6, v6, v7
  ds_write_b128 v6, v[200:203] offset:0
  ds_write_b128 v6, v[204:207] offset:16
  ds_write_b128 v6, v[208:211] offset:32
  ds_write_b128 v6, v[212:215] offset:48
  ds_write_b128 v6, v[216:219] offset:64
  ds_write_b128 v6, v[220:223] offset:80
  ds_write_b128 v6, v[224:227] offset:96
  ds_write_b128 v6, v[228:231] offset:112
  s_waitcnt lgkmcnt(0)
  s_barrier
  s_lshr_b32 s28, s24, 1
  s_and_b32 s29, s24, 1
  v_lshrrev_b32 v6, 5, v2
  v_lshlrev_b32 v6, 3, v6
  v_bfe_u32 v7, v2, 2, 2
  v_add_u32 v6, v6, v7
  v_mul_u32_u24 v6, 144, v6
  v_bfe_u32 v7, v2, 4, 1
  v_lshl_add_u32 v6, v7, 5, v6
  v_and_b32 v7, 3, v2
  v_lshl_add_u32 v6, v7, 3, v6
  s_mul_i32 s30, s28, 18432
  v_add_u32 v6, s30, v6
  v_add_u32 v7, 80, v6
  s_lshl_b32 s30, s29, 6
  v_add_u32 v6, s30, v6
  ds_read_b64_tr_b16 v[128:129], v6 offset:0
  ds_read_b64_tr_b16 v[130:131], v6 offset:576
  ds_read_b64_tr_b16 v[160:161], v7 offset:0
  ds_read_b64_tr_b16 v[162:163], v7 offset:576
  ds_read_b64_tr_b16 v[132:133], v6 offset:2304
  ds_read_b64_tr_b16 v[134:135], v6 offset:2880
  ds_read_b64_tr_b16 v[164:165], v7 offset:2304
  ds_read_b64_tr_b16 v[166:167], v7 offset:2880
  s_waitcnt lgkmcnt(8)
  ds_read_b64_tr_b16 v[136:137], v6 offset:4608
  ds_read_b64_tr_b16 v[138:139], v6 offset:5184
  ds_read_b64_tr_b16 v[168:169], v7 offset:4608
  ds_read_b64_tr_b16 v[170:171], v7 offset:5184
  ds_read_b64_tr_b16 v[140:141], v6 offset:6912
  ds_read_b64_tr_b16 v[142:143], v6 offset:7488
  ds_read_b64_tr_b16 v[172:173], v7 offset:6912
  ds_read_b64_tr_b16 v[174:175], v7 offset:7488
  s_waitcnt lgkmcnt(8)
  ds_read_b64_tr_b16 v[144:145], v6 offset:9216
  ds_read_b64_tr_b16 v[146:147], v6 offset:9792
  ds_read_b64_tr_b16 v[176:177], v7 offset:9216
  ds_read_b64_tr_b16 v[178:179], v7 offset:9792
  ds_read_b64_tr_b16 v[148:149], v6 offset:11520
  ds_read_b64_tr_b16 v[150:151], v6 offset:12096
  ds_read_b64_tr_b16 v[180:181], v7 offset:11520
  ds_read_b64_tr_b16 v[182:183], v7 offset:12096
  s_waitcnt lgkmcnt(8)
  ds_read_b64_tr_b16 v[152:153], v6 offset:13824
  ds_read_b64_tr_b16 v[154:155], v6 offset:14400
  ds_read_b64_tr_b16 v[184:185], v7 offset:13824
  ds_read_b64_tr_b16 v[186:187], v7 offset:14400
  ds_read_b64_tr_b16 v[156:157], v6 offset:16128
  ds_read_b64_tr_b16 v[158:159], v6 offset:16704
  ds_read_b64_tr_b16 v[188:189], v7 offset:16128
  ds_read_b64_tr_b16 v[190:191], v7 offset:16704
  s_waitcnt lgkmcnt(0)
  v_mfma_f32_32x32x16_bf16 v[232:247], v[128:131], v[160:163], 0
  v_mfma_f32_32x32x16_bf16 v[232:247], v[132:135], v[164:167], v[232:247]
  v_mfma_f32_32x32x16_bf16 v[232:247], v[136:139], v[168:171], v[232:247]
  v_mfma_f32_32x32x16_bf16 v[232:247], v[140:143], v[172:175], v[232:247]
  v_mfma_f32_32x32x16_bf16 v[232:247], v[144:147], v[176:179], v[232:247]
  v_mfma_f32_32x32x16_bf16 v[232:247], v[148:151], v[180:183], v[232:247]
  v_mfma_f32_32x32x16_bf16 v[232:247], v[152:155], v[184:187], v[232:247]
  v_mfma_f32_32x32x16_bf16 v[232:247], v[156:159], v[188:191], v[232:247]
  v_max3_f32 v24, v104, v105, v106
  v_min3_f32 v26, v104, v105, v106
  v_max3_f32 v24, v24, v107, v108
  v_min3_f32 v26, v26, v107, v108
  v_max3_f32 v24, v24, v109, v110
  v_min3_f32 v26, v26, v109, v110
  v_max3_f32 v24, v24, v111, v112
  v_min3_f32 v26, v26, v111, v112
  v_max3_f32 v24, v24, v113, v114
  v_min3_f32 v26, v26, v113, v114
  v_max3_f32 v24, v24, v115, v116
  v_min3_f32 v26, v26, v115, v116
  v_max3_f32 v24, v24, v117, v118
  v_min3_f32 v26, v26, v117, v118
  v_max3_f32 v24, v24, v119, v120
  v_min3_f32 v26, v26, v119, v120
  v_max3_f32 v24, v24, v121, v122
  v_min3_f32 v26, v26, v121, v122
  v_max_f32 v24, v24, v123
  v_min_f32 v26, v26, v123
  v_pk_add_f32 v[192:193], v[104:105], v[24:25] op_sel_hi:[1,0] neg_lo:[0,1] neg_hi:[0,1]
  v_pk_add_f32 v[212:213], v[104:105], v[26:27] op_sel_hi:[1,0] neg_lo:[1,0] neg_hi:[1,0]
  v_pk_add_f32 v[194:195], v[106:107], v[24:25] op_sel_hi:[1,0] neg_lo:[0,1] neg_hi:[0,1]
  v_pk_add_f32 v[214:215], v[106:107], v[26:27] op_sel_hi:[1,0] neg_lo:[1,0] neg_hi:[1,0]
  v_pk_add_f32 v[196:197], v[108:109], v[24:25] op_sel_hi:[1,0] neg_lo:[0,1] neg_hi:[0,1]
  v_pk_add_f32 v[216:217], v[108:109], v[26:27] op_sel_hi:[1,0] neg_lo:[1,0] neg_hi:[1,0]
  v_pk_add_f32 v[198:199], v[110:111], v[24:25] op_sel_hi:[1,0] neg_lo:[0,1] neg_hi:[0,1]
  v_pk_add_f32 v[218:219], v[110:111], v[26:27] op_sel_hi:[1,0] neg_lo:[1,0] neg_hi:[1,0]
  v_pk_add_f32 v[200:201], v[112:113], v[24:25] op_sel_hi:[1,0] neg_lo:[0,1] neg_hi:[0,1]
  v_pk_add_f32 v[220:221], v[112:113], v[26:27] op_sel_hi:[1,0] neg_lo:[1,0] neg_hi:[1,0]
  v_pk_add_f32 v[202:203], v[114:115], v[24:25] op_sel_hi:[1,0] neg_lo:[0,1] neg_hi:[0,1]
  v_pk_add_f32 v[222:223], v[114:115], v[26:27] op_sel_hi:[1,0] neg_lo:[1,0] neg_hi:[1,0]
  v_pk_add_f32 v[204:205], v[116:117], v[24:25] op_sel_hi:[1,0] neg_lo:[0,1] neg_hi:[0,1]
  v_pk_add_f32 v[224:225], v[116:117], v[26:27] op_sel_hi:[1,0] neg_lo:[1,0] neg_hi:[1,0]
  v_pk_add_f32 v[206:207], v[118:119], v[24:25] op_sel_hi:[1,0] neg_lo:[0,1] neg_hi:[0,1]
  v_pk_add_f32 v[226:227], v[118:119], v[26:27] op_sel_hi:[1,0] neg_lo:[1,0] neg_hi:[1,0]
  v_pk_add_f32 v[208:209], v[120:121], v[24:25] op_sel_hi:[1,0] neg_lo:[0,1] neg_hi:[0,1]
  v_pk_add_f32 v[228:229], v[120:121], v[26:27] op_sel_hi:[1,0] neg_lo:[1,0] neg_hi:[1,0]
  v_pk_add_f32 v[210:211], v[122:123], v[24:25] op_sel_hi:[1,0] neg_lo:[0,1] neg_hi:[0,1]
  v_pk_add_f32 v[230:231], v[122:123], v[26:27] op_sel_hi:[1,0] neg_lo:[1,0] neg_hi:[1,0]
  v_exp_f32 v192, v192
  v_exp_f32 v193, v193
  v_exp_f32 v194, v194
  v_exp_f32 v195, v195
  v_exp_f32 v196, v196
  v_exp_f32 v197, v197
  v_exp_f32 v198, v198
  v_exp_f32 v199, v199
  v_exp_f32 v200, v200
  v_exp_f32 v201, v201
  v_exp_f32 v202, v202
  v_exp_f32 v203, v203
  v_exp_f32 v204, v204
  v_exp_f32 v205, v205
  v_exp_f32 v206, v206
  v_exp_f32 v207, v207
  v_exp_f32 v208, v208
  v_exp_f32 v209, v209
  v_exp_f32 v210, v210
  v_exp_f32 v211, v211
  v_exp_f32 v212, v212
  v_exp_f32 v213, v213
  v_exp_f32 v214, v214
  v_exp_f32 v215, v215
  v_exp_f32 v216, v216
  v_exp_f32 v217, v217
  v_exp_f32 v218, v218
  v_exp_f32 v219, v219
  v_exp_f32 v220, v220
  v_exp_f32 v221, v221
  v_exp_f32 v222, v222
  v_exp_f32 v223, v223
  v_exp_f32 v224, v224
  v_exp_f32 v225, v225
  v_exp_f32 v226, v226
  v_exp_f32 v227, v227
  v_exp_f32 v228, v228
  v_exp_f32 v229, v229
  v_exp_f32 v230, v230
  v_exp_f32 v231, v231
  v_pk_add_f32 v[28:29], v[192:193], v[194:195]
  v_pk_add_f32 v[30:31], v[212:213], v[214:215]
  v_pk_add_f32 v[28:29], v[28:29], v[196:197]
  v_pk_add_f32 v[30:31], v[30:31], v[216:217]
  v_pk_add_f32 v[28:29], v[28:29], v[198:199]
  v_pk_add_f32 v[30:31], v[30:31], v[218:219]
  v_pk_add_f32 v[28:29], v[28:29], v[200:201]
  v_pk_add_f32 v[30:31], v[30:31], v[220:221]
  v_pk_add_f32 v[28:29], v[28:29], v[202:203]
  v_pk_add_f32 v[30:31], v[30:31], v[222:223]
  v_pk_add_f32 v[28:29], v[28:29], v[204:205]
  v_pk_add_f32 v[30:31], v[30:31], v[224:225]
  v_pk_add_f32 v[28:29], v[28:29], v[206:207]
  v_pk_add_f32 v[30:31], v[30:31], v[226:227]
  v_pk_add_f32 v[28:29], v[28:29], v[208:209]
  v_pk_add_f32 v[30:31], v[30:31], v[228:229]
  v_pk_add_f32 v[28:29], v[28:29], v[210:211]
  v_pk_add_f32 v[30:31], v[30:31], v[230:231]
  v_add_f32 v28, v28, v29
  v_add_f32 v30, v30, v31
  v_rcp_f32 v28, v28
  v_rcp_f32 v30, v30
  s_nop 0
  v_pk_mul_f32 v[192:193], v[192:193], v[28:29] op_sel_hi:[1,0]
  v_pk_mul_f32 v[212:213], v[212:213], v[30:31] op_sel_hi:[1,0]
  v_pk_mul_f32 v[194:195], v[194:195], v[28:29] op_sel_hi:[1,0]
  v_pk_mul_f32 v[214:215], v[214:215], v[30:31] op_sel_hi:[1,0]
  v_pk_mul_f32 v[196:197], v[196:197], v[28:29] op_sel_hi:[1,0]
  v_pk_mul_f32 v[216:217], v[216:217], v[30:31] op_sel_hi:[1,0]
  v_pk_mul_f32 v[198:199], v[198:199], v[28:29] op_sel_hi:[1,0]
  v_pk_mul_f32 v[218:219], v[218:219], v[30:31] op_sel_hi:[1,0]
  v_pk_mul_f32 v[200:201], v[200:201], v[28:29] op_sel_hi:[1,0]
  v_pk_mul_f32 v[220:221], v[220:221], v[30:31] op_sel_hi:[1,0]
  v_pk_mul_f32 v[202:203], v[202:203], v[28:29] op_sel_hi:[1,0]
  v_pk_mul_f32 v[222:223], v[222:223], v[30:31] op_sel_hi:[1,0]
  v_pk_mul_f32 v[204:205], v[204:205], v[28:29] op_sel_hi:[1,0]
  v_pk_mul_f32 v[224:225], v[224:225], v[30:31] op_sel_hi:[1,0]
  v_pk_mul_f32 v[206:207], v[206:207], v[28:29] op_sel_hi:[1,0]
  v_pk_mul_f32 v[226:227], v[226:227], v[30:31] op_sel_hi:[1,0]
  v_pk_mul_f32 v[208:209], v[208:209], v[28:29] op_sel_hi:[1,0]
  v_pk_mul_f32 v[228:229], v[228:229], v[30:31] op_sel_hi:[1,0]
  v_pk_mul_f32 v[210:211], v[210:211], v[28:29] op_sel_hi:[1,0]
  v_pk_mul_f32 v[230:231], v[230:231], v[30:31] op_sel_hi:[1,0]
  v_cvt_pk_bf16_f32 v40, v192, v193
  v_cvt_pk_bf16_f32 v41, v194, v195
  v_cvt_pk_bf16_f32 v42, v196, v197
  v_cvt_pk_bf16_f32 v43, v198, v199
  v_cvt_pk_bf16_f32 v44, v200, v201
  v_cvt_pk_bf16_f32 v45, v202, v203
  v_cvt_pk_bf16_f32 v46, v204, v205
  v_cvt_pk_bf16_f32 v47, v206, v207
  v_cvt_pk_bf16_f32 v48, v208, v209
  v_cvt_pk_bf16_f32 v49, v210, v211
  v_cvt_pk_bf16_f32 v50, v212, v213
  v_cvt_pk_bf16_f32 v51, v214, v215
  v_cvt_pk_bf16_f32 v52, v216, v217
  v_cvt_pk_bf16_f32 v53, v218, v219
  v_cvt_pk_bf16_f32 v54, v220, v221
  v_cvt_pk_bf16_f32 v55, v222, v223
  v_cvt_pk_bf16_f32 v56, v224, v225
  v_cvt_pk_bf16_f32 v57, v226, v227
  v_cvt_pk_bf16_f32 v58, v228, v229
  v_cvt_pk_bf16_f32 v59, v230, v231
  buffer_store_dwordx4 v[40:43], v3, s[36:39], s49 offen offset:0
  buffer_store_dwordx4 v[44:47], v3, s[36:39], s49 offen offset:1024
  buffer_store_dwordx4 v[48:51], v3, s[36:39], s49 offen offset:2048
  buffer_store_dwordx4 v[52:55], v3, s[36:39], s49 offen offset:3072
  s_add_u32 s49, s49, 4096
  buffer_store_dwordx4 v[56:59], v3, s[36:39], s49 offen offset:0
  s_add_u32 s12, s4, 0x77c000
  s_addc_u32 s13, s5, 0
  s_mov_b32 s14, 0xf0000
  s_mov_b32 s15, 0x00020000
  s_lshl_b32 s30, s22, 4
  s_add_u32 s30, s30, s23
  s_mul_i32 s30, s30, 3840
  s_mul_i32 s31, s28, 1920
  s_add_u32 s30, s30, s31
  s_mul_i32 s31, s29, 1536
  s_add_u32 s30, s30, s31
  v_and_b32 v6, 31, v2
  v_lshlrev_b32 v7, 4, v6
  v_lshrrev_b32 v8, 5, v2
  v_lshl_add_u32 v7, v8, 3, v7
  v_cvt_pk_bf16_f32 v128, v232, v233
  v_cvt_pk_bf16_f32 v129, v234, v235
  v_cvt_pk_bf16_f32 v130, v236, v237
  v_cvt_pk_bf16_f32 v131, v238, v239
  v_cvt_pk_bf16_f32 v132, v240, v241
  v_cvt_pk_bf16_f32 v133, v242, v243
  v_cvt_pk_bf16_f32 v134, v244, v245
  v_cvt_pk_bf16_f32 v135, v246, v247
  v_cmp_gt_u32 vcc, 24, v6
  s_and_saveexec_b64 s[40:41], vcc
  buffer_store_dwordx2 v[128:129], v7, s[12:15], s30 offen
  s_cmp_eq_u32 s29, 1
  s_cbranch_scc1 L_k1_fin
  buffer_store_dwordx2 v[130:131], v7, s[12:15], s30 offen offset:384
  buffer_store_dwordx2 v[132:133], v7, s[12:15], s30 offen offset:768
  buffer_store_dwordx2 v[134:135], v7, s[12:15], s30 offen offset:1152
L_k1_fin:
L_k1_end:
  s_endpgm
.globl tail_kernel
.p2align 8
.type tail_kernel,@function
tail_kernel:
  s_cmp_ge_u32 s2, 256
  s_cbranch_scc1 L_k2_end
  s_load_dwordx2 s[4:5], s[0:1], 104
  s_load_dwordx2 s[6:7], s[0:1], 0
  s_load_dwordx2 s[8:9], s[0:1], 88
  s_load_dwordx2 s[10:11], s[0:1], 48
  s_load_dwordx2 s[12:13], s[0:1], 64
  s_getreg_b32 s27, hwreg(HW_REG_XCC_ID, 0, 4)
  s_and_b32 s20, s2, 7
  s_lshr_b32 s21, s2, 7
  s_bfe_u32 s22, s2, 0x40003
  s_lshl_b32 s23, s20, 1
  s_add_u32 s23, s23, s21
  s_and_b32 s28, s22, 7
  s_lshl_b32 s29, s23, 3
  s_lshr_b32 s33, s22, 3
  s_lshl_b32 s69, s33, 2
  s_add_u32 s29, s29, s69
  s_lshl_b32 s30, s23, 7
  s_lshr_b32 s33, s22, 2
  s_mul_i32 s33, s33, 27
  s_and_b32 s34, s22, 3
  s_mul_i32 s35, s34, 7
  s_add_u32 s31, s33, s35
  s_cmp_eq_u32 s34, 3
  s_cselect_b32 s32, 6, 7
  s_mul_i32 s36, s31, 20480
  s_mul_i32 s68, s23, 655360
  v_lshrrev_b32 v3, 6, v0
  v_and_b32 v1, 63, v0
  v_readfirstlane_b32 s24, v3
  v_lshlrev_b32 v2, 4, v1
  v_lshlrev_b32 v4, 4, v0
  s_waitcnt lgkmcnt(0)
  s_load_dword s25, s[4:5], 8192
  s_add_u32 s44, s4, 0x77c000
  s_addc_u32 s45, s5, 0
  s_mov_b32 s46, 0xf0000
  s_mov_b32 s47, 0x00020000
  s_add_u32 s48, s4, 0x88c000
  s_addc_u32 s49, s5, 0
  s_mov_b32 s50, 0xa00000
  s_mov_b32 s51, 0x00020000
  s_add_u32 s52, s4, 0x268000
  s_addc_u32 s53, s5, 0
  s_mov_b32 s54, 0xc8000
  s_mov_b32 s55, 0x00020000
  s_add_u32 s56, s4, 0x330000
  s_addc_u32 s57, s5, 0
  s_mov_b32 s58, 0x21c000
  s_mov_b32 s59, 0x00020000
  s_add_u32 s60, s4, 0x54c000
  s_addc_u32 s61, s5, 0
  s_mov_b32 s62, 0x230000
  s_mov_b32 s63, 0x00020000
  s_mul_i32 s64, s22, 61440
  s_mul_i32 s65, s28, 20480
  s_add_u32 s65, s65, s68
  s_cmp_lt_u32 s22, 8
  s_mov_b32 s34, 172032
  s_cselect_b32 s34, 483328, s34
  s_add_u32 s65, s65, s34
  s_mul_i32 s34, s24, 5120
  s_add_u32 s65, s65, s34
  s_mul_i32 s66, s28, 102400
  s_mul_i32 s67, s24, 25600
  s_add_u32 s66, s66, s67
  buffer_load_dwordx4 v[64:67], v4, s[44:47], s64 offen
  s_add_u32 s64, s64, 3840
  buffer_load_dwordx4 v[68:71], v4, s[44:47], s64 offen
  s_add_u32 s64, s64, 3840
  buffer_load_dwordx4 v[72:75], v4, s[44:47], s64 offen
  s_add_u32 s64, s64, 3840
  buffer_load_dwordx4 v[76:79], v4, s[44:47], s64 offen
  s_add_u32 s64, s64, 3840
  buffer_load_dwordx4 v[80:83], v4, s[44:47], s64 offen
  s_add_u32 s64, s64, 3840
  buffer_load_dwordx4 v[84:87], v4, s[44:47], s64 offen
  s_add_u32 s64, s64, 3840
  s_add_u32 s16, s4, 0x5000
  s_addc_u32 s17, s5, 0
  s_mov_b32 s18, 0x800
  s_mov_b32 s19, 0x00020000
  s_lshl_b32 s33, s22, 3
  s_add_u32 s33, s33, s30
  v_mov_b32 v12, 0
  v_mov_b32 v13, 0
  v_mov_b32 v14, 0
  v_mov_b32 v15, 0
  v_add_u32 v5, 147200, v4
  v_cmp_gt_u32 vcc, 100, v0
  s_and_saveexec_b64 s[40:41], vcc
  ds_write_b128 v5, v[12:15]
  s_mov_b64 exec, s[40:41]
  s_waitcnt lgkmcnt(0)
  v_mov_b32 v18, s33
  v_mov_b32 v10, s25
  v_mov_b32 v11, s27
  v_cmp_eq_u32 vcc, 0, v0
  v_mov_b32 v9, 0x7ffffff0
  s_nop 0
  v_cndmask_b32 v18, v9, v18, vcc
  s_mov_b32 s34, 0x00003f80
  s_mov_b32 s35, 0x3f800000
  v_mov_b32 v148, 0
  v_mov_b32 v149, 0
  v_mov_b32 v150, 0
  v_mov_b32 v151, 0
  v_mov_b32 v152, 0
  v_mov_b32 v153, 0
  v_mov_b32 v154, 0
  v_mov_b32 v155, 0
  v_and_b32 v5, 31, v1
  v_bfe_u32 v6, v5, 2, 1
  v_lshrrev_b32 v7, 5, v1
  v_lshrrev_b32 v8, 3, v5
  v_lshlrev_b32 v8, 2, v8
  v_and_b32 v9, 3, v5
  v_add_u32 v8, v8, v9
  v_mul_u32_u24 v16, 1920, v6
  v_lshl_add_u32 v16, v8, 4, v16
  v_add_u32 v16, 143360, v16
  v_add_u32 v17, 256, v16
  v_mov_b32 v13, 147200
  v_cmp_eq_u32 vcc, v6, v7
  v_cmp_gt_u32 s[40:41], 8, v8
  s_nop 0
  v_cndmask_b32 v16, v13, v16, vcc
  s_and_b64 vcc, vcc, s[40:41]
  s_nop 1
  v_cndmask_b32 v17, v13, v17, vcc
  s_mov_b32 s72, s6
  s_mov_b32 s73, s7
  s_mov_b32 s74, 0x280000
  s_mov_b32 s75, 0x00020000
  s_mov_b32 s76, s4
  s_mov_b32 s77, s5
  s_mov_b32 s78, 0x1e00
  s_mov_b32 s79, 0x00020000
  v_and_b32 v24, 15, v1
  v_lshrrev_b32 v25, 4, v1
  s_add_u32 s33, s29, s24
  s_lshl_b32 s33, s33, 4
  v_add_u32 v23, s33, v24
  s_mov_b32 s33, 1280
  v_mul_u32_u24 v20, s33, v23
  s_mul_i32 s33, s28, 160
  v_lshl_add_u32 v21, v25, 3, s33
  v_add_u32 v20, v20, v21
  v_add_u32 v22, 4096, v21
  s_waitcnt vmcnt(5)
  v_dot2_f32_bf16 v148, v64, s34, v148
  v_dot2_f32_bf16 v149, v64, s35, v149
  v_dot2_f32_bf16 v150, v65, s34, v150
  v_dot2_f32_bf16 v151, v65, s35, v151
  v_dot2_f32_bf16 v152, v66, s34, v152
  v_dot2_f32_bf16 v153, v66, s35, v153
  v_dot2_f32_bf16 v154, v67, s34, v154
  v_dot2_f32_bf16 v155, v67, s35, v155
  buffer_load_dwordx4 v[88:91], v4, s[44:47], s64 offen
  s_add_u32 s64, s64, 3840
  s_waitcnt vmcnt(5)
  v_dot2_f32_bf16 v148, v68, s34, v148
  v_dot2_f32_bf16 v149, v68, s35, v149
  v_dot2_f32_bf16 v150, v69, s34, v150
  v_dot2_f32_bf16 v151, v69, s35, v151
  v_dot2_f32_bf16 v152, v70, s34, v152
  v_dot2_f32_bf16 v153, v70, s35, v153
  v_dot2_f32_bf16 v154, v71, s34, v154
  v_dot2_f32_bf16 v155, v71, s35, v155
  buffer_load_dwordx4 v[92:95], v4, s[44:47], s64 offen
  s_add_u32 s64, s64, 3840
  s_waitcnt vmcnt(5)
  v_dot2_f32_bf16 v148, v72, s34, v148
  v_dot2_f32_bf16 v149, v72, s35, v149
  v_dot2_f32_bf16 v150, v73, s34, v150
  v_dot2_f32_bf16 v151, v73, s35, v151
  v_dot2_f32_bf16 v152, v74, s34, v152
  v_dot2_f32_bf16 v153, v74, s35, v153
  v_dot2_f32_bf16 v154, v75, s34, v154
  v_dot2_f32_bf16 v155, v75, s35, v155
  buffer_load_dwordx4 v[96:99], v4, s[44:47], s64 offen
  s_add_u32 s64, s64, 3840
  s_waitcnt vmcnt(5)
  v_dot2_f32_bf16 v148, v76, s34, v148
  v_dot2_f32_bf16 v149, v76, s35, v149
  v_dot2_f32_bf16 v150, v77, s34, v150
  v_dot2_f32_bf16 v151, v77, s35, v151
  v_dot2_f32_bf16 v152, v78, s34, v152
  v_dot2_f32_bf16 v153, v78, s35, v153
  v_dot2_f32_bf16 v154, v79, s34, v154
  v_dot2_f32_bf16 v155, v79, s35, v155
  buffer_load_dwordx4 v[100:103], v4, s[44:47], s64 offen
  s_add_u32 s64, s64, 3840
  s_waitcnt vmcnt(5)
  v_dot2_f32_bf16 v148, v80, s34, v148
  v_dot2_f32_bf16 v149, v80, s35, v149
  v_dot2_f32_bf16 v150, v81, s34, v150
  v_dot2_f32_bf16 v151, v81, s35, v151
  v_dot2_f32_bf16 v152, v82, s34, v152
  v_dot2_f32_bf16 v153, v82, s35, v153
  v_dot2_f32_bf16 v154, v83, s34, v154
  v_dot2_f32_bf16 v155, v83, s35, v155
  buffer_load_dwordx4 v[104:107], v4, s[44:47], s64 offen
  s_add_u32 s64, s64, 3840
  s_waitcnt vmcnt(5)
  v_dot2_f32_bf16 v148, v84, s34, v148
  v_dot2_f32_bf16 v149, v84, s35, v149
  v_dot2_f32_bf16 v150, v85, s34, v150
  v_dot2_f32_bf16 v151, v85, s35, v151
  v_dot2_f32_bf16 v152, v86, s34, v152
  v_dot2_f32_bf16 v153, v86, s35, v153
  v_dot2_f32_bf16 v154, v87, s34, v154
  v_dot2_f32_bf16 v155, v87, s35, v155
  buffer_load_dwordx4 v[108:111], v4, s[44:47], s64 offen
  s_add_u32 s64, s64, 3840
  s_waitcnt vmcnt(5)
  v_dot2_f32_bf16 v148, v88, s34, v148
  v_dot2_f32_bf16 v149, v88, s35, v149
  v_dot2_f32_bf16 v150, v89, s34, v150
  v_dot2_f32_bf16 v151, v89, s35, v151
  v_dot2_f32_bf16 v152, v90, s34, v152
  v_dot2_f32_bf16 v153, v90, s35, v153
  v_dot2_f32_bf16 v154, v91, s34, v154
  v_dot2_f32_bf16 v155, v91, s35, v155
  buffer_load_dwordx4 v[112:115], v4, s[44:47], s64 offen
  s_add_u32 s64, s64, 3840
  s_waitcnt vmcnt(5)
  v_dot2_f32_bf16 v148, v92, s34, v148
  v_dot2_f32_bf16 v149, v92, s35, v149
  v_dot2_f32_bf16 v150, v93, s34, v150
  v_dot2_f32_bf16 v151, v93, s35, v151
  v_dot2_f32_bf16 v152, v94, s34, v152
  v_dot2_f32_bf16 v153, v94, s35, v153
  v_dot2_f32_bf16 v154, v95, s34, v154
  v_dot2_f32_bf16 v155, v95, s35, v155
  buffer_load_dwordx4 v[116:119], v4, s[44:47], s64 offen
  s_add_u32 s64, s64, 3840
  s_waitcnt vmcnt(5)
  v_dot2_f32_bf16 v148, v96, s34, v148
  v_dot2_f32_bf16 v149, v96, s35, v149
  v_dot2_f32_bf16 v150, v97, s34, v150
  v_dot2_f32_bf16 v151, v97, s35, v151
  v_dot2_f32_bf16 v152, v98, s34, v152
  v_dot2_f32_bf16 v153, v98, s35, v153
  v_dot2_f32_bf16 v154, v99, s34, v154
  v_dot2_f32_bf16 v155, v99, s35, v155
  buffer_load_dwordx4 v[120:123], v4, s[44:47], s64 offen
  s_add_u32 s64, s64, 3840
  s_add_u32 s33, s66, 0
  buffer_load_dwordx4 a[0:3], v2, s[52:55], s33 offen offset:0
  s_add_u32 s33, s66, 0
  buffer_load_dwordx4 a[4:7], v2, s[52:55], s33 offen offset:1024
  s_waitcnt vmcnt(7)
  v_dot2_f32_bf16 v148, v100, s34, v148
  v_dot2_f32_bf16 v149, v100, s35, v149
  v_dot2_f32_bf16 v150, v101, s34, v150
  v_dot2_f32_bf16 v151, v101, s35, v151
  v_dot2_f32_bf16 v152, v102, s34, v152
  v_dot2_f32_bf16 v153, v102, s35, v153
  v_dot2_f32_bf16 v154, v103, s34, v154
  v_dot2_f32_bf16 v155, v103, s35, v155
  buffer_load_dwordx4 v[124:127], v4, s[44:47], s64 offen
  s_add_u32 s64, s64, 3840
  s_add_u32 s33, s66, 0
  buffer_load_dwordx4 a[8:11], v2, s[52:55], s33 offen offset:2048
  s_add_u32 s33, s66, 0
  buffer_load_dwordx4 a[12:15], v2, s[52:55], s33 offen offset:3072
  s_waitcnt vmcnt(9)
  v_dot2_f32_bf16 v148, v104, s34, v148
  v_dot2_f32_bf16 v149, v104, s35, v149
  v_dot2_f32_bf16 v150, v105, s34, v150
  v_dot2_f32_bf16 v151, v105, s35, v151
  v_dot2_f32_bf16 v152, v106, s34, v152
  v_dot2_f32_bf16 v153, v106, s35, v153
  v_dot2_f32_bf16 v154, v107, s34, v154
  v_dot2_f32_bf16 v155, v107, s35, v155
  buffer_load_dwordx4 v[128:131], v2, s[48:51], s65 offen offset:0
  s_add_u32 s33, s66, 4096
  buffer_load_dwordx4 a[16:19], v2, s[52:55], s33 offen offset:0
  s_add_u32 s33, s66, 4096
  buffer_load_dwordx4 a[20:23], v2, s[52:55], s33 offen offset:1024
  s_waitcnt vmcnt(11)
  v_dot2_f32_bf16 v148, v108, s34, v148
  v_dot2_f32_bf16 v149, v108, s35, v149
  v_dot2_f32_bf16 v150, v109, s34, v150
  v_dot2_f32_bf16 v151, v109, s35, v151
  v_dot2_f32_bf16 v152, v110, s34, v152
  v_dot2_f32_bf16 v153, v110, s35, v153
  v_dot2_f32_bf16 v154, v111, s34, v154
  v_dot2_f32_bf16 v155, v111, s35, v155
  buffer_load_dwordx4 v[132:135], v2, s[48:51], s65 offen offset:1024
  s_add_u32 s33, s66, 4096
  buffer_load_dwordx4 a[24:27], v2, s[52:55], s33 offen offset:2048
  s_add_u32 s33, s66, 4096
  buffer_load_dwordx4 a[28:31], v2, s[52:55], s33 offen offset:3072
  s_waitcnt vmcnt(13)
  v_dot2_f32_bf16 v148, v112, s34, v148
  v_dot2_f32_bf16 v149, v112, s35, v149
  v_dot2_f32_bf16 v150, v113, s34, v150
  v_dot2_f32_bf16 v151, v113, s35, v151
  v_dot2_f32_bf16 v152, v114, s34, v152
  v_dot2_f32_bf16 v153, v114, s35, v153
  v_dot2_f32_bf16 v154, v115, s34, v154
  v_dot2_f32_bf16 v155, v115, s35, v155
  buffer_load_dwordx4 v[136:139], v2, s[48:51], s65 offen offset:2048
  s_add_u32 s33, s66, 8192
  buffer_load_dwordx4 a[32:35], v2, s[52:55], s33 offen offset:0
  s_add_u32 s33, s66, 8192
  buffer_load_dwordx4 a[36:39], v2, s[52:55], s33 offen offset:1024
  s_waitcnt vmcnt(15)
  v_dot2_f32_bf16 v148, v116, s34, v148
  v_dot2_f32_bf16 v149, v116, s35, v149
  v_dot2_f32_bf16 v150, v117, s34, v150
  v_dot2_f32_bf16 v151, v117, s35, v151
  v_dot2_f32_bf16 v152, v118, s34, v152
  v_dot2_f32_bf16 v153, v118, s35, v153
  v_dot2_f32_bf16 v154, v119, s34, v154
  v_dot2_f32_bf16 v155, v119, s35, v155
  buffer_load_dwordx4 v[140:143], v2, s[48:51], s65 offen offset:3072
  s_add_u32 s33, s66, 8192
  buffer_load_dwordx4 a[40:43], v2, s[52:55], s33 offen offset:2048
  s_add_u32 s33, s66, 8192
  buffer_load_dwordx4 a[44:47], v2, s[52:55], s33 offen offset:3072
  s_waitcnt vmcnt(17)
  v_dot2_f32_bf16 v148, v120, s34, v148
  v_dot2_f32_bf16 v149, v120, s35, v149
  v_dot2_f32_bf16 v150, v121, s34, v150
  v_dot2_f32_bf16 v151, v121, s35, v151
  v_dot2_f32_bf16 v152, v122, s34, v152
  v_dot2_f32_bf16 v153, v122, s35, v153
  v_dot2_f32_bf16 v154, v123, s34, v154
  v_dot2_f32_bf16 v155, v123, s35, v155
  s_add_u32 s65, s65, 4096
  buffer_load_dwordx4 v[144:147], v2, s[48:51], s65 offen offset:0
  buffer_store_dwordx2 v[10:11], v18, s[16:19], 0 offen sc1
  s_add_u32 s33, s66, 12288
  buffer_load_dwordx4 a[48:51], v2, s[52:55], s33 offen offset:0
  s_add_u32 s33, s66, 12288
  buffer_load_dwordx4 a[52:55], v2, s[52:55], s33 offen offset:1024
  s_waitcnt vmcnt(18)
  v_dot2_f32_bf16 v148, v124, s34, v148
  v_dot2_f32_bf16 v149, v124, s35, v149
  v_dot2_f32_bf16 v150, v125, s34, v150
  v_dot2_f32_bf16 v151, v125, s35, v151
  v_dot2_f32_bf16 v152, v126, s34, v152
  v_dot2_f32_bf16 v153, v126, s35, v153
  v_dot2_f32_bf16 v154, v127, s34, v154
  v_dot2_f32_bf16 v155, v127, s35, v155
  s_add_u32 s33, s66, 12288
  buffer_load_dwordx4 a[56:59], v2, s[52:55], s33 offen offset:2048
  s_add_u32 s33, s66, 12288
  buffer_load_dwordx4 a[60:63], v2, s[52:55], s33 offen offset:3072
  v_cvt_pk_bf16_f32 v156, v148, v149
  v_cvt_pk_bf16_f32 v157, v150, v151
  v_cvt_pk_bf16_f32 v158, v152, v153
  v_cvt_pk_bf16_f32 v159, v154, v155
  v_add_u32 v5, 143360, v4
  v_cmp_gt_u32 vcc, 240, v0
  s_and_saveexec_b64 s[40:41], vcc
  ds_write_b128 v5, v[156:159]
  s_mov_b64 exec, s[40:41]
  s_waitcnt lgkmcnt(0)
  s_barrier
  ds_read_b128 v[64:67], v16 offset:0
  ds_read_b128 v[68:71], v16 offset:384
  ds_read_b128 v[72:75], v16 offset:768
  ds_read_b128 v[76:79], v16 offset:1152
  ds_read_b128 v[80:83], v16 offset:1536
  ds_read_b128 v[84:87], v17 offset:0
  ds_read_b128 v[88:91], v17 offset:384
  ds_read_b128 v[92:95], v17 offset:768
  ds_read_b128 v[96:99], v17 offset:1152
  ds_read_b128 v[100:103], v17 offset:1536
  s_add_u32 s44, s4, 0x88c000
  s_addc_u32 s45, s5, 0
  s_mov_b32 s46, 0xa00000
  s_mov_b32 s47, 0x00020000
  v_and_b32 v5, 31, v1
  v_lshrrev_b32 v6, 4, v5
  s_lshl_b32 s33, s24, 1
  v_add_u32 v6, s33, v6
  s_mov_b32 s34, 20480
  v_mul_u32_u24 v6, s34, v6
  v_and_b32 v5, 15, v5
  v_lshl_add_u32 v6, v5, 4, v6
  s_mul_i32 s34, s22, 1280
  s_add_u32 s34, s34, s68
  v_add_u32 v6, s34, v6
  v_lshrrev_b32 v7, 5, v1
  v_lshl_add_u32 v8, v7, 9, v6
  v_lshl_add_u32 v6, v7, 3, v6
  s_waitcnt vmcnt(5)
  s_waitcnt lgkmcnt(0)
  v_mfma_f32_32x32x16_bf16 v[160:175], v[64:67], v[128:131], 0
  v_mfma_f32_32x32x16_bf16 v[176:191], v[84:87], v[128:131], 0
  v_mfma_f32_32x32x16_bf16 v[160:175], v[68:71], v[132:135], v[160:175]
  v_mfma_f32_32x32x16_bf16 v[176:191], v[88:91], v[132:135], v[176:191]
  v_mfma_f32_32x32x16_bf16 v[160:175], v[72:75], v[136:139], v[160:175]
  v_mfma_f32_32x32x16_bf16 v[176:191], v[92:95], v[136:139], v[176:191]
  v_mfma_f32_32x32x16_bf16 v[160:175], v[76:79], v[140:143], v[160:175]
  v_mfma_f32_32x32x16_bf16 v[176:191], v[96:99], v[140:143], v[176:191]
  v_mfma_f32_32x32x16_bf16 v[160:175], v[80:83], v[144:147], v[160:175]
  v_mfma_f32_32x32x16_bf16 v[176:191], v[100:103], v[144:147], v[176:191]
  s_add_u32 s44, s4, 0x88c000
  s_addc_u32 s45, s5, 0
  s_mov_b32 s46, 0xa00000
  s_mov_b32 s47, 0x00020000
  s_add_u32 s33, s66, 16384
  buffer_load_dwordx4 a[64:67], v2, s[52:55], s33 offen offset:0
  s_add_u32 s33, s66, 16384
  buffer_load_dwordx4 a[68:71], v2, s[52:55], s33 offen offset:1024
  s_add_u32 s33, s66, 16384
  buffer_load_dwordx4 a[72:75], v2, s[52:55], s33 offen offset:2048
  buffer_load_dwordx2 v[192:193], v20, s[72:75], 0 offen offset:0
  buffer_load_dwordx2 v[194:195], v20, s[72:75], 0 offen offset:32
  buffer_load_dwordx2 v[196:197], v20, s[72:75], 0 offen offset:64
  buffer_load_dwordx2 v[198:199], v20, s[72:75], 0 offen offset:96
  buffer_load_dwordx2 v[200:201], v20, s[72:75], 0 offen offset:128
  buffer_load_dwordx2 v[202:203], v21, s[76:79], 0 offen offset:2560
  s_nop 7
  v_add_f32 v5, 0x358637bd, v180
  v_rcp_f32 v5, v5
  s_nop 0
  v_mul_f32 v160, v160, v5
  v_mul_f32 v161, v161, v5
  v_mul_f32 v162, v162, v5
  v_mul_f32 v163, v163, v5
  v_mul_f32 v164, v164, v5
  v_mul_f32 v165, v165, v5
  v_mul_f32 v166, v166, v5
  v_mul_f32 v167, v167, v5
  v_mul_f32 v168, v168, v5
  v_mul_f32 v169, v169, v5
  v_mul_f32 v170, v170, v5
  v_mul_f32 v171, v171, v5
  v_mul_f32 v172, v172, v5
  v_mul_f32 v173, v173, v5
  v_mul_f32 v174, v174, v5
  v_mul_f32 v175, v175, v5
  v_mul_f32 v176, v176, v5
  v_mul_f32 v177, v177, v5
  v_mul_f32 v178, v178, v5
  v_mul_f32 v179, v179, v5
  v_cvt_pk_bf16_f32 v104, v160, v161
  v_cvt_pk_bf16_f32 v105, v162, v163
  v_cvt_pk_bf16_f32 v106, v164, v165
  v_cvt_pk_bf16_f32 v107, v166, v167
  v_cvt_pk_bf16_f32 v108, v168, v169
  v_cvt_pk_bf16_f32 v109, v170, v171
  v_cvt_pk_bf16_f32 v110, v172, v173
  v_cvt_pk_bf16_f32 v111, v174, v175
  v_cvt_pk_bf16_f32 v112, v176, v177
  v_cvt_pk_bf16_f32 v113, v178, v179
  buffer_store_dwordx4 v[104:107], v8, s[44:47], 0 offen
  buffer_store_dwordx4 v[108:111], v8, s[44:47], 0 offen offset:256
  buffer_store_dwordx2 v[112:113], v6, s[44:47], 0 offen offset:1024
  s_cmp_lg_u32 s24, 0
  s_cbranch_scc1 L_k2_nomode
  s_add_u32 s16, s4, 0x5000
  s_addc_u32 s17, s5, 0
  s_mov_b32 s18, 0x800
  s_mov_b32 s19, 0x00020000
  v_and_b32 v8, 15, v1
  v_lshlrev_b32 v8, 3, v8
  v_add_u32 v8, s30, v8
  s_add_u32 s33, s66, 16384
  buffer_load_dwordx4 a[76:79], v2, s[52:55], s33 offen offset:3072
  s_add_u32 s33, s66, 20480
  buffer_load_dwordx4 a[80:83], v2, s[52:55], s33 offen offset:0
  s_add_u32 s33, s66, 20480
  buffer_load_dwordx4 a[84:87], v2, s[52:55], s33 offen offset:1024
  s_add_u32 s33, s66, 20480
  buffer_load_dwordx4 a[88:91], v2, s[52:55], s33 offen offset:2048
  s_add_u32 s33, s66, 20480
  buffer_load_dwordx4 a[92:95], v2, s[52:55], s33 offen offset:3072
  s_add_u32 s33, s66, 24576
  buffer_load_dwordx4 a[96:99], v2, s[52:55], s33 offen offset:0
  buffer_load_dwordx2 v[204:205], v21, s[76:79], 0 offen offset:2592
  buffer_load_dwordx2 v[206:207], v21, s[76:79], 0 offen offset:2624
  buffer_load_dwordx2 v[208:209], v21, s[76:79], 0 offen offset:2656
  buffer_load_dwordx2 v[210:211], v21, s[76:79], 0 offen offset:2688
  buffer_load_dwordx2 v[212:213], v22, s[76:79], 0 offen offset:1024
  buffer_load_dwordx2 v[214:215], v22, s[76:79], 0 offen offset:1056
  buffer_load_dwordx2 v[216:217], v22, s[76:79], 0 offen offset:1088
  buffer_load_dwordx2 v[218:219], v22, s[76:79], 0 offen offset:1120
  buffer_load_dwordx2 v[220:221], v22, s[76:79], 0 offen offset:1152
  buffer_load_dwordx4 v[224:227], v4, s[76:79], 0 offen offset:3840
  s_mov_b32 s42, 0
L_poll_xt2_1:
  buffer_load_dwordx2 v[10:11], v8, s[16:19], 0 offen sc1
  s_waitcnt vmcnt(0)
  v_cmp_ne_u32 vcc, s25, v10
  s_add_u32 s42, s42, 1
  s_cmp_gt_u32 s42, 1048576
  s_cbranch_scc1 L_poll_xt2_1_done
  s_cmp_lg_u64 vcc, 0
  s_cbranch_scc1 L_poll_xt2_1
L_poll_xt2_1_done:
  v_cmp_ne_u32 vcc, s27, v11
  s_cmp_eq_u64 vcc, 0
  s_cselect_b32 s26, 1, 0
L_k2_nomode:
  s_cmp_eq_u32 s24, 0
  s_cbranch_scc1 L_sp_o_2_p
  s_add_u32 s33, s66, 16384
  buffer_load_dwordx4 a[76:79], v2, s[52:55], s33 offen offset:3072
  s_add_u32 s33, s66, 20480
  buffer_load_dwordx4 a[80:83], v2, s[52:55], s33 offen offset:0
  s_add_u32 s33, s66, 20480
  buffer_load_dwordx4 a[84:87], v2, s[52:55], s33 offen offset:1024
  s_add_u32 s33, s66, 20480
  buffer_load_dwordx4 a[88:91], v2, s[52:55], s33 offen offset:2048
  s_add_u32 s33, s66, 20480
  buffer_load_dwordx4 a[92:95], v2, s[52:55], s33 offen offset:3072
  s_add_u32 s33, s66, 24576
  buffer_load_dwordx4 a[96:99], v2, s[52:55], s33 offen offset:0
  buffer_load_dwordx2 v[204:205], v21, s[76:79], 0 offen offset:2592
  buffer_load_dwordx2 v[206:207], v21, s[76:79], 0 offen offset:2624
  buffer_load_dwordx2 v[208:209], v21, s[76:79], 0 offen offset:2656
  buffer_load_dwordx2 v[210:211], v21, s[76:79], 0 offen offset:2688
  buffer_load_dwordx2 v[212:213], v22, s[76:79], 0 offen offset:1024
  buffer_load_dwordx2 v[214:215], v22, s[76:79], 0 offen offset:1056
  buffer_load_dwordx2 v[216:217], v22, s[76:79], 0 offen offset:1088
  buffer_load_dwordx2 v[218:219], v22, s[76:79], 0 offen offset:1120
  buffer_load_dwordx2 v[220:221], v22, s[76:79], 0 offen offset:1152
  buffer_load_dwordx4 v[224:227], v4, s[76:79], 0 offen offset:3840
  s_waitcnt vmcnt(16)
  s_barrier
  s_cmp_gt_u32 s24, 0
  s_cselect_b32 s38, 1, 0
  s_sub_u32 s38, s24, s38
  s_mul_i32 s38, s38, 20480
  s_add_u32 s38, s38, 0
  s_add_u32 s37, s36, s38
  s_add_u32 m0, s38, 0
  s_nop 0
  buffer_load_dwordx4 v2, s[56:59], s37 offen offset:0 lds
  buffer_load_dwordx4 v2, s[56:59], s37 offen offset:1024 lds
  buffer_load_dwordx4 v2, s[56:59], s37 offen offset:2048 lds
  buffer_load_dwordx4 v2, s[56:59], s37 offen offset:3072 lds
  s_add_u32 m0, s38, 4096
  s_add_u32 s37, s37, 4096
  buffer_load_dwordx4 v2, s[56:59], s37 offen offset:0 lds
  buffer_load_dwordx4 v2, s[56:59], s37 offen offset:1024 lds
  buffer_load_dwordx4 v2, s[56:59], s37 offen offset:2048 lds
  buffer_load_dwordx4 v2, s[56:59], s37 offen offset:3072 lds
  s_add_u32 m0, s38, 8192
  s_add_u32 s37, s37, 4096
  buffer_load_dwordx4 v2, s[56:59], s37 offen offset:0 lds
  buffer_load_dwordx4 v2, s[56:59], s37 offen offset:1024 lds
  buffer_load_dwordx4 v2, s[56:59], s37 offen offset:2048 lds
  buffer_load_dwordx4 v2, s[56:59], s37 offen offset:3072 lds
  s_add_u32 m0, s38, 12288
  s_add_u32 s37, s37, 4096
  buffer_load_dwordx4 v2, s[56:59], s37 offen offset:0 lds
  buffer_load_dwordx4 v2, s[56:59], s37 offen offset:1024 lds
  buffer_load_dwordx4 v2, s[56:59], s37 offen offset:2048 lds
  buffer_load_dwordx4 v2, s[56:59], s37 offen offset:3072 lds
  s_add_u32 m0, s38, 16384
  s_add_u32 s37, s37, 4096
  buffer_load_dwordx4 v2, s[56:59], s37 offen offset:0 lds
  buffer_load_dwordx4 v2, s[56:59], s37 offen offset:1024 lds
  buffer_load_dwordx4 v2, s[56:59], s37 offen offset:2048 lds
  buffer_load_dwordx4 v2, s[56:59], s37 offen offset:3072 lds
  s_barrier
  s_branch L_sp_o_2_j
L_sp_o_2_p:
  s_waitcnt vmcnt(0)
  s_barrier
  s_add_u32 s16, s4, 0x6000
  s_addc_u32 s17, s5, 0
  s_mov_b32 s18, 0x800
  s_mov_b32 s19, 0x00020000
  s_lshl_b32 s33, s22, 2
  s_add_u32 s33, s33, s30
  v_mov_b32 v10, s33
  v_mov_b32 v11, s25
  s_mov_b64 s[40:41], exec
  s_mov_b64 exec, 1
  s_cmp_eq_u32 s26, 0
  s_cbranch_scc1 L_slow_o_3
  buffer_store_dword v11, v10, s[16:19], 0 offen
  s_branch L_slow_o_3_d
L_slow_o_3:
  buffer_wbl2 sc1
  s_waitcnt vmcnt(0)
  buffer_store_dword v11, v10, s[16:19], 0 offen sc1
L_slow_o_3_d:
  s_mov_b64 exec, s[40:41]
  v_and_b32 v8, 15, v1
  v_lshlrev_b32 v8, 2, v8
  v_add_u32 v8, s30, v8
  s_mov_b32 s42, 0
L_poll_o_4:
  buffer_load_dword v9, v8, s[16:19], 0 offen sc1
  s_waitcnt vmcnt(0)
  v_cmp_ne_u32 vcc, s25, v9
  s_add_u32 s42, s42, 1
  s_cmp_gt_u32 s42, 1048576
  s_cbranch_scc1 L_poll_o_4_done
  s_cmp_lg_u64 vcc, 0
  s_cbranch_scc1 L_poll_o_4
L_poll_o_4_done:
  s_barrier
L_sp_o_2_j:
  s_add_u32 s33, s24, 1
  s_and_b32 s33, s33, 3
  s_add_u32 s33, s33, s69
  s_mul_i32 s33, s33, 20480
  s_add_u32 s33, s33, s68
  s_mul_i32 s34, s24, 5120
  s_add_u32 s64, s33, s34
  s_add_u32 s33, s24, 2
  s_and_b32 s33, s33, 3
  s_add_u32 s33, s33, s69
  s_mul_i32 s33, s33, 20480
  s_add_u32 s33, s33, s68
  s_mul_i32 s34, s24, 5120
  s_add_u32 s65, s33, s34
  s_add_u32 s33, s24, 3
  s_and_b32 s33, s33, 3
  s_add_u32 s33, s33, s69
  s_mul_i32 s33, s33, 20480
  s_add_u32 s33, s33, s68
  s_mul_i32 s34, s24, 5120
  s_add_u32 s66, s33, s34
  s_add_u32 s33, s24, 4
  s_and_b32 s33, s33, 3
  s_add_u32 s33, s33, s69
  s_mul_i32 s33, s33, 20480
  s_add_u32 s33, s33, s68
  s_mul_i32 s34, s24, 5120
  s_add_u32 s67, s33, s34
  s_add_u32 s16, s4, 0x5000
  s_addc_u32 s17, s5, 0
  s_mov_b32 s18, 0x800
  s_mov_b32 s19, 0x00020000
  v_and_b32 v8, 15, v1
  v_lshlrev_b32 v8, 3, v8
  v_add_u32 v8, s30, v8
  s_mov_b32 s38, s24
  s_mul_i32 s38, s38, 10240
  s_add_u32 s38, s38, 61440
  s_add_u32 s37, s36, s38
  buffer_load_dwordx4 v[64:67], v2, s[44:47], s64 offen offset:0 sc1
  buffer_load_dwordx4 v[68:71], v2, s[44:47], s64 offen offset:1024 sc1
  buffer_load_dwordx4 v[72:75], v2, s[44:47], s64 offen offset:2048 sc1
  buffer_load_dwordx4 v[76:79], v2, s[44:47], s64 offen offset:3072 sc1
  s_add_u32 s64, s64, 4096
  buffer_load_dwordx4 v[80:83], v2, s[44:47], s64 offen offset:0 sc1
  buffer_load_dwordx4 v[84:87], v2, s[44:47], s65 offen offset:0 sc1
  s_waitcnt vmcnt(5)
  v_mfma_f32_16x16x32_bf16 v[144:147], a[0:3], v[64:67], 0
  buffer_load_dwordx4 v[88:91], v2, s[44:47], s65 offen offset:1024 sc1
  v_mfma_f32_16x16x32_bf16 v[148:151], a[4:7], v[64:67], 0
  v_mfma_f32_16x16x32_bf16 v[152:155], a[8:11], v[64:67], 0
  v_mfma_f32_16x16x32_bf16 v[156:159], a[12:15], v[64:67], 0
  v_mfma_f32_16x16x32_bf16 v[160:163], a[16:19], v[64:67], 0
  s_waitcnt vmcnt(5)
  v_mfma_f32_16x16x32_bf16 v[144:147], a[20:23], v[68:71], v[144:147]
  buffer_load_dwordx4 v[92:95], v2, s[44:47], s65 offen offset:2048 sc1
  v_mfma_f32_16x16x32_bf16 v[148:151], a[24:27], v[68:71], v[148:151]
  v_mfma_f32_16x16x32_bf16 v[152:155], a[28:31], v[68:71], v[152:155]
  v_mfma_f32_16x16x32_bf16 v[156:159], a[32:35], v[68:71], v[156:159]
  v_mfma_f32_16x16x32_bf16 v[160:163], a[36:39], v[68:71], v[160:163]
  s_waitcnt vmcnt(5)
  v_mfma_f32_16x16x32_bf16 v[144:147], a[40:43], v[72:75], v[144:147]
  buffer_load_dwordx4 v[64:67], v2, s[44:47], s65 offen offset:3072 sc1
  v_mfma_f32_16x16x32_bf16 v[148:151], a[44:47], v[72:75], v[148:151]
  buffer_load_dwordx2 v[18:19], v8, s[16:19], 0 offen sc1
  v_mfma_f32_16x16x32_bf16 v[152:155], a[48:51], v[72:75], v[152:155]
  v_mfma_f32_16x16x32_bf16 v[156:159], a[52:55], v[72:75], v[156:159]
  v_mfma_f32_16x16x32_bf16 v[160:163], a[56:59], v[72:75], v[160:163]
  s_waitcnt vmcnt(6)
  v_mfma_f32_16x16x32_bf16 v[144:147], a[60:63], v[76:79], v[144:147]
  s_add_u32 s65, s65, 4096
  buffer_load_dwordx4 v[68:71], v2, s[44:47], s65 offen offset:0 sc1
  v_mfma_f32_16x16x32_bf16 v[148:151], a[64:67], v[76:79], v[148:151]
  v_mfma_f32_16x16x32_bf16 v[152:155], a[68:71], v[76:79], v[152:155]
  v_mfma_f32_16x16x32_bf16 v[156:159], a[72:75], v[76:79], v[156:159]
  v_mfma_f32_16x16x32_bf16 v[160:163], a[76:79], v[76:79], v[160:163]
  s_waitcnt vmcnt(6)
  v_mfma_f32_16x16x32_bf16 v[144:147], a[80:83], v[80:83], v[144:147]
  buffer_load_dwordx4 v[72:75], v2, s[44:47], s66 offen offset:0 sc1
  v_mfma_f32_16x16x32_bf16 v[148:151], a[84:87], v[80:83], v[148:151]
  v_mfma_f32_16x16x32_bf16 v[152:155], a[88:91], v[80:83], v[152:155]
  v_mfma_f32_16x16x32_bf16 v[156:159], a[92:95], v[80:83], v[156:159]
  v_mfma_f32_16x16x32_bf16 v[160:163], a[96:99], v[80:83], v[160:163]
  s_waitcnt vmcnt(6)
  v_mfma_f32_16x16x32_bf16 v[164:167], a[0:3], v[84:87], 0
  buffer_load_dwordx4 v[76:79], v2, s[44:47], s66 offen offset:1024 sc1
  v_mfma_f32_16x16x32_bf16 v[168:171], a[4:7], v[84:87], 0
  v_mfma_f32_16x16x32_bf16 v[172:175], a[8:11], v[84:87], 0
  v_mfma_f32_16x16x32_bf16 v[176:179], a[12:15], v[84:87], 0
  v_mfma_f32_16x16x32_bf16 v[180:183], a[16:19], v[84:87], 0
  s_waitcnt vmcnt(6)
  s_add_u32 s33, s24, 1
  s_and_b32 s33, s33, 3
  s_mul_i32 s33, s33, 15360
  s_add_u32 s33, s33, 112640
  v_add_u32 v5, s33, v2
  v_mfma_f32_16x16x32_bf16 v[164:167], a[20:23], v[88:91], v[164:167]
  buffer_load_dwordx4 v[80:83], v2, s[44:47], s66 offen offset:2048 sc1
  v_mfma_f32_16x16x32_bf16 v[168:171], a[24:27], v[88:91], v[168:171]
  ds_write_b128 v5, v[144:147] offset:0
  v_mfma_f32_16x16x32_bf16 v[172:175], a[28:31], v[88:91], v[172:175]
  v_mfma_f32_16x16x32_bf16 v[176:179], a[32:35], v[88:91], v[176:179]
  v_mfma_f32_16x16x32_bf16 v[180:183], a[36:39], v[88:91], v[180:183]
  s_waitcnt vmcnt(6)
  v_mfma_f32_16x16x32_bf16 v[164:167], a[40:43], v[92:95], v[164:167]
  buffer_load_dwordx4 v[84:87], v2, s[44:47], s66 offen offset:3072 sc1
  v_mfma_f32_16x16x32_bf16 v[168:171], a[44:47], v[92:95], v[168:171]
  ds_write_b128 v5, v[148:151] offset:1024
  v_mfma_f32_16x16x32_bf16 v[172:175], a[48:51], v[92:95], v[172:175]
  v_mfma_f32_16x16x32_bf16 v[176:179], a[52:55], v[92:95], v[176:179]
  v_mfma_f32_16x16x32_bf16 v[180:183], a[56:59], v[92:95], v[180:183]
  s_waitcnt vmcnt(6)
  v_mfma_f32_16x16x32_bf16 v[164:167], a[60:63], v[64:67], v[164:167]
  s_add_u32 s66, s66, 4096
  buffer_load_dwordx4 v[88:91], v2, s[44:47], s66 offen offset:0 sc1
  v_mfma_f32_16x16x32_bf16 v[168:171], a[64:67], v[64:67], v[168:171]
  ds_write_b128 v5, v[152:155] offset:2048
  v_mfma_f32_16x16x32_bf16 v[172:175], a[68:71], v[64:67], v[172:175]
  v_mfma_f32_16x16x32_bf16 v[176:179], a[72:75], v[64:67], v[176:179]
  v_mfma_f32_16x16x32_bf16 v[180:183], a[76:79], v[64:67], v[180:183]
  s_waitcnt vmcnt(5)
  v_mfma_f32_16x16x32_bf16 v[164:167], a[80:83], v[68:71], v[164:167]
  buffer_load_dwordx4 v[92:95], v2, s[44:47], s67 offen offset:0 sc1
  v_mfma_f32_16x16x32_bf16 v[168:171], a[84:87], v[68:71], v[168:171]
  ds_write_b128 v5, v[156:159] offset:3072
  v_mfma_f32_16x16x32_bf16 v[172:175], a[88:91], v[68:71], v[172:175]
  v_mfma_f32_16x16x32_bf16 v[176:179], a[92:95], v[68:71], v[176:179]
  v_mfma_f32_16x16x32_bf16 v[180:183], a[96:99], v[68:71], v[180:183]
  ds_write_b128 v5, v[160:163] offset:4096
  s_waitcnt vmcnt(5)
  v_mfma_f32_16x16x32_bf16 v[144:147], a[0:3], v[72:75], 0
  buffer_load_dwordx4 v[64:67], v2, s[44:47], s67 offen offset:1024 sc1
  v_mfma_f32_16x16x32_bf16 v[148:151], a[4:7], v[72:75], 0
  v_mfma_f32_16x16x32_bf16 v[152:155], a[8:11], v[72:75], 0
  v_mfma_f32_16x16x32_bf16 v[156:159], a[12:15], v[72:75], 0
  v_mfma_f32_16x16x32_bf16 v[160:163], a[16:19], v[72:75], 0
  s_waitcnt vmcnt(5)
  s_add_u32 s33, s24, 2
  s_and_b32 s33, s33, 3
  s_mul_i32 s33, s33, 15360
  s_add_u32 s33, s33, 107520
  v_add_u32 v5, s33, v2
  v_mfma_f32_16x16x32_bf16 v[144:147], a[20:23], v[76:79], v[144:147]
  buffer_load_dwordx4 v[68:71], v2, s[44:47], s67 offen offset:2048 sc1
  v_mfma_f32_16x16x32_bf16 v[148:151], a[24:27], v[76:79], v[148:151]
  ds_write_b128 v5, v[164:167] offset:0
  v_mfma_f32_16x16x32_bf16 v[152:155], a[28:31], v[76:79], v[152:155]
  v_mfma_f32_16x16x32_bf16 v[156:159], a[32:35], v[76:79], v[156:159]
  v_mfma_f32_16x16x32_bf16 v[160:163], a[36:39], v[76:79], v[160:163]
  s_waitcnt vmcnt(5)
  v_mfma_f32_16x16x32_bf16 v[144:147], a[40:43], v[80:83], v[144:147]
  buffer_load_dwordx4 v[72:75], v2, s[44:47], s67 offen offset:3072 sc1
  v_mfma_f32_16x16x32_bf16 v[148:151], a[44:47], v[80:83], v[148:151]
  ds_write_b128 v5, v[168:171] offset:1024
  v_mfma_f32_16x16x32_bf16 v[152:155], a[48:51], v[80:83], v[152:155]
  v_mfma_f32_16x16x32_bf16 v[156:159], a[52:55], v[80:83], v[156:159]
  v_mfma_f32_16x16x32_bf16 v[160:163], a[56:59], v[80:83], v[160:163]
  s_waitcnt vmcnt(5)
  v_mfma_f32_16x16x32_bf16 v[144:147], a[60:63], v[84:87], v[144:147]
  s_add_u32 s67, s67, 4096
  buffer_load_dwordx4 v[76:79], v2, s[44:47], s67 offen offset:0 sc1
  v_mfma_f32_16x16x32_bf16 v[148:151], a[64:67], v[84:87], v[148:151]
  ds_write_b128 v5, v[172:175] offset:2048
  v_mfma_f32_16x16x32_bf16 v[152:155], a[68:71], v[84:87], v[152:155]
  v_mfma_f32_16x16x32_bf16 v[156:159], a[72:75], v[84:87], v[156:159]
  v_mfma_f32_16x16x32_bf16 v[160:163], a[76:79], v[84:87], v[160:163]
  s_waitcnt vmcnt(5)
  v_mfma_f32_16x16x32_bf16 v[144:147], a[80:83], v[88:91], v[144:147]
  s_add_u32 m0, s38, 0
  s_nop 0
  buffer_load_dwordx4 v2, s[56:59], s37 offen offset:0 lds
  v_mfma_f32_16x16x32_bf16 v[148:151], a[84:87], v[88:91], v[148:151]
  buffer_load_dwordx4 v2, s[56:59], s37 offen offset:1024 lds
  v_mfma_f32_16x16x32_bf16 v[152:155], a[88:91], v[88:91], v[152:155]
  ds_write_b128 v5, v[176:179] offset:3072
  v_mfma_f32_16x16x32_bf16 v[156:159], a[92:95], v[88:91], v[156:159]
  v_mfma_f32_16x16x32_bf16 v[160:163], a[96:99], v[88:91], v[160:163]
  ds_write_b128 v5, v[180:183] offset:4096
  s_waitcnt vmcnt(6)
  v_mfma_f32_16x16x32_bf16 v[164:167], a[0:3], v[92:95], 0
  buffer_load_dwordx4 v2, s[56:59], s37 offen offset:2048 lds
  v_mfma_f32_16x16x32_bf16 v[168:171], a[4:7], v[92:95], 0
  buffer_load_dwordx4 v2, s[56:59], s37 offen offset:3072 lds
  v_mfma_f32_16x16x32_bf16 v[172:175], a[8:11], v[92:95], 0
  v_mfma_f32_16x16x32_bf16 v[176:179], a[12:15], v[92:95], 0
  v_mfma_f32_16x16x32_bf16 v[180:183], a[16:19], v[92:95], 0
  s_waitcnt vmcnt(7)
  s_add_u32 s33, s24, 3
  s_and_b32 s33, s33, 3
  s_mul_i32 s33, s33, 15360
  s_add_u32 s33, s33, 102400
  v_add_u32 v5, s33, v2
  v_mfma_f32_16x16x32_bf16 v[164:167], a[20:23], v[64:67], v[164:167]
  s_add_u32 m0, s38, 4096
  s_add_u32 s37, s37, 4096
  buffer_load_dwordx4 v2, s[56:59], s37 offen offset:0 lds
  v_mfma_f32_16x16x32_bf16 v[168:171], a[24:27], v[64:67], v[168:171]
  buffer_load_dwordx4 v2, s[56:59], s37 offen offset:1024 lds
  v_mfma_f32_16x16x32_bf16 v[172:175], a[28:31], v[64:67], v[172:175]
  ds_write_b128 v5, v[144:147] offset:0
  v_mfma_f32_16x16x32_bf16 v[176:179], a[32:35], v[64:67], v[176:179]
  v_mfma_f32_16x16x32_bf16 v[180:183], a[36:39], v[64:67], v[180:183]
  s_waitcnt vmcnt(8)
  v_mfma_f32_16x16x32_bf16 v[164:167], a[40:43], v[68:71], v[164:167]
  buffer_load_dwordx4 v2, s[56:59], s37 offen offset:2048 lds
  v_mfma_f32_16x16x32_bf16 v[168:171], a[44:47], v[68:71], v[168:171]
  buffer_load_dwordx4 v2, s[56:59], s37 offen offset:3072 lds
  v_mfma_f32_16x16x32_bf16 v[172:175], a[48:51], v[68:71], v[172:175]
  ds_write_b128 v5, v[148:151] offset:1024
  v_mfma_f32_16x16x32_bf16 v[176:179], a[52:55], v[68:71], v[176:179]
  v_mfma_f32_16x16x32_bf16 v[180:183], a[56:59], v[68:71], v[180:183]
  s_waitcnt vmcnt(9)
  v_mfma_f32_16x16x32_bf16 v[164:167], a[60:63], v[72:75], v[164:167]
  s_add_u32 m0, s38, 8192
  s_add_u32 s37, s37, 4096
  buffer_load_dwordx4 v2, s[56:59], s37 offen offset:0 lds
  v_mfma_f32_16x16x32_bf16 v[168:171], a[64:67], v[72:75], v[168:171]
  buffer_load_dwordx4 v2, s[56:59], s37 offen offset:1024 lds
  v_mfma_f32_16x16x32_bf16 v[172:175], a[68:71], v[72:75], v[172:175]
  ds_write_b128 v5, v[152:155] offset:2048
  v_mfma_f32_16x16x32_bf16 v[176:179], a[72:75], v[72:75], v[176:179]
  v_mfma_f32_16x16x32_bf16 v[180:183], a[76:79], v[72:75], v[180:183]
  s_waitcnt vmcnt(10)
  v_mfma_f32_16x16x32_bf16 v[164:167], a[80:83], v[76:79], v[164:167]
  ds_write_b128 v5, v[156:159] offset:3072
  v_mfma_f32_16x16x32_bf16 v[168:171], a[84:87], v[76:79], v[168:171]
  v_mfma_f32_16x16x32_bf16 v[172:175], a[88:91], v[76:79], v[172:175]
  v_mfma_f32_16x16x32_bf16 v[176:179], a[92:95], v[76:79], v[176:179]
  v_mfma_f32_16x16x32_bf16 v[180:183], a[96:99], v[76:79], v[180:183]
  ds_write_b128 v5, v[160:163] offset:4096
  s_waitcnt lgkmcnt(0)
  s_barrier
  s_mul_i32 s33, s24, 15360
  s_add_u32 s33, s33, 102400
  v_add_u32 v5, s33, v2
  ds_read_b128 v[64:67], v5 offset:0
  ds_read_b128 v[68:71], v5 offset:1024
  ds_read_b128 v[72:75], v5 offset:2048
  ds_read_b128 v[76:79], v5 offset:3072
  ds_read_b128 v[80:83], v5 offset:4096
  ds_read_b128 v[84:87], v5 offset:5120
  ds_read_b128 v[88:91], v5 offset:6144
  ds_read_b128 v[92:95], v5 offset:7168
  ds_read_b128 v[96:99], v5 offset:8192
  ds_read_b128 v[100:103], v5 offset:9216
  ds_read_b128 v[104:107], v5 offset:10240
  ds_read_b128 v[108:111], v5 offset:11264
  ds_read_b128 v[112:115], v5 offset:12288
  ds_read_b128 v[116:119], v5 offset:13312
  ds_read_b128 v[120:123], v5 offset:14336
  s_waitcnt lgkmcnt(10)
  v_pk_add_f32 v[164:165], v[164:165], v[64:65]
  v_pk_add_f32 v[166:167], v[166:167], v[66:67]
  v_pk_add_f32 v[168:169], v[168:169], v[68:69]
  v_pk_add_f32 v[170:171], v[170:171], v[70:71]
  v_pk_add_f32 v[172:173], v[172:173], v[72:73]
  v_pk_add_f32 v[174:175], v[174:175], v[74:75]
  v_pk_add_f32 v[176:177], v[176:177], v[76:77]
  v_pk_add_f32 v[178:179], v[178:179], v[78:79]
  v_pk_add_f32 v[180:181], v[180:181], v[80:81]
  v_pk_add_f32 v[182:183], v[182:183], v[82:83]
  s_waitcnt lgkmcnt(5)
  v_pk_add_f32 v[164:165], v[164:165], v[84:85]
  v_pk_add_f32 v[166:167], v[166:167], v[86:87]
  v_pk_add_f32 v[168:169], v[168:169], v[88:89]
  v_pk_add_f32 v[170:171], v[170:171], v[90:91]
  v_pk_add_f32 v[172:173], v[172:173], v[92:93]
  v_pk_add_f32 v[174:175], v[174:175], v[94:95]
  v_pk_add_f32 v[176:177], v[176:177], v[96:97]
  v_pk_add_f32 v[178:179], v[178:179], v[98:99]
  v_pk_add_f32 v[180:181], v[180:181], v[100:101]
  v_pk_add_f32 v[182:183], v[182:183], v[102:103]
  s_waitcnt lgkmcnt(0)
  v_pk_add_f32 v[164:165], v[164:165], v[104:105]
  v_pk_add_f32 v[166:167], v[166:167], v[106:107]
  v_pk_add_f32 v[168:169], v[168:169], v[108:109]
  v_pk_add_f32 v[170:171], v[170:171], v[110:111]
  v_pk_add_f32 v[172:173], v[172:173], v[112:113]
  v_pk_add_f32 v[174:175], v[174:175], v[114:115]
  v_pk_add_f32 v[176:177], v[176:177], v[116:117]
  v_pk_add_f32 v[178:179], v[178:179], v[118:119]
  v_pk_add_f32 v[180:181], v[180:181], v[120:121]
  v_pk_add_f32 v[182:183], v[182:183], v[122:123]
  s_barrier
  v_cmp_ne_u32 vcc, s27, v19
  s_cmp_eq_u64 vcc, 0
  s_cselect_b32 s26, 1, 0
  v_lshlrev_b32 v4, 4, v0
  v_add_u32 v9, 146432, v4
  v_cmp_gt_u32 vcc, 160, v0
  s_and_saveexec_b64 s[40:41], vcc
  ds_write_b128 v9, v[224:227]
  s_mov_b64 exec, s[40:41]
  s_mov_b32 s35, 0xffff0000
  v_lshlrev_b32 v12, 16, v192
  v_and_b32 v13, s35, v192
  v_lshlrev_b32 v14, 16, v202
  v_and_b32 v15, s35, v202
  v_pk_fma_f32 v[12:13], v[164:165], v[14:15], v[12:13]
  v_cvt_pk_bf16_f32 v16, v12, v13
  v_lshlrev_b32 v32, 16, v16
  v_and_b32 v33, s35, v16
  v_lshlrev_b32 v12, 16, v193
  v_and_b32 v13, s35, v193
  v_lshlrev_b32 v14, 16, v203
  v_and_b32 v15, s35, v203
  v_pk_fma_f32 v[12:13], v[166:167], v[14:15], v[12:13]
  v_cvt_pk_bf16_f32 v16, v12, v13
  v_lshlrev_b32 v34, 16, v16
  v_and_b32 v35, s35, v16
  v_lshlrev_b32 v12, 16, v194
  v_and_b32 v13, s35, v194
  v_lshlrev_b32 v14, 16, v204
  v_and_b32 v15, s35, v204
  v_pk_fma_f32 v[12:13], v[168:169], v[14:15], v[12:13]
  v_cvt_pk_bf16_f32 v16, v12, v13
  v_lshlrev_b32 v36, 16, v16
  v_and_b32 v37, s35, v16
  v_lshlrev_b32 v12, 16, v195
  v_and_b32 v13, s35, v195
  v_lshlrev_b32 v14, 16, v205
  v_and_b32 v15, s35, v205
  v_pk_fma_f32 v[12:13], v[170:171], v[14:15], v[12:13]
  v_cvt_pk_bf16_f32 v16, v12, v13
  v_lshlrev_b32 v38, 16, v16
  v_and_b32 v39, s35, v16
  v_lshlrev_b32 v12, 16, v196
  v_and_b32 v13, s35, v196
  v_lshlrev_b32 v14, 16, v206
  v_and_b32 v15, s35, v206
  v_pk_fma_f32 v[12:13], v[172:173], v[14:15], v[12:13]
  v_cvt_pk_bf16_f32 v16, v12, v13
  v_lshlrev_b32 v40, 16, v16
  v_and_b32 v41, s35, v16
  v_lshlrev_b32 v12, 16, v197
  v_and_b32 v13, s35, v197
  v_lshlrev_b32 v14, 16, v207
  v_and_b32 v15, s35, v207
  v_pk_fma_f32 v[12:13], v[174:175], v[14:15], v[12:13]
  v_cvt_pk_bf16_f32 v16, v12, v13
  v_lshlrev_b32 v42, 16, v16
  v_and_b32 v43, s35, v16
  v_lshlrev_b32 v12, 16, v198
  v_and_b32 v13, s35, v198
  v_lshlrev_b32 v14, 16, v208
  v_and_b32 v15, s35, v208
  v_pk_fma_f32 v[12:13], v[176:177], v[14:15], v[12:13]
  v_cvt_pk_bf16_f32 v16, v12, v13
  v_lshlrev_b32 v44, 16, v16
  v_and_b32 v45, s35, v16
  v_lshlrev_b32 v12, 16, v199
  v_and_b32 v13, s35, v199
  v_lshlrev_b32 v14, 16, v209
  v_and_b32 v15, s35, v209
  v_pk_fma_f32 v[12:13], v[178:179], v[14:15], v[12:13]
  v_cvt_pk_bf16_f32 v16, v12, v13
  v_lshlrev_b32 v46, 16, v16
  v_and_b32 v47, s35, v16
  v_lshlrev_b32 v12, 16, v200
  v_and_b32 v13, s35, v200
  v_lshlrev_b32 v14, 16, v210
  v_and_b32 v15, s35, v210
  v_pk_fma_f32 v[12:13], v[180:181], v[14:15], v[12:13]
  v_cvt_pk_bf16_f32 v16, v12, v13
  v_lshlrev_b32 v48, 16, v16
  v_and_b32 v49, s35, v16
  v_lshlrev_b32 v12, 16, v201
  v_and_b32 v13, s35, v201
  v_lshlrev_b32 v14, 16, v211
  v_and_b32 v15, s35, v211
  v_pk_fma_f32 v[12:13], v[182:183], v[14:15], v[12:13]
  v_cvt_pk_bf16_f32 v16, v12, v13
  v_lshlrev_b32 v50, 16, v16
  v_and_b32 v51, s35, v16
  v_lshlrev_b32 v14, 16, v212
  v_and_b32 v15, s35, v212
  v_pk_mul_f32 v[12:13], v[32:33], v[14:15]
  v_cvt_pk_bf16_f32 v64, v12, v13
  v_lshlrev_b32 v14, 16, v213
  v_and_b32 v15, s35, v213
  v_pk_mul_f32 v[12:13], v[34:35], v[14:15]
  v_cvt_pk_bf16_f32 v65, v12, v13
  v_lshlrev_b32 v14, 16, v214
  v_and_b32 v15, s35, v214
  v_pk_mul_f32 v[12:13], v[36:37], v[14:15]
  v_cvt_pk_bf16_f32 v66, v12, v13
  v_lshlrev_b32 v14, 16, v215
  v_and_b32 v15, s35, v215
  v_pk_mul_f32 v[12:13], v[38:39], v[14:15]
  v_cvt_pk_bf16_f32 v67, v12, v13
  v_lshlrev_b32 v14, 16, v216
  v_and_b32 v15, s35, v216
  v_pk_mul_f32 v[12:13], v[40:41], v[14:15]
  v_cvt_pk_bf16_f32 v68, v12, v13
  v_lshlrev_b32 v14, 16, v217
  v_and_b32 v15, s35, v217
  v_pk_mul_f32 v[12:13], v[42:43], v[14:15]
  v_cvt_pk_bf16_f32 v69, v12, v13
  v_lshlrev_b32 v14, 16, v218
  v_and_b32 v15, s35, v218
  v_pk_mul_f32 v[12:13], v[44:45], v[14:15]
  v_cvt_pk_bf16_f32 v70, v12, v13
  v_lshlrev_b32 v14, 16, v219
  v_and_b32 v15, s35, v219
  v_pk_mul_f32 v[12:13], v[46:47], v[14:15]
  v_cvt_pk_bf16_f32 v71, v12, v13
  v_lshlrev_b32 v14, 16, v220
  v_and_b32 v15, s35, v220
  v_pk_mul_f32 v[12:13], v[48:49], v[14:15]
  v_cvt_pk_bf16_f32 v72, v12, v13
  v_lshlrev_b32 v14, 16, v221
  v_and_b32 v15, s35, v221
  v_pk_mul_f32 v[12:13], v[50:51], v[14:15]
  v_cvt_pk_bf16_f32 v73, v12, v13
  s_add_u32 s33, s69, s24
  s_mul_i32 s33, s33, 21504
  s_add_u32 s33, s33, s68
  s_add_u32 s33, s33, 483328
  s_mul_i32 s34, s28, 5
  s_add_u32 s34, s34, 0
  s_lshr_b32 s37, s34, 1
  s_lshl_b32 s37, s37, 10
  s_and_b32 s34, s34, 1
  s_lshl_b32 s34, s34, 3
  s_add_u32 s34, s34, s37
  s_add_u32 s34, s34, s33
  buffer_store_dwordx2 v[64:65], v2, s[44:47], s34 offen
  s_mul_i32 s34, s28, 5
  s_add_u32 s34, s34, 1
  s_lshr_b32 s37, s34, 1
  s_lshl_b32 s37, s37, 10
  s_and_b32 s34, s34, 1
  s_lshl_b32 s34, s34, 3
  s_add_u32 s34, s34, s37
  s_add_u32 s34, s34, s33
  buffer_store_dwordx2 v[66:67], v2, s[44:47], s34 offen
  s_mul_i32 s34, s28, 5
  s_add_u32 s34, s34, 2
  s_lshr_b32 s37, s34, 1
  s_lshl_b32 s37, s37, 10
  s_and_b32 s34, s34, 1
  s_lshl_b32 s34, s34, 3
  s_add_u32 s34, s34, s37
  s_add_u32 s34, s34, s33
  buffer_store_dwordx2 v[68:69], v2, s[44:47], s34 offen
  s_mul_i32 s34, s28, 5
  s_add_u32 s34, s34, 3
  s_lshr_b32 s37, s34, 1
  s_lshl_b32 s37, s37, 10
  s_and_b32 s34, s34, 1
  s_lshl_b32 s34, s34, 3
  s_add_u32 s34, s34, s37
  s_add_u32 s34, s34, s33
  buffer_store_dwordx2 v[70:71], v2, s[44:47], s34 offen
  s_mul_i32 s34, s28, 5
  s_add_u32 s34, s34, 4
  s_lshr_b32 s37, s34, 1
  s_lshl_b32 s37, s37, 10
  s_and_b32 s34, s34, 1
  s_lshl_b32 s34, s34, 3
  s_add_u32 s34, s34, s37
  s_add_u32 s34, s34, s33
  buffer_store_dwordx2 v[72:73], v2, s[44:47], s34 offen
  v_pk_add_f32 v[12:13], v[32:33], v[34:35]
  v_pk_add_f32 v[12:13], v[12:13], v[36:37]
  v_pk_add_f32 v[12:13], v[12:13], v[38:39]
  v_pk_add_f32 v[12:13], v[12:13], v[40:41]
  v_pk_add_f32 v[12:13], v[12:13], v[42:43]
  v_pk_add_f32 v[12:13], v[12:13], v[44:45]
  v_pk_add_f32 v[12:13], v[12:13], v[46:47]
  v_pk_add_f32 v[12:13], v[12:13], v[48:49]
  v_pk_add_f32 v[12:13], v[12:13], v[50:51]
  v_add_f32 v12, v12, v13
  v_mov_b32 v13, v12
  s_nop 1
  v_permlane16_swap_b32 v12, v13
  v_add_f32 v12, v12, v13
  v_mov_b32 v13, v12
  s_nop 1
  v_permlane32_swap_b32 v12, v13
  v_add_f32 v12, v12, v13
  v_mul_f32 v14, 0x3c4ccccd, v12
  v_pk_add_f32 v[16:17], v[32:33], v[14:15] op_sel_hi:[1,0] neg_lo:[0,1] neg_hi:[0,1]
  v_pk_mul_f32 v[18:19], v[16:17], v[16:17]
  v_pk_add_f32 v[16:17], v[34:35], v[14:15] op_sel_hi:[1,0] neg_lo:[0,1] neg_hi:[0,1]
  v_pk_fma_f32 v[18:19], v[16:17], v[16:17], v[18:19]
  v_pk_add_f32 v[16:17], v[36:37], v[14:15] op_sel_hi:[1,0] neg_lo:[0,1] neg_hi:[0,1]
  v_pk_fma_f32 v[18:19], v[16:17], v[16:17], v[18:19]
  v_pk_add_f32 v[16:17], v[38:39], v[14:15] op_sel_hi:[1,0] neg_lo:[0,1] neg_hi:[0,1]
  v_pk_fma_f32 v[18:19], v[16:17], v[16:17], v[18:19]
  v_pk_add_f32 v[16:17], v[40:41], v[14:15] op_sel_hi:[1,0] neg_lo:[0,1] neg_hi:[0,1]
  v_pk_fma_f32 v[18:19], v[16:17], v[16:17], v[18:19]
  v_pk_add_f32 v[16:17], v[42:43], v[14:15] op_sel_hi:[1,0] neg_lo:[0,1] neg_hi:[0,1]
  v_pk_fma_f32 v[18:19], v[16:17], v[16:17], v[18:19]
  v_pk_add_f32 v[16:17], v[44:45], v[14:15] op_sel_hi:[1,0] neg_lo:[0,1] neg_hi:[0,1]
  v_pk_fma_f32 v[18:19], v[16:17], v[16:17], v[18:19]
  v_pk_add_f32 v[16:17], v[46:47], v[14:15] op_sel_hi:[1,0] neg_lo:[0,1] neg_hi:[0,1]
  v_pk_fma_f32 v[18:19], v[16:17], v[16:17], v[18:19]
  v_pk_add_f32 v[16:17], v[48:49], v[14:15] op_sel_hi:[1,0] neg_lo:[0,1] neg_hi:[0,1]
  v_pk_fma_f32 v[18:19], v[16:17], v[16:17], v[18:19]
  v_pk_add_f32 v[16:17], v[50:51], v[14:15] op_sel_hi:[1,0] neg_lo:[0,1] neg_hi:[0,1]
  v_pk_fma_f32 v[18:19], v[16:17], v[16:17], v[18:19]
  v_add_f32 v13, v18, v19
  v_mov_b32 v14, v13
  s_nop 1
  v_permlane16_swap_b32 v13, v14
  v_add_f32 v13, v13, v14
  v_mov_b32 v14, v13
  s_nop 1
  v_permlane32_swap_b32 v13, v14
  v_add_f32 v13, v13, v14
  s_add_u32 s48, s4, 0x86c000
  s_addc_u32 s49, s5, 0
  s_mov_b32 s50, 0x20000
  s_mov_b32 s51, 0x00020000
  v_lshlrev_b32 v14, 6, v23
  s_lshl_b32 s33, s28, 3
  v_add_u32 v14, s33, v14
  v_cmp_gt_u32 vcc, 16, v1
  v_mov_b32 v15, 0x7ffffff0
  s_nop 0
  v_cndmask_b32 v14, v15, v14, vcc
  buffer_store_dwordx2 v[12:13], v14, s[48:51], 0 offen
  s_mul_i32 s33, s24, 73
  s_cmp_eq_u32 s24, 3
  s_cselect_b32 s34, 12, 0
  s_sub_u32 s33, s33, s34
  s_lshl_b32 s33, s33, 10
  s_mul_i32 s43, s28, 286720
  s_add_u32 s43, s43, s33
  s_cmp_eq_u32 s24, 1
  s_cbranch_scc1 L_sp_x_5_p
  s_cmp_gt_u32 s24, 1
  s_cselect_b32 s38, 1, 0
  s_sub_u32 s38, s24, s38
  s_mul_i32 s38, s38, 14336
  s_add_u32 s38, s38, 102400
  s_add_u32 s37, s36, s38
  s_add_u32 m0, s38, 0
  s_nop 0
  buffer_load_dwordx4 v2, s[56:59], s37 offen offset:0 lds
  buffer_load_dwordx4 v2, s[56:59], s37 offen offset:1024 lds
  buffer_load_dwordx4 v2, s[56:59], s37 offen offset:2048 lds
  buffer_load_dwordx4 v2, s[56:59], s37 offen offset:3072 lds
  s_add_u32 m0, s38, 4096
  s_add_u32 s37, s37, 4096
  buffer_load_dwordx4 v2, s[56:59], s37 offen offset:0 lds
  buffer_load_dwordx4 v2, s[56:59], s37 offen offset:1024 lds
  buffer_load_dwordx4 v2, s[56:59], s37 offen offset:2048 lds
  buffer_load_dwordx4 v2, s[56:59], s37 offen offset:3072 lds
  s_add_u32 m0, s38, 8192
  s_add_u32 s37, s37, 4096
  buffer_load_dwordx4 v2, s[56:59], s37 offen offset:0 lds
  buffer_load_dwordx4 v2, s[56:59], s37 offen offset:1024 lds
  buffer_load_dwordx4 v2, s[56:59], s37 offen offset:2048 lds
  buffer_load_dwordx4 v2, s[56:59], s37 offen offset:3072 lds
  s_add_u32 m0, s38, 12288
  s_add_u32 s37, s37, 4096
  buffer_load_dwordx4 v2, s[56:59], s37 offen offset:0 lds
  buffer_load_dwordx4 v2, s[56:59], s37 offen offset:1024 lds
  s_waitcnt vmcnt(14)
  s_barrier
  s_barrier
  s_branch L_sp_x_5_j
L_sp_x_5_p:
  s_waitcnt vmcnt(0)
  s_barrier
  s_add_u32 s16, s4, 0x7000
  s_addc_u32 s17, s5, 0
  s_mov_b32 s18, 0x800
  s_mov_b32 s19, 0x00020000
  s_lshl_b32 s33, s22, 2
  s_add_u32 s33, s33, s30
  v_mov_b32 v10, s33
  v_mov_b32 v11, s25
  s_mov_b64 s[40:41], exec
  s_mov_b64 exec, 1
  s_cmp_eq_u32 s26, 0
  s_cbranch_scc1 L_slow_x_6
  buffer_store_dword v11, v10, s[16:19], 0 offen
  s_branch L_slow_x_6_d
L_slow_x_6:
  buffer_wbl2 sc1
  s_waitcnt vmcnt(0)
  buffer_store_dword v11, v10, s[16:19], 0 offen sc1
L_slow_x_6_d:
  s_mov_b64 exec, s[40:41]
  v_and_b32 v8, 15, v1
  v_lshlrev_b32 v8, 2, v8
  v_add_u32 v8, s30, v8
  s_mov_b32 s42, 0
L_poll_x_7:
  buffer_load_dword v9, v8, s[16:19], 0 offen sc1
  s_waitcnt vmcnt(0)
  v_cmp_ne_u32 vcc, s25, v9
  s_add_u32 s42, s42, 1
  s_cmp_gt_u32 s42, 1048576
  s_cbranch_scc1 L_poll_x_7_done
  s_cmp_lg_u64 vcc, 0
  s_cbranch_scc1 L_poll_x_7
L_poll_x_7_done:
  s_barrier
L_sp_x_5_j:
  s_lshl_b32 s34, s24, 1
  s_mul_i32 s64, s34, 21504
  s_add_u32 s64, s64, s68
  s_add_u32 s64, s64, 483328
  s_add_u32 s65, s64, 21504
  s_lshl_b32 s33, s23, 3
  s_add_u32 s33, s33, s34
  buffer_load_dwordx4 v[176:179], v2, s[44:47], s64 offen offset:0 sc1
  buffer_load_dwordx4 v[180:183], v2, s[44:47], s65 offen offset:0 sc1
  buffer_load_dwordx4 v[184:187], v2, s[44:47], s64 offen offset:1024 sc1
  buffer_load_dwordx4 v[188:191], v2, s[44:47], s65 offen offset:1024 sc1
  buffer_load_dwordx4 v[192:195], v2, s[44:47], s64 offen offset:2048 sc1
  buffer_load_dwordx4 v[196:199], v2, s[44:47], s65 offen offset:2048 sc1
  s_add_u32 s48, s4, 0x86c000
  s_addc_u32 s49, s5, 0
  s_mov_b32 s50, 0x20000
  s_mov_b32 s51, 0x00020000
  v_and_b32 v5, 15, v1
  v_lshrrev_b32 v6, 4, v1
  s_lshl_b32 s33, s33, 4
  v_add_u32 v7, s33, v5
  v_lshlrev_b32 v7, 6, v7
  v_lshl_add_u32 v7, v6, 4, v7
  s_mov_b32 s52, s10
  s_mov_b32 s53, s11
  s_mov_b32 s54, 0xd80
  s_mov_b32 s55, 0x00020000
  s_add_u32 s33, s31, s24
  s_lshl_b32 s33, s33, 5
  v_lshl_add_u32 v8, v6, 3, s33
  v_mov_b32 v3, v2
  v_add_u32 v4, 65536, v2
  v_add_u32 v5, 131072, v2
  v_and_b32 v9, 1, v1
  v_xor_b32 v9, 1, v9
  v_mul_u32_u24 v9, 1280, v9
  v_lshl_add_u32 v9, v6, 3, v9
  v_add_u32 v9, 146432, v9
  s_waitcnt vmcnt(6)
  s_waitcnt lgkmcnt(0)
  s_barrier
  ds_read_b128 v[120:123], v3 offset:0
  ds_read_b128 v[124:127], v3 offset:20480
  ds_read_b128 v[128:131], v3 offset:40960
  ds_read_b128 v[132:135], v3 offset:61440
  ds_read_b128 v[136:139], v4 offset:16384
  ds_read_b128 v[140:143], v4 offset:36864
  ds_read_b128 v[144:147], v4 offset:57344
  ds_read_b64 v[24:25], v9 offset:0
  ds_read_b64 v[26:27], v9 offset:32
  s_mul_i32 s33, s24, 20480
  v_add_u32 v16, s33, v2
  v_add_u32 v17, 81920, v16
  ds_read_b128 v[240:243], v16 offset:0
  ds_read_b128 v[244:247], v17 offset:0
  s_waitcnt vmcnt(4)
  s_waitcnt lgkmcnt(10)
  v_mfma_f32_16x16x32_bf16 v[64:67], v[120:123], v[176:179], 0
  ds_read_b128 v[148:151], v3 offset:1024
  v_mfma_f32_16x16x32_bf16 v[68:71], v[120:123], v[180:183], 0
  buffer_load_dwordx4 v[200:203], v2, s[44:47], s64 offen offset:3072 sc1
  s_waitcnt lgkmcnt(10)
  v_mfma_f32_16x16x32_bf16 v[72:75], v[124:127], v[176:179], 0
  ds_read_b128 v[152:155], v3 offset:21504
  v_mfma_f32_16x16x32_bf16 v[76:79], v[124:127], v[180:183], 0
  buffer_load_dwordx4 v[204:207], v2, s[44:47], s65 offen offset:3072 sc1
  s_waitcnt lgkmcnt(10)
  v_mfma_f32_16x16x32_bf16 v[80:83], v[128:131], v[176:179], 0
  ds_read_b128 v[156:159], v3 offset:41984
  v_mfma_f32_16x16x32_bf16 v[84:87], v[128:131], v[180:183], 0
  buffer_load_dwordx4 v[52:55], v7, s[48:51], 0 offen sc1
  s_waitcnt lgkmcnt(10)
  v_mfma_f32_16x16x32_bf16 v[88:91], v[132:135], v[176:179], 0
  ds_read_b128 v[160:163], v3 offset:62464
  v_mfma_f32_16x16x32_bf16 v[92:95], v[132:135], v[180:183], 0
  s_add_u32 s33, s43, 0
  buffer_load_dwordx4 a[0:3], v2, s[60:63], s33 offen offset:0
  s_waitcnt lgkmcnt(10)
  v_mfma_f32_16x16x32_bf16 v[96:99], v[136:139], v[176:179], 0
  ds_read_b128 v[164:167], v4 offset:17408
  v_mfma_f32_16x16x32_bf16 v[100:103], v[136:139], v[180:183], 0
  s_waitcnt lgkmcnt(10)
  v_mfma_f32_16x16x32_bf16 v[104:107], v[140:143], v[176:179], 0
  ds_read_b128 v[168:171], v4 offset:37888
  v_mfma_f32_16x16x32_bf16 v[108:111], v[140:143], v[180:183], 0
  s_waitcnt lgkmcnt(10)
  v_mfma_f32_16x16x32_bf16 v[112:115], v[144:147], v[176:179], 0
  ds_read_b128 v[172:175], v4 offset:58368
  v_mfma_f32_16x16x32_bf16 v[116:119], v[144:147], v[180:183], 0
  s_waitcnt lgkmcnt(7)
  v_mfma_f32_16x16x32_bf16 v[224:227], v[240:243], v[24:27], 0
  ds_read_b64 v[28:29], v9 offset:64
  ds_read_b64 v[30:31], v9 offset:96
  v_mfma_f32_16x16x32_bf16 v[228:231], v[244:247], v[24:27], 0
  ds_read_b128 v[248:251], v16 offset:1024
  ds_read_b128 v[252:255], v17 offset:1024
  s_waitcnt vmcnt(6)
  s_waitcnt lgkmcnt(10)
  v_mfma_f32_16x16x32_bf16 v[64:67], v[148:151], v[184:187], v[64:67]
  ds_read_b128 v[120:123], v3 offset:2048
  v_mfma_f32_16x16x32_bf16 v[68:71], v[148:151], v[188:191], v[68:71]
  s_add_u32 s64, s64, 4096
  buffer_load_dwordx4 v[208:211], v2, s[44:47], s64 offen offset:0 sc1
  s_waitcnt lgkmcnt(10)
  v_mfma_f32_16x16x32_bf16 v[72:75], v[152:155], v[184:187], v[72:75]
  ds_read_b128 v[124:127], v3 offset:22528
  v_mfma_f32_16x16x32_bf16 v[76:79], v[152:155], v[188:191], v[76:79]
  s_add_u32 s65, s65, 4096
  buffer_load_dwordx4 v[212:215], v2, s[44:47], s65 offen offset:0 sc1
  s_waitcnt lgkmcnt(10)
  v_mfma_f32_16x16x32_bf16 v[80:83], v[156:159], v[184:187], v[80:83]
  ds_read_b128 v[128:131], v3 offset:43008
  v_mfma_f32_16x16x32_bf16 v[84:87], v[156:159], v[188:191], v[84:87]
  buffer_load_dwordx4 v[56:59], v7, s[48:51], 0 offen offset:1024 sc1
  s_waitcnt lgkmcnt(10)
  v_mfma_f32_16x16x32_bf16 v[88:91], v[160:163], v[184:187], v[88:91]
  ds_read_b128 v[132:135], v3 offset:63488
  v_mfma_f32_16x16x32_bf16 v[92:95], v[160:163], v[188:191], v[92:95]
  s_add_u32 s33, s43, 0
  buffer_load_dwordx4 a[4:7], v2, s[60:63], s33 offen offset:1024
  s_waitcnt lgkmcnt(10)
  v_mfma_f32_16x16x32_bf16 v[96:99], v[164:167], v[184:187], v[96:99]
  ds_read_b128 v[136:139], v4 offset:18432
  v_mfma_f32_16x16x32_bf16 v[100:103], v[164:167], v[188:191], v[100:103]
  s_add_u32 s33, s43, 0
  buffer_load_dwordx4 a[8:11], v2, s[60:63], s33 offen offset:2048
  s_waitcnt lgkmcnt(10)
  v_mfma_f32_16x16x32_bf16 v[104:107], v[168:171], v[184:187], v[104:107]
  ds_read_b128 v[140:143], v4 offset:38912
  v_mfma_f32_16x16x32_bf16 v[108:111], v[168:171], v[188:191], v[108:111]
  s_waitcnt lgkmcnt(10)
  v_mfma_f32_16x16x32_bf16 v[112:115], v[172:175], v[184:187], v[112:115]
  ds_read_b128 v[144:147], v4 offset:59392
  v_mfma_f32_16x16x32_bf16 v[116:119], v[172:175], v[188:191], v[116:119]
  s_waitcnt lgkmcnt(7)
  v_mfma_f32_16x16x32_bf16 v[224:227], v[248:251], v[28:31], v[224:227]
  ds_read_b64 v[24:25], v9 offset:128
  ds_read_b64 v[26:27], v9 offset:160
  v_mfma_f32_16x16x32_bf16 v[228:231], v[252:255], v[28:31], v[228:231]
  ds_read_b128 v[240:243], v16 offset:2048
  ds_read_b128 v[244:247], v17 offset:2048
  s_waitcnt vmcnt(9)
  s_waitcnt lgkmcnt(10)
  v_mfma_f32_16x16x32_bf16 v[64:67], v[120:123], v[192:195], v[64:67]
  ds_read_b128 v[148:151], v3 offset:3072
  v_mfma_f32_16x16x32_bf16 v[68:71], v[120:123], v[196:199], v[68:71]
  buffer_load_dwordx4 v[216:219], v2, s[44:47], s64 offen offset:1024 sc1
  s_waitcnt lgkmcnt(10)
  v_mfma_f32_16x16x32_bf16 v[72:75], v[124:127], v[192:195], v[72:75]
  ds_read_b128 v[152:155], v3 offset:23552
  v_mfma_f32_16x16x32_bf16 v[76:79], v[124:127], v[196:199], v[76:79]
  buffer_load_dwordx4 v[220:223], v2, s[44:47], s65 offen offset:1024 sc1
  s_waitcnt lgkmcnt(10)
  v_mfma_f32_16x16x32_bf16 v[80:83], v[128:131], v[192:195], v[80:83]
  ds_read_b128 v[156:159], v3 offset:44032
  v_mfma_f32_16x16x32_bf16 v[84:87], v[128:131], v[196:199], v[84:87]
  buffer_load_dwordx2 v[60:61], v8, s[52:55], 0 offen
  s_waitcnt lgkmcnt(10)
  v_mfma_f32_16x16x32_bf16 v[88:91], v[132:135], v[192:195], v[88:91]
  ds_read_b128 v[160:163], v3 offset:64512
  v_mfma_f32_16x16x32_bf16 v[92:95], v[132:135], v[196:199], v[92:95]
  s_add_u32 s33, s43, 0
  buffer_load_dwordx4 a[12:15], v2, s[60:63], s33 offen offset:3072
  s_waitcnt lgkmcnt(10)
  v_mfma_f32_16x16x32_bf16 v[96:99], v[136:139], v[192:195], v[96:99]
  ds_read_b128 v[164:167], v4 offset:19456
  v_mfma_f32_16x16x32_bf16 v[100:103], v[136:139], v[196:199], v[100:103]
  s_waitcnt lgkmcnt(10)
  v_mfma_f32_16x16x32_bf16 v[104:107], v[140:143], v[192:195], v[104:107]
  ds_read_b128 v[168:171], v4 offset:39936
  v_mfma_f32_16x16x32_bf16 v[108:111], v[140:143], v[196:199], v[108:111]
  s_waitcnt lgkmcnt(10)
  v_mfma_f32_16x16x32_bf16 v[112:115], v[144:147], v[192:195], v[112:115]
  ds_read_b128 v[172:175], v4 offset:60416
  v_mfma_f32_16x16x32_bf16 v[116:119], v[144:147], v[196:199], v[116:119]
  s_waitcnt lgkmcnt(7)
  v_mfma_f32_16x16x32_bf16 v[224:227], v[240:243], v[24:27], v[224:227]
  ds_read_b64 v[28:29], v9 offset:192
  ds_read_b64 v[30:31], v9 offset:224
  v_mfma_f32_16x16x32_bf16 v[228:231], v[244:247], v[24:27], v[228:231]
  ds_read_b128 v[248:251], v16 offset:3072
  ds_read_b128 v[252:255], v17 offset:3072
  s_waitcnt vmcnt(11)
  s_waitcnt lgkmcnt(10)
  v_mfma_f32_16x16x32_bf16 v[64:67], v[148:151], v[200:203], v[64:67]
  ds_read_b128 v[120:123], v3 offset:4096
  v_mfma_f32_16x16x32_bf16 v[68:71], v[148:151], v[204:207], v[68:71]
  buffer_load_dwordx4 v[176:179], v2, s[44:47], s64 offen offset:2048 sc1
  s_waitcnt lgkmcnt(10)
  v_mfma_f32_16x16x32_bf16 v[72:75], v[152:155], v[200:203], v[72:75]
  ds_read_b128 v[124:127], v3 offset:24576
  v_mfma_f32_16x16x32_bf16 v[76:79], v[152:155], v[204:207], v[76:79]
  buffer_load_dwordx4 v[180:183], v2, s[44:47], s65 offen offset:2048 sc1
  s_waitcnt lgkmcnt(10)
  v_mfma_f32_16x16x32_bf16 v[80:83], v[156:159], v[200:203], v[80:83]
  ds_read_b128 v[128:131], v3 offset:45056
  v_mfma_f32_16x16x32_bf16 v[84:87], v[156:159], v[204:207], v[84:87]
  buffer_load_dwordx2 v[62:63], v8, s[52:55], 0 offen offset:128
  s_waitcnt lgkmcnt(10)
  v_mfma_f32_16x16x32_bf16 v[88:91], v[160:163], v[200:203], v[88:91]
  ds_read_b128 v[132:135], v4 offset:0
  v_mfma_f32_16x16x32_bf16 v[92:95], v[160:163], v[204:207], v[92:95]
  s_add_u32 s33, s43, 4096
  buffer_load_dwordx4 a[16:19], v2, s[60:63], s33 offen offset:0
  s_waitcnt lgkmcnt(10)
  v_mfma_f32_16x16x32_bf16 v[96:99], v[164:167], v[200:203], v[96:99]
  ds_read_b128 v[136:139], v4 offset:20480
  v_mfma_f32_16x16x32_bf16 v[100:103], v[164:167], v[204:207], v[100:103]
  s_add_u32 s33, s43, 4096
  buffer_load_dwordx4 a[20:23], v2, s[60:63], s33 offen offset:1024
  s_waitcnt lgkmcnt(10)
  v_mfma_f32_16x16x32_bf16 v[104:107], v[168:171], v[200:203], v[104:107]
  ds_read_b128 v[140:143], v4 offset:40960
  v_mfma_f32_16x16x32_bf16 v[108:111], v[168:171], v[204:207], v[108:111]
  s_waitcnt lgkmcnt(10)
  v_mfma_f32_16x16x32_bf16 v[112:115], v[172:175], v[200:203], v[112:115]
  ds_read_b128 v[144:147], v4 offset:61440
  v_mfma_f32_16x16x32_bf16 v[116:119], v[172:175], v[204:207], v[116:119]
  s_waitcnt lgkmcnt(7)
  v_mfma_f32_16x16x32_bf16 v[224:227], v[248:251], v[28:31], v[224:227]
  ds_read_b64 v[24:25], v9 offset:256
  ds_read_b64 v[26:27], v9 offset:288
  v_mfma_f32_16x16x32_bf16 v[228:231], v[252:255], v[28:31], v[228:231]
  ds_read_b128 v[240:243], v16 offset:4096
  ds_read_b128 v[244:247], v17 offset:4096
  s_waitcnt vmcnt(12)
  s_waitcnt lgkmcnt(10)
  v_mfma_f32_16x16x32_bf16 v[64:67], v[120:123], v[208:211], v[64:67]
  ds_read_b128 v[148:151], v3 offset:5120
  v_mfma_f32_16x16x32_bf16 v[68:71], v[120:123], v[212:215], v[68:71]
  buffer_load_dwordx4 v[184:187], v2, s[44:47], s64 offen offset:3072 sc1
  s_waitcnt lgkmcnt(10)
  v_mfma_f32_16x16x32_bf16 v[72:75], v[124:127], v[208:211], v[72:75]
  ds_read_b128 v[152:155], v3 offset:25600
  v_mfma_f32_16x16x32_bf16 v[76:79], v[124:127], v[212:215], v[76:79]
  buffer_load_dwordx4 v[188:191], v2, s[44:47], s65 offen offset:3072 sc1
  s_waitcnt lgkmcnt(10)
  v_mfma_f32_16x16x32_bf16 v[80:83], v[128:131], v[208:211], v[80:83]
  ds_read_b128 v[156:159], v3 offset:46080
  v_mfma_f32_16x16x32_bf16 v[84:87], v[128:131], v[212:215], v[84:87]
  s_add_u32 s33, s43, 4096
  buffer_load_dwordx4 a[24:27], v2, s[60:63], s33 offen offset:2048
  s_waitcnt lgkmcnt(10)
  v_mfma_f32_16x16x32_bf16 v[88:91], v[132:135], v[208:211], v[88:91]
  ds_read_b128 v[160:163], v4 offset:1024
  v_mfma_f32_16x16x32_bf16 v[92:95], v[132:135], v[212:215], v[92:95]
  s_waitcnt lgkmcnt(10)
  v_mfma_f32_16x16x32_bf16 v[96:99], v[136:139], v[208:211], v[96:99]
  ds_read_b128 v[164:167], v4 offset:21504
  v_mfma_f32_16x16x32_bf16 v[100:103], v[136:139], v[212:215], v[100:103]
  s_waitcnt lgkmcnt(10)
  v_mfma_f32_16x16x32_bf16 v[104:107], v[140:143], v[208:211], v[104:107]
  ds_read_b128 v[168:171], v4 offset:41984
  v_mfma_f32_16x16x32_bf16 v[108:111], v[140:143], v[212:215], v[108:111]
  s_waitcnt lgkmcnt(10)
  v_mfma_f32_16x16x32_bf16 v[112:115], v[144:147], v[208:211], v[112:115]
  ds_read_b128 v[172:175], v4 offset:62464
  v_mfma_f32_16x16x32_bf16 v[116:119], v[144:147], v[212:215], v[116:119]
  s_waitcnt lgkmcnt(7)
  v_mfma_f32_16x16x32_bf16 v[224:227], v[240:243], v[24:27], v[224:227]
  ds_read_b64 v[28:29], v9 offset:320
  ds_read_b64 v[30:31], v9 offset:352
  v_mfma_f32_16x16x32_bf16 v[228:231], v[244:247], v[24:27], v[228:231]
  ds_read_b128 v[248:251], v16 offset:5120
  ds_read_b128 v[252:255], v17 offset:5120
  s_waitcnt vmcnt(10)
  s_waitcnt lgkmcnt(10)
  v_mfma_f32_16x16x32_bf16 v[64:67], v[148:151], v[216:219], v[64:67]
  ds_read_b128 v[120:123], v3 offset:6144
  v_mfma_f32_16x16x32_bf16 v[68:71], v[148:151], v[220:223], v[68:71]
  s_add_u32 s64, s64, 4096
  buffer_load_dwordx4 v[192:195], v2, s[44:47], s64 offen offset:0 sc1
  s_waitcnt lgkmcnt(10)
  v_mfma_f32_16x16x32_bf16 v[72:75], v[152:155], v[216:219], v[72:75]
  ds_read_b128 v[124:127], v3 offset:26624
  v_mfma_f32_16x16x32_bf16 v[76:79], v[152:155], v[220:223], v[76:79]
  s_add_u32 s65, s65, 4096
  buffer_load_dwordx4 v[196:199], v2, s[44:47], s65 offen offset:0 sc1
  s_waitcnt lgkmcnt(10)
  v_mfma_f32_16x16x32_bf16 v[80:83], v[156:159], v[216:219], v[80:83]
  ds_read_b128 v[128:131], v3 offset:47104
  v_mfma_f32_16x16x32_bf16 v[84:87], v[156:159], v[220:223], v[84:87]
  s_add_u32 s33, s43, 4096
  buffer_load_dwordx4 a[28:31], v2, s[60:63], s33 offen offset:3072
  s_waitcnt lgkmcnt(10)
  v_mfma_f32_16x16x32_bf16 v[88:91], v[160:163], v[216:219], v[88:91]
  ds_read_b128 v[132:135], v4 offset:2048
  v_mfma_f32_16x16x32_bf16 v[92:95], v[160:163], v[220:223], v[92:95]
  s_add_u32 s33, s43, 8192
  buffer_load_dwordx4 a[32:35], v2, s[60:63], s33 offen offset:0
  s_waitcnt lgkmcnt(10)
  v_mfma_f32_16x16x32_bf16 v[96:99], v[164:167], v[216:219], v[96:99]
  ds_read_b128 v[136:139], v4 offset:22528
  v_mfma_f32_16x16x32_bf16 v[100:103], v[164:167], v[220:223], v[100:103]
  s_waitcnt lgkmcnt(10)
  v_mfma_f32_16x16x32_bf16 v[104:107], v[168:171], v[216:219], v[104:107]
  ds_read_b128 v[140:143], v4 offset:43008
  v_mfma_f32_16x16x32_bf16 v[108:111], v[168:171], v[220:223], v[108:111]
  s_waitcnt lgkmcnt(10)
  v_mfma_f32_16x16x32_bf16 v[112:115], v[172:175], v[216:219], v[112:115]
  ds_read_b128 v[144:147], v4 offset:63488
  v_mfma_f32_16x16x32_bf16 v[116:119], v[172:175], v[220:223], v[116:119]
  s_waitcnt lgkmcnt(7)
  v_mfma_f32_16x16x32_bf16 v[224:227], v[248:251], v[28:31], v[224:227]
  ds_read_b64 v[24:25], v9 offset:384
  ds_read_b64 v[26:27], v9 offset:416
  v_mfma_f32_16x16x32_bf16 v[228:231], v[252:255], v[28:31], v[228:231]
  ds_read_b128 v[240:243], v16 offset:6144
  ds_read_b128 v[244:247], v17 offset:6144
  s_waitcnt vmcnt(10)
  s_waitcnt lgkmcnt(10)
  v_mfma_f32_16x16x32_bf16 v[64:67], v[120:123], v[176:179], v[64:67]
  ds_read_b128 v[148:151], v3 offset:7168
  v_mfma_f32_16x16x32_bf16 v[68:71], v[120:123], v[180:183], v[68:71]
  buffer_load_dwordx4 v[200:203], v2, s[44:47], s64 offen offset:1024 sc1
  s_waitcnt lgkmcnt(10)
  v_mfma_f32_16x16x32_bf16 v[72:75], v[124:127], v[176:179], v[72:75]
  ds_read_b128 v[152:155], v3 offset:27648
  v_mfma_f32_16x16x32_bf16 v[76:79], v[124:127], v[180:183], v[76:79]
  buffer_load_dwordx4 v[204:207], v2, s[44:47], s65 offen offset:1024 sc1
  s_waitcnt lgkmcnt(10)
  v_mfma_f32_16x16x32_bf16 v[80:83], v[128:131], v[176:179], v[80:83]
  ds_read_b128 v[156:159], v3 offset:48128
  v_mfma_f32_16x16x32_bf16 v[84:87], v[128:131], v[180:183], v[84:87]
  s_add_u32 s33, s43, 8192
  buffer_load_dwordx4 a[36:39], v2, s[60:63], s33 offen offset:1024
  s_waitcnt lgkmcnt(10)
  v_mfma_f32_16x16x32_bf16 v[88:91], v[132:135], v[176:179], v[88:91]
  ds_read_b128 v[160:163], v4 offset:3072
  v_mfma_f32_16x16x32_bf16 v[92:95], v[132:135], v[180:183], v[92:95]
  s_waitcnt lgkmcnt(10)
  v_mfma_f32_16x16x32_bf16 v[96:99], v[136:139], v[176:179], v[96:99]
  ds_read_b128 v[164:167], v4 offset:23552
  v_mfma_f32_16x16x32_bf16 v[100:103], v[136:139], v[180:183], v[100:103]
  s_waitcnt lgkmcnt(10)
  v_mfma_f32_16x16x32_bf16 v[104:107], v[140:143], v[176:179], v[104:107]
  ds_read_b128 v[168:171], v4 offset:44032
  v_mfma_f32_16x16x32_bf16 v[108:111], v[140:143], v[180:183], v[108:111]
  s_waitcnt lgkmcnt(10)
  v_mfma_f32_16x16x32_bf16 v[112:115], v[144:147], v[176:179], v[112:115]
  ds_read_b128 v[172:175], v4 offset:64512
  v_mfma_f32_16x16x32_bf16 v[116:119], v[144:147], v[180:183], v[116:119]
  s_waitcnt lgkmcnt(7)
  v_mfma_f32_16x16x32_bf16 v[224:227], v[240:243], v[24:27], v[224:227]
  ds_read_b64 v[28:29], v9 offset:448
  ds_read_b64 v[30:31], v9 offset:480
  v_mfma_f32_16x16x32_bf16 v[228:231], v[244:247], v[24:27], v[228:231]
  ds_read_b128 v[248:251], v16 offset:7168
  ds_read_b128 v[252:255], v17 offset:7168
  s_waitcnt vmcnt(8)
  s_waitcnt lgkmcnt(10)
  v_mfma_f32_16x16x32_bf16 v[64:67], v[148:151], v[184:187], v[64:67]
  ds_read_b128 v[120:123], v3 offset:8192
  v_mfma_f32_16x16x32_bf16 v[68:71], v[148:151], v[188:191], v[68:71]
  buffer_load_dwordx4 v[208:211], v2, s[44:47], s64 offen offset:2048 sc1
  s_waitcnt lgkmcnt(10)
  v_mfma_f32_16x16x32_bf16 v[72:75], v[152:155], v[184:187], v[72:75]
  ds_read_b128 v[124:127], v3 offset:28672
  v_mfma_f32_16x16x32_bf16 v[76:79], v[152:155], v[188:191], v[76:79]
  buffer_load_dwordx4 v[212:215], v2, s[44:47], s65 offen offset:2048 sc1
  s_waitcnt lgkmcnt(10)
  v_mfma_f32_16x16x32_bf16 v[80:83], v[156:159], v[184:187], v[80:83]
  ds_read_b128 v[128:131], v3 offset:49152
  v_mfma_f32_16x16x32_bf16 v[84:87], v[156:159], v[188:191], v[84:87]
  s_add_u32 s33, s43, 8192
  buffer_load_dwordx4 a[40:43], v2, s[60:63], s33 offen offset:2048
  s_waitcnt lgkmcnt(10)
  v_mfma_f32_16x16x32_bf16 v[88:91], v[160:163], v[184:187], v[88:91]
  ds_read_b128 v[132:135], v4 offset:4096
  v_mfma_f32_16x16x32_bf16 v[92:95], v[160:163], v[188:191], v[92:95]
  s_add_u32 s33, s43, 8192
  buffer_load_dwordx4 a[44:47], v2, s[60:63], s33 offen offset:3072
  s_waitcnt lgkmcnt(10)
  v_mfma_f32_16x16x32_bf16 v[96:99], v[164:167], v[184:187], v[96:99]
  ds_read_b128 v[136:139], v4 offset:24576
  v_mfma_f32_16x16x32_bf16 v[100:103], v[164:167], v[188:191], v[100:103]
  s_waitcnt lgkmcnt(10)
  v_mfma_f32_16x16x32_bf16 v[104:107], v[168:171], v[184:187], v[104:107]
  ds_read_b128 v[140:143], v4 offset:45056
  v_mfma_f32_16x16x32_bf16 v[108:111], v[168:171], v[188:191], v[108:111]
  s_waitcnt lgkmcnt(10)
  v_mfma_f32_16x16x32_bf16 v[112:115], v[172:175], v[184:187], v[112:115]
  ds_read_b128 v[144:147], v5 offset:0
  v_mfma_f32_16x16x32_bf16 v[116:119], v[172:175], v[188:191], v[116:119]
  s_waitcnt lgkmcnt(7)
  v_mfma_f32_16x16x32_bf16 v[224:227], v[248:251], v[28:31], v[224:227]
  ds_read_b64 v[24:25], v9 offset:512
  ds_read_b64 v[26:27], v9 offset:544
  v_mfma_f32_16x16x32_bf16 v[228:231], v[252:255], v[28:31], v[228:231]
  ds_read_b128 v[240:243], v16 offset:8192
  ds_read_b128 v[244:247], v17 offset:8192
  s_waitcnt vmcnt(9)
  s_waitcnt lgkmcnt(10)
  v_mfma_f32_16x16x32_bf16 v[64:67], v[120:123], v[192:195], v[64:67]
  ds_read_b128 v[148:151], v3 offset:9216
  v_mfma_f32_16x16x32_bf16 v[68:71], v[120:123], v[196:199], v[68:71]
  buffer_load_dwordx4 v[216:219], v2, s[44:47], s64 offen offset:3072 sc1
  s_waitcnt lgkmcnt(10)
  v_mfma_f32_16x16x32_bf16 v[72:75], v[124:127], v[192:195], v[72:75]
  ds_read_b128 v[152:155], v3 offset:29696
  v_mfma_f32_16x16x32_bf16 v[76:79], v[124:127], v[196:199], v[76:79]
  buffer_load_dwordx4 v[220:223], v2, s[44:47], s65 offen offset:3072 sc1
  s_waitcnt lgkmcnt(10)
  v_mfma_f32_16x16x32_bf16 v[80:83], v[128:131], v[192:195], v[80:83]
  ds_read_b128 v[156:159], v3 offset:50176
  v_mfma_f32_16x16x32_bf16 v[84:87], v[128:131], v[196:199], v[84:87]
  s_add_u32 s33, s43, 12288
  buffer_load_dwordx4 a[48:51], v2, s[60:63], s33 offen offset:0
  s_waitcnt lgkmcnt(10)
  v_mfma_f32_16x16x32_bf16 v[88:91], v[132:135], v[192:195], v[88:91]
  ds_read_b128 v[160:163], v4 offset:5120
  v_mfma_f32_16x16x32_bf16 v[92:95], v[132:135], v[196:199], v[92:95]
  s_waitcnt lgkmcnt(10)
  v_mfma_f32_16x16x32_bf16 v[96:99], v[136:139], v[192:195], v[96:99]
  ds_read_b128 v[164:167], v4 offset:25600
  v_mfma_f32_16x16x32_bf16 v[100:103], v[136:139], v[196:199], v[100:103]
  s_waitcnt lgkmcnt(10)
  v_mfma_f32_16x16x32_bf16 v[104:107], v[140:143], v[192:195], v[104:107]
  ds_read_b128 v[168:171], v4 offset:46080
  v_mfma_f32_16x16x32_bf16 v[108:111], v[140:143], v[196:199], v[108:111]
  s_waitcnt lgkmcnt(10)
  v_mfma_f32_16x16x32_bf16 v[112:115], v[144:147], v[192:195], v[112:115]
  ds_read_b128 v[172:175], v5 offset:1024
  v_mfma_f32_16x16x32_bf16 v[116:119], v[144:147], v[196:199], v[116:119]
  s_waitcnt lgkmcnt(7)
  v_mfma_f32_16x16x32_bf16 v[224:227], v[240:243], v[24:27], v[224:227]
  ds_read_b64 v[28:29], v9 offset:576
  ds_read_b64 v[30:31], v9 offset:608
  v_mfma_f32_16x16x32_bf16 v[228:231], v[244:247], v[24:27], v[228:231]
  ds_read_b128 v[248:251], v16 offset:9216
  ds_read_b128 v[252:255], v17 offset:9216
  s_waitcnt vmcnt(8)
  s_waitcnt lgkmcnt(10)
  v_mfma_f32_16x16x32_bf16 v[64:67], v[148:151], v[200:203], v[64:67]
  ds_read_b128 v[120:123], v3 offset:10240
  v_mfma_f32_16x16x32_bf16 v[68:71], v[148:151], v[204:207], v[68:71]
  s_add_u32 s64, s64, 4096
  buffer_load_dwordx4 v[176:179], v2, s[44:47], s64 offen offset:0 sc1
  s_waitcnt lgkmcnt(10)
  v_mfma_f32_16x16x32_bf16 v[72:75], v[152:155], v[200:203], v[72:75]
  ds_read_b128 v[124:127], v3 offset:30720
  v_mfma_f32_16x16x32_bf16 v[76:79], v[152:155], v[204:207], v[76:79]
  s_add_u32 s65, s65, 4096
  buffer_load_dwordx4 v[180:183], v2, s[44:47], s65 offen offset:0 sc1
  s_waitcnt lgkmcnt(10)
  v_mfma_f32_16x16x32_bf16 v[80:83], v[156:159], v[200:203], v[80:83]
  ds_read_b128 v[128:131], v3 offset:51200
  v_mfma_f32_16x16x32_bf16 v[84:87], v[156:159], v[204:207], v[84:87]
  s_add_u32 s33, s43, 12288
  buffer_load_dwordx4 a[52:55], v2, s[60:63], s33 offen offset:1024
  s_waitcnt lgkmcnt(10)
  v_mfma_f32_16x16x32_bf16 v[88:91], v[160:163], v[200:203], v[88:91]
  ds_read_b128 v[132:135], v4 offset:6144
  v_mfma_f32_16x16x32_bf16 v[92:95], v[160:163], v[204:207], v[92:95]
  s_add_u32 s33, s43, 12288
  buffer_load_dwordx4 a[56:59], v2, s[60:63], s33 offen offset:2048
  s_waitcnt lgkmcnt(10)
  v_mfma_f32_16x16x32_bf16 v[96:99], v[164:167], v[200:203], v[96:99]
  ds_read_b128 v[136:139], v4 offset:26624
  v_mfma_f32_16x16x32_bf16 v[100:103], v[164:167], v[204:207], v[100:103]
  s_waitcnt lgkmcnt(10)
  v_mfma_f32_16x16x32_bf16 v[104:107], v[168:171], v[200:203], v[104:107]
  ds_read_b128 v[140:143], v4 offset:47104
  v_mfma_f32_16x16x32_bf16 v[108:111], v[168:171], v[204:207], v[108:111]
  s_waitcnt lgkmcnt(10)
  v_mfma_f32_16x16x32_bf16 v[112:115], v[172:175], v[200:203], v[112:115]
  ds_read_b128 v[144:147], v5 offset:2048
  v_mfma_f32_16x16x32_bf16 v[116:119], v[172:175], v[204:207], v[116:119]
  s_waitcnt lgkmcnt(7)
  v_mfma_f32_16x16x32_bf16 v[224:227], v[248:251], v[28:31], v[224:227]
  ds_read_b64 v[24:25], v9 offset:640
  ds_read_b64 v[26:27], v9 offset:672
  v_mfma_f32_16x16x32_bf16 v[228:231], v[252:255], v[28:31], v[228:231]
  ds_read_b128 v[240:243], v16 offset:10240
  ds_read_b128 v[244:247], v17 offset:10240
  s_waitcnt vmcnt(9)
  s_waitcnt lgkmcnt(10)
  v_mfma_f32_16x16x32_bf16 v[64:67], v[120:123], v[208:211], v[64:67]
  ds_read_b128 v[148:151], v3 offset:11264
  v_mfma_f32_16x16x32_bf16 v[68:71], v[120:123], v[212:215], v[68:71]
  buffer_load_dwordx4 v[184:187], v2, s[44:47], s64 offen offset:1024 sc1
  s_waitcnt lgkmcnt(10)
  v_mfma_f32_16x16x32_bf16 v[72:75], v[124:127], v[208:211], v[72:75]
  ds_read_b128 v[152:155], v3 offset:31744
  v_mfma_f32_16x16x32_bf16 v[76:79], v[124:127], v[212:215], v[76:79]
  buffer_load_dwordx4 v[188:191], v2, s[44:47], s65 offen offset:1024 sc1
  s_waitcnt lgkmcnt(10)
  v_mfma_f32_16x16x32_bf16 v[80:83], v[128:131], v[208:211], v[80:83]
  ds_read_b128 v[156:159], v3 offset:52224
  v_mfma_f32_16x16x32_bf16 v[84:87], v[128:131], v[212:215], v[84:87]
  s_add_u32 s33, s43, 12288
  buffer_load_dwordx4 a[60:63], v2, s[60:63], s33 offen offset:3072
  s_waitcnt lgkmcnt(10)
  v_mfma_f32_16x16x32_bf16 v[88:91], v[132:135], v[208:211], v[88:91]
  ds_read_b128 v[160:163], v4 offset:7168
  v_mfma_f32_16x16x32_bf16 v[92:95], v[132:135], v[212:215], v[92:95]
  s_waitcnt lgkmcnt(10)
  v_mfma_f32_16x16x32_bf16 v[96:99], v[136:139], v[208:211], v[96:99]
  ds_read_b128 v[164:167], v4 offset:27648
  v_mfma_f32_16x16x32_bf16 v[100:103], v[136:139], v[212:215], v[100:103]
  s_waitcnt lgkmcnt(10)
  v_mfma_f32_16x16x32_bf16 v[104:107], v[140:143], v[208:211], v[104:107]
  ds_read_b128 v[168:171], v4 offset:48128
  v_mfma_f32_16x16x32_bf16 v[108:111], v[140:143], v[212:215], v[108:111]
  s_waitcnt lgkmcnt(10)
  v_mfma_f32_16x16x32_bf16 v[112:115], v[144:147], v[208:211], v[112:115]
  ds_read_b128 v[172:175], v5 offset:3072
  v_mfma_f32_16x16x32_bf16 v[116:119], v[144:147], v[212:215], v[116:119]
  s_waitcnt lgkmcnt(7)
  v_mfma_f32_16x16x32_bf16 v[224:227], v[240:243], v[24:27], v[224:227]
  ds_read_b64 v[28:29], v9 offset:704
  ds_read_b64 v[30:31], v9 offset:736
  v_mfma_f32_16x16x32_bf16 v[228:231], v[244:247], v[24:27], v[228:231]
  ds_read_b128 v[248:251], v16 offset:11264
  ds_read_b128 v[252:255], v17 offset:11264
  s_waitcnt vmcnt(8)
  s_waitcnt lgkmcnt(10)
  v_mfma_f32_16x16x32_bf16 v[64:67], v[148:151], v[216:219], v[64:67]
  ds_read_b128 v[120:123], v3 offset:12288
  v_mfma_f32_16x16x32_bf16 v[68:71], v[148:151], v[220:223], v[68:71]
  buffer_load_dwordx4 v[192:195], v2, s[44:47], s64 offen offset:2048 sc1
  s_waitcnt lgkmcnt(10)
  v_mfma_f32_16x16x32_bf16 v[72:75], v[152:155], v[216:219], v[72:75]
  ds_read_b128 v[124:127], v3 offset:32768
  v_mfma_f32_16x16x32_bf16 v[76:79], v[152:155], v[220:223], v[76:79]
  buffer_load_dwordx4 v[196:199], v2, s[44:47], s65 offen offset:2048 sc1
  s_waitcnt lgkmcnt(10)
  v_mfma_f32_16x16x32_bf16 v[80:83], v[156:159], v[216:219], v[80:83]
  ds_read_b128 v[128:131], v3 offset:53248
  v_mfma_f32_16x16x32_bf16 v[84:87], v[156:159], v[220:223], v[84:87]
  s_add_u32 s33, s43, 16384
  buffer_load_dwordx4 a[64:67], v2, s[60:63], s33 offen offset:0
  s_waitcnt lgkmcnt(10)
  v_mfma_f32_16x16x32_bf16 v[88:91], v[160:163], v[216:219], v[88:91]
  ds_read_b128 v[132:135], v4 offset:8192
  v_mfma_f32_16x16x32_bf16 v[92:95], v[160:163], v[220:223], v[92:95]
  s_add_u32 s33, s43, 16384
  buffer_load_dwordx4 a[68:71], v2, s[60:63], s33 offen offset:1024
  s_waitcnt lgkmcnt(10)
  v_mfma_f32_16x16x32_bf16 v[96:99], v[164:167], v[216:219], v[96:99]
  ds_read_b128 v[136:139], v4 offset:28672
  v_mfma_f32_16x16x32_bf16 v[100:103], v[164:167], v[220:223], v[100:103]
  s_waitcnt lgkmcnt(10)
  v_mfma_f32_16x16x32_bf16 v[104:107], v[168:171], v[216:219], v[104:107]
  ds_read_b128 v[140:143], v4 offset:49152
  v_mfma_f32_16x16x32_bf16 v[108:111], v[168:171], v[220:223], v[108:111]
  s_waitcnt lgkmcnt(10)
  v_mfma_f32_16x16x32_bf16 v[112:115], v[172:175], v[216:219], v[112:115]
  ds_read_b128 v[144:147], v5 offset:4096
  v_mfma_f32_16x16x32_bf16 v[116:119], v[172:175], v[220:223], v[116:119]
  s_waitcnt lgkmcnt(7)
  v_mfma_f32_16x16x32_bf16 v[224:227], v[248:251], v[28:31], v[224:227]
  ds_read_b64 v[24:25], v9 offset:768
  ds_read_b64 v[26:27], v9 offset:800
  v_mfma_f32_16x16x32_bf16 v[228:231], v[252:255], v[28:31], v[228:231]
  ds_read_b128 v[240:243], v16 offset:12288
  ds_read_b128 v[244:247], v17 offset:12288
  s_waitcnt vmcnt(9)
  s_waitcnt lgkmcnt(10)
  v_mfma_f32_16x16x32_bf16 v[64:67], v[120:123], v[176:179], v[64:67]
  ds_read_b128 v[148:151], v3 offset:13312
  v_mfma_f32_16x16x32_bf16 v[68:71], v[120:123], v[180:183], v[68:71]
  buffer_load_dwordx4 v[200:203], v2, s[44:47], s64 offen offset:3072 sc1
  s_waitcnt lgkmcnt(10)
  v_mfma_f32_16x16x32_bf16 v[72:75], v[124:127], v[176:179], v[72:75]
  ds_read_b128 v[152:155], v3 offset:33792
  v_mfma_f32_16x16x32_bf16 v[76:79], v[124:127], v[180:183], v[76:79]
  buffer_load_dwordx4 v[204:207], v2, s[44:47], s65 offen offset:3072 sc1
  s_waitcnt lgkmcnt(10)
  v_mfma_f32_16x16x32_bf16 v[80:83], v[128:131], v[176:179], v[80:83]
  ds_read_b128 v[156:159], v3 offset:54272
  v_mfma_f32_16x16x32_bf16 v[84:87], v[128:131], v[180:183], v[84:87]
  s_add_u32 s33, s43, 16384
  buffer_load_dwordx4 a[72:75], v2, s[60:63], s33 offen offset:2048
  s_waitcnt lgkmcnt(10)
  v_mfma_f32_16x16x32_bf16 v[88:91], v[132:135], v[176:179], v[88:91]
  ds_read_b128 v[160:163], v4 offset:9216
  v_mfma_f32_16x16x32_bf16 v[92:95], v[132:135], v[180:183], v[92:95]
  s_waitcnt lgkmcnt(10)
  v_mfma_f32_16x16x32_bf16 v[96:99], v[136:139], v[176:179], v[96:99]
  ds_read_b128 v[164:167], v4 offset:29696
  v_mfma_f32_16x16x32_bf16 v[100:103], v[136:139], v[180:183], v[100:103]
  s_waitcnt lgkmcnt(10)
  v_mfma_f32_16x16x32_bf16 v[104:107], v[140:143], v[176:179], v[104:107]
  ds_read_b128 v[168:171], v4 offset:50176
  v_mfma_f32_16x16x32_bf16 v[108:111], v[140:143], v[180:183], v[108:111]
  s_waitcnt lgkmcnt(10)
  v_mfma_f32_16x16x32_bf16 v[112:115], v[144:147], v[176:179], v[112:115]
  ds_read_b128 v[172:175], v5 offset:5120
  v_mfma_f32_16x16x32_bf16 v[116:119], v[144:147], v[180:183], v[116:119]
  s_waitcnt lgkmcnt(7)
  v_mfma_f32_16x16x32_bf16 v[224:227], v[240:243], v[24:27], v[224:227]
  ds_read_b64 v[28:29], v9 offset:832
  ds_read_b64 v[30:31], v9 offset:864
  v_mfma_f32_16x16x32_bf16 v[228:231], v[244:247], v[24:27], v[228:231]
  ds_read_b128 v[248:251], v16 offset:13312
  ds_read_b128 v[252:255], v17 offset:13312
  s_waitcnt vmcnt(8)
  s_waitcnt lgkmcnt(10)
  v_mfma_f32_16x16x32_bf16 v[64:67], v[148:151], v[184:187], v[64:67]
  ds_read_b128 v[120:123], v3 offset:14336
  v_mfma_f32_16x16x32_bf16 v[68:71], v[148:151], v[188:191], v[68:71]
  s_add_u32 s64, s64, 4096
  buffer_load_dwordx4 v[208:211], v2, s[44:47], s64 offen offset:0 sc1
  s_waitcnt lgkmcnt(10)
  v_mfma_f32_16x16x32_bf16 v[72:75], v[152:155], v[184:187], v[72:75]
  ds_read_b128 v[124:127], v3 offset:34816
  v_mfma_f32_16x16x32_bf16 v[76:79], v[152:155], v[188:191], v[76:79]
  s_add_u32 s65, s65, 4096
  buffer_load_dwordx4 v[212:215], v2, s[44:47], s65 offen offset:0 sc1
  s_waitcnt lgkmcnt(10)
  v_mfma_f32_16x16x32_bf16 v[80:83], v[156:159], v[184:187], v[80:83]
  ds_read_b128 v[128:131], v3 offset:55296
  v_mfma_f32_16x16x32_bf16 v[84:87], v[156:159], v[188:191], v[84:87]
  s_add_u32 s33, s43, 16384
  buffer_load_dwordx4 a[76:79], v2, s[60:63], s33 offen offset:3072
  s_waitcnt lgkmcnt(10)
  v_mfma_f32_16x16x32_bf16 v[88:91], v[160:163], v[184:187], v[88:91]
  ds_read_b128 v[132:135], v4 offset:10240
  v_mfma_f32_16x16x32_bf16 v[92:95], v[160:163], v[188:191], v[92:95]
  s_add_u32 s33, s43, 20480
  buffer_load_dwordx4 a[80:83], v2, s[60:63], s33 offen offset:0
  s_waitcnt lgkmcnt(10)
  v_mfma_f32_16x16x32_bf16 v[96:99], v[164:167], v[184:187], v[96:99]
  ds_read_b128 v[136:139], v4 offset:30720
  v_mfma_f32_16x16x32_bf16 v[100:103], v[164:167], v[188:191], v[100:103]
  s_waitcnt lgkmcnt(10)
  v_mfma_f32_16x16x32_bf16 v[104:107], v[168:171], v[184:187], v[104:107]
  ds_read_b128 v[140:143], v4 offset:51200
  v_mfma_f32_16x16x32_bf16 v[108:111], v[168:171], v[188:191], v[108:111]
  s_waitcnt lgkmcnt(10)
  v_mfma_f32_16x16x32_bf16 v[112:115], v[172:175], v[184:187], v[112:115]
  ds_read_b128 v[144:147], v5 offset:6144
  v_mfma_f32_16x16x32_bf16 v[116:119], v[172:175], v[188:191], v[116:119]
  s_waitcnt lgkmcnt(7)
  v_mfma_f32_16x16x32_bf16 v[224:227], v[248:251], v[28:31], v[224:227]
  ds_read_b64 v[24:25], v9 offset:896
  ds_read_b64 v[26:27], v9 offset:928
  v_mfma_f32_16x16x32_bf16 v[228:231], v[252:255], v[28:31], v[228:231]
  ds_read_b128 v[240:243], v16 offset:14336
  ds_read_b128 v[244:247], v17 offset:14336
  s_waitcnt vmcnt(9)
  s_waitcnt lgkmcnt(10)
  v_mfma_f32_16x16x32_bf16 v[64:67], v[120:123], v[192:195], v[64:67]
  ds_read_b128 v[148:151], v3 offset:15360
  v_mfma_f32_16x16x32_bf16 v[68:71], v[120:123], v[196:199], v[68:71]
  buffer_load_dwordx4 v[216:219], v2, s[44:47], s64 offen offset:1024 sc1
  s_waitcnt lgkmcnt(10)
  v_mfma_f32_16x16x32_bf16 v[72:75], v[124:127], v[192:195], v[72:75]
  ds_read_b128 v[152:155], v3 offset:35840
  v_mfma_f32_16x16x32_bf16 v[76:79], v[124:127], v[196:199], v[76:79]
  buffer_load_dwordx4 v[220:223], v2, s[44:47], s65 offen offset:1024 sc1
  s_waitcnt lgkmcnt(10)
  v_mfma_f32_16x16x32_bf16 v[80:83], v[128:131], v[192:195], v[80:83]
  ds_read_b128 v[156:159], v3 offset:56320
  v_mfma_f32_16x16x32_bf16 v[84:87], v[128:131], v[196:199], v[84:87]
  s_add_u32 s33, s43, 20480
  buffer_load_dwordx4 a[84:87], v2, s[60:63], s33 offen offset:1024
  s_waitcnt lgkmcnt(10)
  v_mfma_f32_16x16x32_bf16 v[88:91], v[132:135], v[192:195], v[88:91]
  ds_read_b128 v[160:163], v4 offset:11264
  v_mfma_f32_16x16x32_bf16 v[92:95], v[132:135], v[196:199], v[92:95]
  s_waitcnt lgkmcnt(10)
  v_mfma_f32_16x16x32_bf16 v[96:99], v[136:139], v[192:195], v[96:99]
  ds_read_b128 v[164:167], v4 offset:31744
  v_mfma_f32_16x16x32_bf16 v[100:103], v[136:139], v[196:199], v[100:103]
  s_waitcnt lgkmcnt(10)
  v_mfma_f32_16x16x32_bf16 v[104:107], v[140:143], v[192:195], v[104:107]
  ds_read_b128 v[168:171], v4 offset:52224
  v_mfma_f32_16x16x32_bf16 v[108:111], v[140:143], v[196:199], v[108:111]
  s_waitcnt lgkmcnt(10)
  v_mfma_f32_16x16x32_bf16 v[112:115], v[144:147], v[192:195], v[112:115]
  ds_read_b128 v[172:175], v5 offset:7168
  v_mfma_f32_16x16x32_bf16 v[116:119], v[144:147], v[196:199], v[116:119]
  s_waitcnt lgkmcnt(7)
  v_mfma_f32_16x16x32_bf16 v[224:227], v[240:243], v[24:27], v[224:227]
  ds_read_b64 v[28:29], v9 offset:960
  ds_read_b64 v[30:31], v9 offset:992
  v_mfma_f32_16x16x32_bf16 v[228:231], v[244:247], v[24:27], v[228:231]
  ds_read_b128 v[248:251], v16 offset:15360
  ds_read_b128 v[252:255], v17 offset:15360
  s_waitcnt vmcnt(8)
  s_waitcnt lgkmcnt(10)
  v_mfma_f32_16x16x32_bf16 v[64:67], v[148:151], v[200:203], v[64:67]
  ds_read_b128 v[120:123], v3 offset:16384
  v_mfma_f32_16x16x32_bf16 v[68:71], v[148:151], v[204:207], v[68:71]
  buffer_load_dwordx4 v[176:179], v2, s[44:47], s64 offen offset:2048 sc1
  s_waitcnt lgkmcnt(10)
  v_mfma_f32_16x16x32_bf16 v[72:75], v[152:155], v[200:203], v[72:75]
  ds_read_b128 v[124:127], v3 offset:36864
  v_mfma_f32_16x16x32_bf16 v[76:79], v[152:155], v[204:207], v[76:79]
  buffer_load_dwordx4 v[180:183], v2, s[44:47], s65 offen offset:2048 sc1
  s_waitcnt lgkmcnt(10)
  v_mfma_f32_16x16x32_bf16 v[80:83], v[156:159], v[200:203], v[80:83]
  ds_read_b128 v[128:131], v3 offset:57344
  v_mfma_f32_16x16x32_bf16 v[84:87], v[156:159], v[204:207], v[84:87]
  s_add_u32 s33, s43, 20480
  buffer_load_dwordx4 a[88:91], v2, s[60:63], s33 offen offset:2048
  s_waitcnt lgkmcnt(10)
  v_mfma_f32_16x16x32_bf16 v[88:91], v[160:163], v[200:203], v[88:91]
  ds_read_b128 v[132:135], v4 offset:12288
  v_mfma_f32_16x16x32_bf16 v[92:95], v[160:163], v[204:207], v[92:95]
  s_add_u32 s33, s43, 20480
  buffer_load_dwordx4 a[92:95], v2, s[60:63], s33 offen offset:3072
  s_waitcnt lgkmcnt(10)
  v_mfma_f32_16x16x32_bf16 v[96:99], v[164:167], v[200:203], v[96:99]
  ds_read_b128 v[136:139], v4 offset:32768
  v_mfma_f32_16x16x32_bf16 v[100:103], v[164:167], v[204:207], v[100:103]
  s_waitcnt lgkmcnt(10)
  v_mfma_f32_16x16x32_bf16 v[104:107], v[168:171], v[200:203], v[104:107]
  ds_read_b128 v[140:143], v4 offset:53248
  v_mfma_f32_16x16x32_bf16 v[108:111], v[168:171], v[204:207], v[108:111]
  s_waitcnt lgkmcnt(10)
  v_mfma_f32_16x16x32_bf16 v[112:115], v[172:175], v[200:203], v[112:115]
  ds_read_b128 v[144:147], v5 offset:8192
  v_mfma_f32_16x16x32_bf16 v[116:119], v[172:175], v[204:207], v[116:119]
  s_waitcnt lgkmcnt(7)
  v_mfma_f32_16x16x32_bf16 v[224:227], v[248:251], v[28:31], v[224:227]
  ds_read_b64 v[24:25], v9 offset:1024
  ds_read_b64 v[26:27], v9 offset:1056
  v_mfma_f32_16x16x32_bf16 v[228:231], v[252:255], v[28:31], v[228:231]
  ds_read_b128 v[240:243], v16 offset:16384
  ds_read_b128 v[244:247], v17 offset:16384
  s_waitcnt vmcnt(9)
  s_waitcnt lgkmcnt(10)
  v_mfma_f32_16x16x32_bf16 v[64:67], v[120:123], v[208:211], v[64:67]
  ds_read_b128 v[148:151], v3 offset:17408
  v_mfma_f32_16x16x32_bf16 v[68:71], v[120:123], v[212:215], v[68:71]
  buffer_load_dwordx4 v[184:187], v2, s[44:47], s64 offen offset:3072 sc1
  s_waitcnt lgkmcnt(10)
  v_mfma_f32_16x16x32_bf16 v[72:75], v[124:127], v[208:211], v[72:75]
  ds_read_b128 v[152:155], v3 offset:37888
  v_mfma_f32_16x16x32_bf16 v[76:79], v[124:127], v[212:215], v[76:79]
  buffer_load_dwordx4 v[188:191], v2, s[44:47], s65 offen offset:3072 sc1
  s_waitcnt lgkmcnt(10)
  v_mfma_f32_16x16x32_bf16 v[80:83], v[128:131], v[208:211], v[80:83]
  ds_read_b128 v[156:159], v3 offset:58368
  v_mfma_f32_16x16x32_bf16 v[84:87], v[128:131], v[212:215], v[84:87]
  s_add_u32 s33, s43, 24576
  buffer_load_dwordx4 a[96:99], v2, s[60:63], s33 offen offset:0
  s_waitcnt lgkmcnt(10)
  v_mfma_f32_16x16x32_bf16 v[88:91], v[132:135], v[208:211], v[88:91]
  ds_read_b128 v[160:163], v4 offset:13312
  v_mfma_f32_16x16x32_bf16 v[92:95], v[132:135], v[212:215], v[92:95]
  s_waitcnt lgkmcnt(10)
  v_mfma_f32_16x16x32_bf16 v[96:99], v[136:139], v[208:211], v[96:99]
  ds_read_b128 v[164:167], v4 offset:33792
  v_mfma_f32_16x16x32_bf16 v[100:103], v[136:139], v[212:215], v[100:103]
  s_waitcnt lgkmcnt(10)
  v_mfma_f32_16x16x32_bf16 v[104:107], v[140:143], v[208:211], v[104:107]
  ds_read_b128 v[168:171], v4 offset:54272
  v_mfma_f32_16x16x32_bf16 v[108:111], v[140:143], v[212:215], v[108:111]
  s_waitcnt lgkmcnt(10)
  v_mfma_f32_16x16x32_bf16 v[112:115], v[144:147], v[208:211], v[112:115]
  ds_read_b128 v[172:175], v5 offset:9216
  v_mfma_f32_16x16x32_bf16 v[116:119], v[144:147], v[212:215], v[116:119]
  s_waitcnt lgkmcnt(7)
  v_mfma_f32_16x16x32_bf16 v[224:227], v[240:243], v[24:27], v[224:227]
  ds_read_b64 v[28:29], v9 offset:1088
  ds_read_b64 v[30:31], v9 offset:1120
  v_mfma_f32_16x16x32_bf16 v[228:231], v[244:247], v[24:27], v[228:231]
  ds_read_b128 v[248:251], v16 offset:17408
  ds_read_b128 v[252:255], v17 offset:17408
  s_waitcnt vmcnt(8)
  s_waitcnt lgkmcnt(10)
  v_mfma_f32_16x16x32_bf16 v[64:67], v[148:151], v[216:219], v[64:67]
  ds_read_b128 v[120:123], v3 offset:18432
  v_mfma_f32_16x16x32_bf16 v[68:71], v[148:151], v[220:223], v[68:71]
  s_add_u32 s33, s43, 24576
  buffer_load_dwordx4 a[100:103], v2, s[60:63], s33 offen offset:1024
  s_waitcnt lgkmcnt(10)
  v_mfma_f32_16x16x32_bf16 v[72:75], v[152:155], v[216:219], v[72:75]
  ds_read_b128 v[124:127], v3 offset:38912
  v_mfma_f32_16x16x32_bf16 v[76:79], v[152:155], v[220:223], v[76:79]
  s_add_u32 s33, s43, 24576
  buffer_load_dwordx4 a[104:107], v2, s[60:63], s33 offen offset:2048
  s_waitcnt lgkmcnt(10)
  v_mfma_f32_16x16x32_bf16 v[80:83], v[156:159], v[216:219], v[80:83]
  ds_read_b128 v[128:131], v3 offset:59392
  v_mfma_f32_16x16x32_bf16 v[84:87], v[156:159], v[220:223], v[84:87]
  s_waitcnt lgkmcnt(10)
  v_mfma_f32_16x16x32_bf16 v[88:91], v[160:163], v[216:219], v[88:91]
  ds_read_b128 v[132:135], v4 offset:14336
  v_mfma_f32_16x16x32_bf16 v[92:95], v[160:163], v[220:223], v[92:95]
  s_waitcnt lgkmcnt(10)
  v_mfma_f32_16x16x32_bf16 v[96:99], v[164:167], v[216:219], v[96:99]
  ds_read_b128 v[136:139], v4 offset:34816
  v_mfma_f32_16x16x32_bf16 v[100:103], v[164:167], v[220:223], v[100:103]
  s_waitcnt lgkmcnt(10)
  v_mfma_f32_16x16x32_bf16 v[104:107], v[168:171], v[216:219], v[104:107]
  ds_read_b128 v[140:143], v4 offset:55296
  v_mfma_f32_16x16x32_bf16 v[108:111], v[168:171], v[220:223], v[108:111]
  s_waitcnt lgkmcnt(10)
  v_mfma_f32_16x16x32_bf16 v[112:115], v[172:175], v[216:219], v[112:115]
  ds_read_b128 v[144:147], v5 offset:10240
  v_mfma_f32_16x16x32_bf16 v[116:119], v[172:175], v[220:223], v[116:119]
  s_waitcnt lgkmcnt(7)
  v_mfma_f32_16x16x32_bf16 v[224:227], v[248:251], v[28:31], v[224:227]
  ds_read_b64 v[24:25], v9 offset:1152
  ds_read_b64 v[26:27], v9 offset:1184
  v_mfma_f32_16x16x32_bf16 v[228:231], v[252:255], v[28:31], v[228:231]
  ds_read_b128 v[240:243], v16 offset:18432
  ds_read_b128 v[244:247], v17 offset:18432
  s_waitcnt vmcnt(7)
  s_waitcnt lgkmcnt(10)
  v_mfma_f32_16x16x32_bf16 v[64:67], v[120:123], v[176:179], v[64:67]
  ds_read_b128 v[148:151], v3 offset:19456
  v_mfma_f32_16x16x32_bf16 v[68:71], v[120:123], v[180:183], v[68:71]
  s_add_u32 s33, s43, 24576
  buffer_load_dwordx4 a[108:111], v2, s[60:63], s33 offen offset:3072
  s_waitcnt lgkmcnt(10)
  v_mfma_f32_16x16x32_bf16 v[72:75], v[124:127], v[176:179], v[72:75]
  ds_read_b128 v[152:155], v3 offset:39936
  v_mfma_f32_16x16x32_bf16 v[76:79], v[124:127], v[180:183], v[76:79]
  s_waitcnt lgkmcnt(10)
  v_mfma_f32_16x16x32_bf16 v[80:83], v[128:131], v[176:179], v[80:83]
  ds_read_b128 v[156:159], v3 offset:60416
  v_mfma_f32_16x16x32_bf16 v[84:87], v[128:131], v[180:183], v[84:87]
  s_waitcnt lgkmcnt(10)
  v_mfma_f32_16x16x32_bf16 v[88:91], v[132:135], v[176:179], v[88:91]
  ds_read_b128 v[160:163], v4 offset:15360
  v_mfma_f32_16x16x32_bf16 v[92:95], v[132:135], v[180:183], v[92:95]
  s_waitcnt lgkmcnt(10)
  v_mfma_f32_16x16x32_bf16 v[96:99], v[136:139], v[176:179], v[96:99]
  ds_read_b128 v[164:167], v4 offset:35840
  v_mfma_f32_16x16x32_bf16 v[100:103], v[136:139], v[180:183], v[100:103]
  s_waitcnt lgkmcnt(10)
  v_mfma_f32_16x16x32_bf16 v[104:107], v[140:143], v[176:179], v[104:107]
  ds_read_b128 v[168:171], v4 offset:56320
  v_mfma_f32_16x16x32_bf16 v[108:111], v[140:143], v[180:183], v[108:111]
  s_waitcnt lgkmcnt(10)
  v_mfma_f32_16x16x32_bf16 v[112:115], v[144:147], v[176:179], v[112:115]
  ds_read_b128 v[172:175], v5 offset:11264
  v_mfma_f32_16x16x32_bf16 v[116:119], v[144:147], v[180:183], v[116:119]
  s_waitcnt lgkmcnt(7)
  v_mfma_f32_16x16x32_bf16 v[224:227], v[240:243], v[24:27], v[224:227]
  ds_read_b64 v[28:29], v9 offset:1216
  ds_read_b64 v[30:31], v9 offset:1248
  v_mfma_f32_16x16x32_bf16 v[228:231], v[244:247], v[24:27], v[228:231]
  ds_read_b128 v[248:251], v16 offset:19456
  ds_read_b128 v[252:255], v17 offset:19456
  s_waitcnt vmcnt(4)
  s_waitcnt lgkmcnt(10)
  v_mfma_f32_16x16x32_bf16 v[64:67], v[148:151], v[184:187], v[64:67]
  v_mfma_f32_16x16x32_bf16 v[68:71], v[148:151], v[188:191], v[68:71]
  s_add_u32 s33, s43, 28672
  buffer_load_dwordx4 a[112:115], v2, s[60:63], s33 offen offset:0
  s_waitcnt lgkmcnt(9)
  v_mfma_f32_16x16x32_bf16 v[72:75], v[152:155], v[184:187], v[72:75]
  v_mfma_f32_16x16x32_bf16 v[76:79], v[152:155], v[188:191], v[76:79]
  s_add_u32 s33, s43, 28672
  buffer_load_dwordx4 a[116:119], v2, s[60:63], s33 offen offset:1024
  s_waitcnt lgkmcnt(8)
  v_mfma_f32_16x16x32_bf16 v[80:83], v[156:159], v[184:187], v[80:83]
  v_mfma_f32_16x16x32_bf16 v[84:87], v[156:159], v[188:191], v[84:87]
  s_waitcnt lgkmcnt(7)
  v_mfma_f32_16x16x32_bf16 v[88:91], v[160:163], v[184:187], v[88:91]
  v_mfma_f32_16x16x32_bf16 v[92:95], v[160:163], v[188:191], v[92:95]
  s_waitcnt lgkmcnt(6)
  v_mfma_f32_16x16x32_bf16 v[96:99], v[164:167], v[184:187], v[96:99]
  v_mfma_f32_16x16x32_bf16 v[100:103], v[164:167], v[188:191], v[100:103]
  s_waitcnt lgkmcnt(5)
  v_mfma_f32_16x16x32_bf16 v[104:107], v[168:171], v[184:187], v[104:107]
  v_mfma_f32_16x16x32_bf16 v[108:111], v[168:171], v[188:191], v[108:111]
  s_waitcnt lgkmcnt(4)
  v_mfma_f32_16x16x32_bf16 v[112:115], v[172:175], v[184:187], v[112:115]
  v_mfma_f32_16x16x32_bf16 v[116:119], v[172:175], v[188:191], v[116:119]
  s_waitcnt lgkmcnt(0)
  v_mfma_f32_16x16x32_bf16 v[224:227], v[248:251], v[28:31], v[224:227]
  v_mfma_f32_16x16x32_bf16 v[228:231], v[252:255], v[28:31], v[228:231]
  v_and_b32 v7, 15, v1
  v_lshlrev_b32 v9, 6, v7
  v_lshl_add_u32 v9, v6, 4, v9
  s_lshl_b32 s33, s24, 7
  s_add_u32 s33, s33, 145408
  v_add_u32 v9, s33, v9
  s_mov_b32 s35, 0xffff0000
  v_cmp_eq_u32 vcc, 1, v7
  v_lshlrev_b32 v16, 16, v60
  v_and_b32 v17, s35, v60
  v_lshlrev_b32 v18, 16, v61
  v_and_b32 v19, s35, v61
  v_cndmask_b32 v16, 0, v16, vcc
  v_add_f32 v224, v224, v16
  v_cndmask_b32 v17, 0, v17, vcc
  v_add_f32 v225, v225, v17
  v_cndmask_b32 v18, 0, v18, vcc
  v_add_f32 v226, v226, v18
  v_cndmask_b32 v19, 0, v19, vcc
  v_add_f32 v227, v227, v19
  v_lshlrev_b32 v16, 16, v62
  v_and_b32 v17, s35, v62
  v_lshlrev_b32 v18, 16, v63
  v_and_b32 v19, s35, v63
  v_cndmask_b32 v16, 0, v16, vcc
  v_add_f32 v228, v228, v16
  v_cndmask_b32 v17, 0, v17, vcc
  v_add_f32 v229, v229, v17
  v_cndmask_b32 v18, 0, v18, vcc
  v_add_f32 v230, v230, v18
  v_cndmask_b32 v19, 0, v19, vcc
  v_add_f32 v231, v231, v19
  v_cmp_gt_u32 vcc, 2, v7
  s_and_saveexec_b64 s[40:41], vcc
  ds_write_b128 v9, v[224:227]
  s_cmp_eq_u32 s24, 3
  s_cbranch_scc1 L_k2_ut3
  ds_write_b128 v9, v[228:231] offset:512
L_k2_ut3:
  s_mov_b64 exec, s[40:41]
  v_add_f32 v12, v52, v54
  v_mov_b32 v13, v12
  s_nop 1
  v_permlane16_swap_b32 v12, v13
  v_add_f32 v12, v12, v13
  v_mov_b32 v13, v12
  s_nop 1
  v_permlane32_swap_b32 v12, v13
  v_add_f32 v12, v12, v13
  v_mul_f32 v12, 0x3acccccd, v12
  v_mul_f32 v14, 0x3c4ccccd, v52
  v_mul_f32 v15, 0x3c4ccccd, v54
  v_sub_f32 v14, v14, v12
  v_sub_f32 v15, v15, v12
  v_mul_f32 v14, v14, v14
  v_fmac_f32 v14, v15, v15
  v_add_f32 v15, v53, v55
  v_fmac_f32 v15, 0x42a00000, v14
  v_mov_b32 v13, v15
  s_nop 1
  v_permlane16_swap_b32 v15, v13
  v_add_f32 v15, v15, v13
  v_mov_b32 v13, v15
  s_nop 1
  v_permlane32_swap_b32 v15, v13
  v_add_f32 v15, v15, v13
  v_mov_b32 v13, 0x3727c5ac
  v_fmac_f32 v13, 0x3acccccd, v15
  v_rsq_f32 v13, v13
  s_nop 0
  v_mov_b32 v52, v13
  v_mul_f32 v53, v13, v12
  v_add_f32 v12, v56, v58
  v_mov_b32 v13, v12
  s_nop 1
  v_permlane16_swap_b32 v12, v13
  v_add_f32 v12, v12, v13
  v_mov_b32 v13, v12
  s_nop 1
  v_permlane32_swap_b32 v12, v13
  v_add_f32 v12, v12, v13
  v_mul_f32 v12, 0x3acccccd, v12
  v_mul_f32 v14, 0x3c4ccccd, v56
  v_mul_f32 v15, 0x3c4ccccd, v58
  v_sub_f32 v14, v14, v12
  v_sub_f32 v15, v15, v12
  v_mul_f32 v14, v14, v14
  v_fmac_f32 v14, v15, v15
  v_add_f32 v15, v57, v59
  v_fmac_f32 v15, 0x42a00000, v14
  v_mov_b32 v13, v15
  s_nop 1
  v_permlane16_swap_b32 v15, v13
  v_add_f32 v15, v15, v13
  v_mov_b32 v13, v15
  s_nop 1
  v_permlane32_swap_b32 v15, v13
  v_add_f32 v15, v15, v13
  v_mov_b32 v13, 0x3727c5ac
  v_fmac_f32 v13, 0x3acccccd, v15
  v_rsq_f32 v13, v13
  s_nop 0
  v_mov_b32 v56, v13
  v_mul_f32 v57, v13, v12
  s_waitcnt lgkmcnt(0)
  s_barrier
  s_lshl_b32 s34, s24, 1
  s_mul_i32 s64, s34, 60416
  s_add_u32 s64, s64, s68
  s_add_u32 s65, s64, 60416
  v_lshlrev_b32 v6, 4, v6
  v_add_u32 v6, 145408, v6
  ds_read_b128 v[120:123], v6 offset:0
  ds_read_b128 v[124:127], v6 offset:64
  ds_read_b128 v[128:131], v6 offset:128
  ds_read_b128 v[132:135], v6 offset:192
  ds_read_b128 v[136:139], v6 offset:256
  ds_read_b128 v[140:143], v6 offset:320
  ds_read_b128 v[144:147], v6 offset:384
  ds_read_b128 v[148:151], v6 offset:448
  ds_read_b128 v[152:155], v6 offset:512
  ds_read_b128 v[156:159], v6 offset:576
  ds_read_b128 v[160:163], v6 offset:640
  ds_read_b128 v[164:167], v6 offset:704
  ds_read_b128 v[168:171], v6 offset:768
  ds_read_b128 v[172:175], v6 offset:832
  s_waitcnt lgkmcnt(12)
  s_add_u32 s37, s31, 0
  s_lshr_b32 s34, s37, 1
  s_cmp_ge_u32 s34, 28
  s_cselect_b32 s38, 4, 2
  s_cmp_ge_u32 s34, 14
  s_cselect_b32 s38, s38, 0
  s_add_u32 s34, s34, s38
  s_lshl_b32 s34, s34, 10
  s_and_b32 s37, s37, 1
  s_lshl_b32 s37, s37, 3
  s_add_u32 s37, s37, s34
  v_pk_fma_f32 v[12:13], v[120:121], v[52:53], v[124:125] op_sel:[0,1,0] op_sel_hi:[1,1,1] neg_lo:[0,1,0] neg_hi:[0,1,0]
  v_pk_fma_f32 v[12:13], v[64:65], v[52:53], v[12:13] op_sel_hi:[1,0,1]
  v_max_f32 v14, 0, v12
  v_max_f32 v15, 0, v13
  v_pk_mul_f32 v[12:13], v[14:15], v[14:15]
  v_cvt_pk_bf16_f32 v16, v12, v13
  v_pk_fma_f32 v[12:13], v[122:123], v[52:53], v[126:127] op_sel:[0,1,0] op_sel_hi:[1,1,1] neg_lo:[0,1,0] neg_hi:[0,1,0]
  v_pk_fma_f32 v[12:13], v[66:67], v[52:53], v[12:13] op_sel_hi:[1,0,1]
  v_max_f32 v14, 0, v12
  v_max_f32 v15, 0, v13
  v_pk_mul_f32 v[12:13], v[14:15], v[14:15]
  v_cvt_pk_bf16_f32 v17, v12, v13
  s_add_u32 s34, s37, s64
  buffer_store_dwordx2 v[16:17], v2, s[44:47], s34 offen
  s_add_u32 s33, s43, 28672
  buffer_load_dwordx4 a[120:123], v2, s[60:63], s33 offen offset:2048
  v_pk_fma_f32 v[12:13], v[120:121], v[56:57], v[124:125] op_sel:[0,1,0] op_sel_hi:[1,1,1] neg_lo:[0,1,0] neg_hi:[0,1,0]
  v_pk_fma_f32 v[12:13], v[68:69], v[56:57], v[12:13] op_sel_hi:[1,0,1]
  v_max_f32 v14, 0, v12
  v_max_f32 v15, 0, v13
  v_pk_mul_f32 v[12:13], v[14:15], v[14:15]
  v_cvt_pk_bf16_f32 v16, v12, v13
  v_pk_fma_f32 v[12:13], v[122:123], v[56:57], v[126:127] op_sel:[0,1,0] op_sel_hi:[1,1,1] neg_lo:[0,1,0] neg_hi:[0,1,0]
  v_pk_fma_f32 v[12:13], v[70:71], v[56:57], v[12:13] op_sel_hi:[1,0,1]
  v_max_f32 v14, 0, v12
  v_max_f32 v15, 0, v13
  v_pk_mul_f32 v[12:13], v[14:15], v[14:15]
  v_cvt_pk_bf16_f32 v17, v12, v13
  s_add_u32 s34, s37, s65
  buffer_store_dwordx2 v[16:17], v2, s[44:47], s34 offen
  s_add_u32 s33, s43, 28672
  buffer_load_dwordx4 a[124:127], v2, s[60:63], s33 offen offset:3072
  s_waitcnt lgkmcnt(10)
  s_add_u32 s37, s31, 1
  s_lshr_b32 s34, s37, 1
  s_cmp_ge_u32 s34, 28
  s_cselect_b32 s38, 4, 2
  s_cmp_ge_u32 s34, 14
  s_cselect_b32 s38, s38, 0
  s_add_u32 s34, s34, s38
  s_lshl_b32 s34, s34, 10
  s_and_b32 s37, s37, 1
  s_lshl_b32 s37, s37, 3
  s_add_u32 s37, s37, s34
  v_pk_fma_f32 v[12:13], v[128:129], v[52:53], v[132:133] op_sel:[0,1,0] op_sel_hi:[1,1,1] neg_lo:[0,1,0] neg_hi:[0,1,0]
  v_pk_fma_f32 v[12:13], v[72:73], v[52:53], v[12:13] op_sel_hi:[1,0,1]
  v_max_f32 v14, 0, v12
  v_max_f32 v15, 0, v13
  v_pk_mul_f32 v[12:13], v[14:15], v[14:15]
  v_cvt_pk_bf16_f32 v16, v12, v13
  v_pk_fma_f32 v[12:13], v[130:131], v[52:53], v[134:135] op_sel:[0,1,0] op_sel_hi:[1,1,1] neg_lo:[0,1,0] neg_hi:[0,1,0]
  v_pk_fma_f32 v[12:13], v[74:75], v[52:53], v[12:13] op_sel_hi:[1,0,1]
  v_max_f32 v14, 0, v12
  v_max_f32 v15, 0, v13
  v_pk_mul_f32 v[12:13], v[14:15], v[14:15]
  v_cvt_pk_bf16_f32 v17, v12, v13
  s_add_u32 s34, s37, s64
  buffer_store_dwordx2 v[16:17], v2, s[44:47], s34 offen
  s_add_u32 s33, s43, 32768
  buffer_load_dwordx4 a[128:131], v2, s[60:63], s33 offen offset:0
  v_pk_fma_f32 v[12:13], v[128:129], v[56:57], v[132:133] op_sel:[0,1,0] op_sel_hi:[1,1,1] neg_lo:[0,1,0] neg_hi:[0,1,0]
  v_pk_fma_f32 v[12:13], v[76:77], v[56:57], v[12:13] op_sel_hi:[1,0,1]
  v_max_f32 v14, 0, v12
  v_max_f32 v15, 0, v13
  v_pk_mul_f32 v[12:13], v[14:15], v[14:15]
  v_cvt_pk_bf16_f32 v16, v12, v13
  v_pk_fma_f32 v[12:13], v[130:131], v[56:57], v[134:135] op_sel:[0,1,0] op_sel_hi:[1,1,1] neg_lo:[0,1,0] neg_hi:[0,1,0]
  v_pk_fma_f32 v[12:13], v[78:79], v[56:57], v[12:13] op_sel_hi:[1,0,1]
  v_max_f32 v14, 0, v12
  v_max_f32 v15, 0, v13
  v_pk_mul_f32 v[12:13], v[14:15], v[14:15]
  v_cvt_pk_bf16_f32 v17, v12, v13
  s_add_u32 s34, s37, s65
  buffer_store_dwordx2 v[16:17], v2, s[44:47], s34 offen
  s_add_u32 s33, s43, 32768
  buffer_load_dwordx4 a[132:135], v2, s[60:63], s33 offen offset:1024
  s_waitcnt lgkmcnt(8)
  s_add_u32 s37, s31, 2
  s_lshr_b32 s34, s37, 1
  s_cmp_ge_u32 s34, 28
  s_cselect_b32 s38, 4, 2
  s_cmp_ge_u32 s34, 14
  s_cselect_b32 s38, s38, 0
  s_add_u32 s34, s34, s38
  s_lshl_b32 s34, s34, 10
  s_and_b32 s37, s37, 1
  s_lshl_b32 s37, s37, 3
  s_add_u32 s37, s37, s34
  v_pk_fma_f32 v[12:13], v[136:137], v[52:53], v[140:141] op_sel:[0,1,0] op_sel_hi:[1,1,1] neg_lo:[0,1,0] neg_hi:[0,1,0]
  v_pk_fma_f32 v[12:13], v[80:81], v[52:53], v[12:13] op_sel_hi:[1,0,1]
  v_max_f32 v14, 0, v12
  v_max_f32 v15, 0, v13
  v_pk_mul_f32 v[12:13], v[14:15], v[14:15]
  v_cvt_pk_bf16_f32 v16, v12, v13
  v_pk_fma_f32 v[12:13], v[138:139], v[52:53], v[142:143] op_sel:[0,1,0] op_sel_hi:[1,1,1] neg_lo:[0,1,0] neg_hi:[0,1,0]
  v_pk_fma_f32 v[12:13], v[82:83], v[52:53], v[12:13] op_sel_hi:[1,0,1]
  v_max_f32 v14, 0, v12
  v_max_f32 v15, 0, v13
  v_pk_mul_f32 v[12:13], v[14:15], v[14:15]
  v_cvt_pk_bf16_f32 v17, v12, v13
  s_add_u32 s34, s37, s64
  buffer_store_dwordx2 v[16:17], v2, s[44:47], s34 offen
  s_add_u32 s33, s43, 32768
  buffer_load_dwordx4 a[136:139], v2, s[60:63], s33 offen offset:2048
  v_pk_fma_f32 v[12:13], v[136:137], v[56:57], v[140:141] op_sel:[0,1,0] op_sel_hi:[1,1,1] neg_lo:[0,1,0] neg_hi:[0,1,0]
  v_pk_fma_f32 v[12:13], v[84:85], v[56:57], v[12:13] op_sel_hi:[1,0,1]
  v_max_f32 v14, 0, v12
  v_max_f32 v15, 0, v13
  v_pk_mul_f32 v[12:13], v[14:15], v[14:15]
  v_cvt_pk_bf16_f32 v16, v12, v13
  v_pk_fma_f32 v[12:13], v[138:139], v[56:57], v[142:143] op_sel:[0,1,0] op_sel_hi:[1,1,1] neg_lo:[0,1,0] neg_hi:[0,1,0]
  v_pk_fma_f32 v[12:13], v[86:87], v[56:57], v[12:13] op_sel_hi:[1,0,1]
  v_max_f32 v14, 0, v12
  v_max_f32 v15, 0, v13
  v_pk_mul_f32 v[12:13], v[14:15], v[14:15]
  v_cvt_pk_bf16_f32 v17, v12, v13
  s_add_u32 s34, s37, s65
  buffer_store_dwordx2 v[16:17], v2, s[44:47], s34 offen
  s_add_u32 s33, s43, 32768
  buffer_load_dwordx4 a[140:143], v2, s[60:63], s33 offen offset:3072
  s_waitcnt lgkmcnt(6)
  s_add_u32 s37, s31, 3
  s_lshr_b32 s34, s37, 1
  s_cmp_ge_u32 s34, 28
  s_cselect_b32 s38, 4, 2
  s_cmp_ge_u32 s34, 14
  s_cselect_b32 s38, s38, 0
  s_add_u32 s34, s34, s38
  s_lshl_b32 s34, s34, 10
  s_and_b32 s37, s37, 1
  s_lshl_b32 s37, s37, 3
  s_add_u32 s37, s37, s34
  v_pk_fma_f32 v[12:13], v[144:145], v[52:53], v[148:149] op_sel:[0,1,0] op_sel_hi:[1,1,1] neg_lo:[0,1,0] neg_hi:[0,1,0]
  v_pk_fma_f32 v[12:13], v[88:89], v[52:53], v[12:13] op_sel_hi:[1,0,1]
  v_max_f32 v14, 0, v12
  v_max_f32 v15, 0, v13
  v_pk_mul_f32 v[12:13], v[14:15], v[14:15]
  v_cvt_pk_bf16_f32 v16, v12, v13
  v_pk_fma_f32 v[12:13], v[146:147], v[52:53], v[150:151] op_sel:[0,1,0] op_sel_hi:[1,1,1] neg_lo:[0,1,0] neg_hi:[0,1,0]
  v_pk_fma_f32 v[12:13], v[90:91], v[52:53], v[12:13] op_sel_hi:[1,0,1]
  v_max_f32 v14, 0, v12
  v_max_f32 v15, 0, v13
  v_pk_mul_f32 v[12:13], v[14:15], v[14:15]
  v_cvt_pk_bf16_f32 v17, v12, v13
  s_add_u32 s34, s37, s64
  buffer_store_dwordx2 v[16:17], v2, s[44:47], s34 offen
  s_add_u32 s33, s43, 36864
  buffer_load_dwordx4 a[144:147], v2, s[60:63], s33 offen offset:0
  v_pk_fma_f32 v[12:13], v[144:145], v[56:57], v[148:149] op_sel:[0,1,0] op_sel_hi:[1,1,1] neg_lo:[0,1,0] neg_hi:[0,1,0]
  v_pk_fma_f32 v[12:13], v[92:93], v[56:57], v[12:13] op_sel_hi:[1,0,1]
  v_max_f32 v14, 0, v12
  v_max_f32 v15, 0, v13
  v_pk_mul_f32 v[12:13], v[14:15], v[14:15]
  v_cvt_pk_bf16_f32 v16, v12, v13
  v_pk_fma_f32 v[12:13], v[146:147], v[56:57], v[150:151] op_sel:[0,1,0] op_sel_hi:[1,1,1] neg_lo:[0,1,0] neg_hi:[0,1,0]
  v_pk_fma_f32 v[12:13], v[94:95], v[56:57], v[12:13] op_sel_hi:[1,0,1]
  v_max_f32 v14, 0, v12
  v_max_f32 v15, 0, v13
  v_pk_mul_f32 v[12:13], v[14:15], v[14:15]
  v_cvt_pk_bf16_f32 v17, v12, v13
  s_add_u32 s34, s37, s65
  buffer_store_dwordx2 v[16:17], v2, s[44:47], s34 offen
  s_add_u32 s33, s43, 36864
  buffer_load_dwordx4 a[148:151], v2, s[60:63], s33 offen offset:1024
  s_waitcnt lgkmcnt(4)
  s_add_u32 s37, s31, 4
  s_lshr_b32 s34, s37, 1
  s_cmp_ge_u32 s34, 28
  s_cselect_b32 s38, 4, 2
  s_cmp_ge_u32 s34, 14
  s_cselect_b32 s38, s38, 0
  s_add_u32 s34, s34, s38
  s_lshl_b32 s34, s34, 10
  s_and_b32 s37, s37, 1
  s_lshl_b32 s37, s37, 3
  s_add_u32 s37, s37, s34
  v_pk_fma_f32 v[12:13], v[152:153], v[52:53], v[156:157] op_sel:[0,1,0] op_sel_hi:[1,1,1] neg_lo:[0,1,0] neg_hi:[0,1,0]
  v_pk_fma_f32 v[12:13], v[96:97], v[52:53], v[12:13] op_sel_hi:[1,0,1]
  v_max_f32 v14, 0, v12
  v_max_f32 v15, 0, v13
  v_pk_mul_f32 v[12:13], v[14:15], v[14:15]
  v_cvt_pk_bf16_f32 v16, v12, v13
  v_pk_fma_f32 v[12:13], v[154:155], v[52:53], v[158:159] op_sel:[0,1,0] op_sel_hi:[1,1,1] neg_lo:[0,1,0] neg_hi:[0,1,0]
  v_pk_fma_f32 v[12:13], v[98:99], v[52:53], v[12:13] op_sel_hi:[1,0,1]
  v_max_f32 v14, 0, v12
  v_max_f32 v15, 0, v13
  v_pk_mul_f32 v[12:13], v[14:15], v[14:15]
  v_cvt_pk_bf16_f32 v17, v12, v13
  s_add_u32 s34, s37, s64
  buffer_store_dwordx2 v[16:17], v2, s[44:47], s34 offen
  s_add_u32 s33, s43, 36864
  buffer_load_dwordx4 a[152:155], v2, s[60:63], s33 offen offset:2048
  v_pk_fma_f32 v[12:13], v[152:153], v[56:57], v[156:157] op_sel:[0,1,0] op_sel_hi:[1,1,1] neg_lo:[0,1,0] neg_hi:[0,1,0]
  v_pk_fma_f32 v[12:13], v[100:101], v[56:57], v[12:13] op_sel_hi:[1,0,1]
  v_max_f32 v14, 0, v12
  v_max_f32 v15, 0, v13
  v_pk_mul_f32 v[12:13], v[14:15], v[14:15]
  v_cvt_pk_bf16_f32 v16, v12, v13
  v_pk_fma_f32 v[12:13], v[154:155], v[56:57], v[158:159] op_sel:[0,1,0] op_sel_hi:[1,1,1] neg_lo:[0,1,0] neg_hi:[0,1,0]
  v_pk_fma_f32 v[12:13], v[102:103], v[56:57], v[12:13] op_sel_hi:[1,0,1]
  v_max_f32 v14, 0, v12
  v_max_f32 v15, 0, v13
  v_pk_mul_f32 v[12:13], v[14:15], v[14:15]
  v_cvt_pk_bf16_f32 v17, v12, v13
  s_add_u32 s34, s37, s65
  buffer_store_dwordx2 v[16:17], v2, s[44:47], s34 offen
  s_add_u32 s33, s43, 36864
  buffer_load_dwordx4 a[156:159], v2, s[60:63], s33 offen offset:3072
  s_waitcnt lgkmcnt(2)
  s_add_u32 s37, s31, 5
  s_lshr_b32 s34, s37, 1
  s_cmp_ge_u32 s34, 28
  s_cselect_b32 s38, 4, 2
  s_cmp_ge_u32 s34, 14
  s_cselect_b32 s38, s38, 0
  s_add_u32 s34, s34, s38
  s_lshl_b32 s34, s34, 10
  s_and_b32 s37, s37, 1
  s_lshl_b32 s37, s37, 3
  s_add_u32 s37, s37, s34
  v_pk_fma_f32 v[12:13], v[160:161], v[52:53], v[164:165] op_sel:[0,1,0] op_sel_hi:[1,1,1] neg_lo:[0,1,0] neg_hi:[0,1,0]
  v_pk_fma_f32 v[12:13], v[104:105], v[52:53], v[12:13] op_sel_hi:[1,0,1]
  v_max_f32 v14, 0, v12
  v_max_f32 v15, 0, v13
  v_pk_mul_f32 v[12:13], v[14:15], v[14:15]
  v_cvt_pk_bf16_f32 v16, v12, v13
  v_pk_fma_f32 v[12:13], v[162:163], v[52:53], v[166:167] op_sel:[0,1,0] op_sel_hi:[1,1,1] neg_lo:[0,1,0] neg_hi:[0,1,0]
  v_pk_fma_f32 v[12:13], v[106:107], v[52:53], v[12:13] op_sel_hi:[1,0,1]
  v_max_f32 v14, 0, v12
  v_max_f32 v15, 0, v13
  v_pk_mul_f32 v[12:13], v[14:15], v[14:15]
  v_cvt_pk_bf16_f32 v17, v12, v13
  s_add_u32 s34, s37, s64
  buffer_store_dwordx2 v[16:17], v2, s[44:47], s34 offen
  s_add_u32 s33, s43, 40960
  buffer_load_dwordx4 a[160:163], v2, s[60:63], s33 offen offset:0
  v_pk_fma_f32 v[12:13], v[160:161], v[56:57], v[164:165] op_sel:[0,1,0] op_sel_hi:[1,1,1] neg_lo:[0,1,0] neg_hi:[0,1,0]
  v_pk_fma_f32 v[12:13], v[108:109], v[56:57], v[12:13] op_sel_hi:[1,0,1]
  v_max_f32 v14, 0, v12
  v_max_f32 v15, 0, v13
  v_pk_mul_f32 v[12:13], v[14:15], v[14:15]
  v_cvt_pk_bf16_f32 v16, v12, v13
  v_pk_fma_f32 v[12:13], v[162:163], v[56:57], v[166:167] op_sel:[0,1,0] op_sel_hi:[1,1,1] neg_lo:[0,1,0] neg_hi:[0,1,0]
  v_pk_fma_f32 v[12:13], v[110:111], v[56:57], v[12:13] op_sel_hi:[1,0,1]
  v_max_f32 v14, 0, v12
  v_max_f32 v15, 0, v13
  v_pk_mul_f32 v[12:13], v[14:15], v[14:15]
  v_cvt_pk_bf16_f32 v17, v12, v13
  s_add_u32 s34, s37, s65
  buffer_store_dwordx2 v[16:17], v2, s[44:47], s34 offen
  s_add_u32 s33, s43, 40960
  buffer_load_dwordx4 a[164:167], v2, s[60:63], s33 offen offset:1024
  s_waitcnt lgkmcnt(0)
  s_cmp_eq_u32 s32, 6
  s_cbranch_scc1 L_k2_h1done
  s_add_u32 s37, s31, 6
  s_lshr_b32 s34, s37, 1
  s_cmp_ge_u32 s34, 28
  s_cselect_b32 s38, 4, 2
  s_cmp_ge_u32 s34, 14
  s_cselect_b32 s38, s38, 0
  s_add_u32 s34, s34, s38
  s_lshl_b32 s34, s34, 10
  s_and_b32 s37, s37, 1
  s_lshl_b32 s37, s37, 3
  s_add_u32 s37, s37, s34
  v_pk_fma_f32 v[12:13], v[168:169], v[52:53], v[172:173] op_sel:[0,1,0] op_sel_hi:[1,1,1] neg_lo:[0,1,0] neg_hi:[0,1,0]
  v_pk_fma_f32 v[12:13], v[112:113], v[52:53], v[12:13] op_sel_hi:[1,0,1]
  v_max_f32 v14, 0, v12
  v_max_f32 v15, 0, v13
  v_pk_mul_f32 v[12:13], v[14:15], v[14:15]
  v_cvt_pk_bf16_f32 v16, v12, v13
  v_pk_fma_f32 v[12:13], v[170:171], v[52:53], v[174:175] op_sel:[0,1,0] op_sel_hi:[1,1,1] neg_lo:[0,1,0] neg_hi:[0,1,0]
  v_pk_fma_f32 v[12:13], v[114:115], v[52:53], v[12:13] op_sel_hi:[1,0,1]
  v_max_f32 v14, 0, v12
  v_max_f32 v15, 0, v13
  v_pk_mul_f32 v[12:13], v[14:15], v[14:15]
  v_cvt_pk_bf16_f32 v17, v12, v13
  s_add_u32 s34, s37, s64
  buffer_store_dwordx2 v[16:17], v2, s[44:47], s34 offen
  s_nop 0
  v_pk_fma_f32 v[12:13], v[168:169], v[56:57], v[172:173] op_sel:[0,1,0] op_sel_hi:[1,1,1] neg_lo:[0,1,0] neg_hi:[0,1,0]
  v_pk_fma_f32 v[12:13], v[116:117], v[56:57], v[12:13] op_sel_hi:[1,0,1]
  v_max_f32 v14, 0, v12
  v_max_f32 v15, 0, v13
  v_pk_mul_f32 v[12:13], v[14:15], v[14:15]
  v_cvt_pk_bf16_f32 v16, v12, v13
  v_pk_fma_f32 v[12:13], v[170:171], v[56:57], v[174:175] op_sel:[0,1,0] op_sel_hi:[1,1,1] neg_lo:[0,1,0] neg_hi:[0,1,0]
  v_pk_fma_f32 v[12:13], v[118:119], v[56:57], v[12:13] op_sel_hi:[1,0,1]
  v_max_f32 v14, 0, v12
  v_max_f32 v15, 0, v13
  v_pk_mul_f32 v[12:13], v[14:15], v[14:15]
  v_cvt_pk_bf16_f32 v17, v12, v13
  s_add_u32 s34, s37, s65
  buffer_store_dwordx2 v[16:17], v2, s[44:47], s34 offen
  s_nop 0
L_k2_h1done:
  s_waitcnt lgkmcnt(0)
  s_cmp_eq_u32 s24, 2
  s_cbranch_scc1 L_sp_h_8_p
  s_add_u32 s33, s43, 40960
  buffer_load_dwordx4 a[168:171], v2, s[60:63], s33 offen offset:2048
  s_add_u32 s33, s43, 40960
  buffer_load_dwordx4 a[172:175], v2, s[60:63], s33 offen offset:3072
  s_add_u32 s33, s43, 45056
  buffer_load_dwordx4 a[176:179], v2, s[60:63], s33 offen offset:0
  s_add_u32 s33, s43, 45056
  buffer_load_dwordx4 a[180:183], v2, s[60:63], s33 offen offset:1024
  s_add_u32 s33, s43, 45056
  buffer_load_dwordx4 a[184:187], v2, s[60:63], s33 offen offset:2048
  s_add_u32 s33, s43, 45056
  buffer_load_dwordx4 a[188:191], v2, s[60:63], s33 offen offset:3072
  s_add_u32 s33, s43, 49152
  buffer_load_dwordx4 a[192:195], v2, s[60:63], s33 offen offset:0
  s_add_u32 s33, s43, 49152
  buffer_load_dwordx4 a[196:199], v2, s[60:63], s33 offen offset:1024
  s_add_u32 s33, s43, 49152
  buffer_load_dwordx4 a[200:203], v2, s[60:63], s33 offen offset:2048
  s_add_u32 s33, s43, 49152
  buffer_load_dwordx4 a[204:207], v2, s[60:63], s33 offen offset:3072
  s_add_u32 s33, s43, 53248
  buffer_load_dwordx4 a[208:211], v2, s[60:63], s33 offen offset:0
  s_add_u32 s33, s43, 53248
  buffer_load_dwordx4 a[212:215], v2, s[60:63], s33 offen offset:1024
  s_add_u32 s33, s43, 53248
  buffer_load_dwordx4 a[216:219], v2, s[60:63], s33 offen offset:2048
  s_add_u32 s33, s43, 53248
  buffer_load_dwordx4 a[220:223], v2, s[60:63], s33 offen offset:3072
  s_add_u32 s33, s43, 57344
  buffer_load_dwordx4 a[224:227], v2, s[60:63], s33 offen offset:0
  s_add_u32 s33, s43, 57344
  buffer_load_dwordx4 a[228:231], v2, s[60:63], s33 offen offset:1024
  s_add_u32 s33, s43, 57344
  buffer_load_dwordx4 a[232:235], v2, s[60:63], s33 offen offset:2048
  s_add_u32 s33, s43, 57344
  buffer_load_dwordx4 a[236:239], v2, s[60:63], s33 offen offset:3072
  s_add_u32 s33, s43, 61440
  buffer_load_dwordx4 a[240:243], v2, s[60:63], s33 offen offset:0
  s_add_u32 s33, s43, 61440
  buffer_load_dwordx4 a[244:247], v2, s[60:63], s33 offen offset:1024
  s_add_u32 s33, s43, 61440
  buffer_load_dwordx4 a[248:251], v2, s[60:63], s33 offen offset:2048
  s_add_u32 s33, s43, 61440
  buffer_load_dwordx4 a[252:255], v2, s[60:63], s33 offen offset:3072
  s_add_u32 s33, s43, 65536
  buffer_load_dwordx4 v[232:235], v2, s[60:63], s33 offen offset:0
  s_add_u32 s33, s43, 65536
  buffer_load_dwordx4 v[236:239], v2, s[60:63], s33 offen offset:1024
  s_add_u32 s33, s43, 65536
  buffer_load_dwordx4 v[240:243], v2, s[60:63], s33 offen offset:2048
  s_add_u32 s33, s43, 65536
  buffer_load_dwordx4 v[244:247], v2, s[60:63], s33 offen offset:3072
  s_add_u32 s33, s43, 69632
  buffer_load_dwordx4 v[248:251], v2, s[60:63], s33 offen offset:0
  s_add_u32 s33, s43, 69632
  buffer_load_dwordx4 v[252:255], v2, s[60:63], s33 offen offset:1024
  s_waitcnt vmcnt(28)
  s_barrier
  s_barrier
  s_branch L_sp_h_8_j
L_sp_h_8_p:
  s_waitcnt vmcnt(0)
  s_barrier
  s_add_u32 s16, s4, 0x8000
  s_addc_u32 s17, s5, 0
  s_mov_b32 s18, 0x800
  s_mov_b32 s19, 0x00020000
  s_lshl_b32 s33, s22, 2
  s_add_u32 s33, s33, s30
  v_mov_b32 v10, s33
  v_mov_b32 v11, s25
  s_mov_b64 s[40:41], exec
  s_mov_b64 exec, 1
  s_cmp_eq_u32 s26, 0
  s_cbranch_scc1 L_slow_h_9
  buffer_store_dword v11, v10, s[16:19], 0 offen
  s_branch L_slow_h_9_d
L_slow_h_9:
  buffer_wbl2 sc1
  s_waitcnt vmcnt(0)
  buffer_store_dword v11, v10, s[16:19], 0 offen sc1
L_slow_h_9_d:
  s_mov_b64 exec, s[40:41]
  v_and_b32 v8, 15, v1
  v_lshlrev_b32 v8, 2, v8
  v_add_u32 v8, s30, v8
  s_mov_b32 s42, 0
L_poll_h_10:
  buffer_load_dword v9, v8, s[16:19], 0 offen sc1
  s_waitcnt vmcnt(0)
  v_cmp_ne_u32 vcc, s25, v9
  s_add_u32 s42, s42, 1
  s_cmp_gt_u32 s42, 1048576
  s_cbranch_scc1 L_poll_h_10_done
  s_cmp_lg_u64 vcc, 0
  s_cbranch_scc1 L_poll_h_10
L_poll_h_10_done:
  s_add_u32 s33, s43, 40960
  buffer_load_dwordx4 a[168:171], v2, s[60:63], s33 offen offset:2048
  s_add_u32 s33, s43, 40960
  buffer_load_dwordx4 a[172:175], v2, s[60:63], s33 offen offset:3072
  s_add_u32 s33, s43, 45056
  buffer_load_dwordx4 a[176:179], v2, s[60:63], s33 offen offset:0
  s_add_u32 s33, s43, 45056
  buffer_load_dwordx4 a[180:183], v2, s[60:63], s33 offen offset:1024
  s_add_u32 s33, s43, 45056
  buffer_load_dwordx4 a[184:187], v2, s[60:63], s33 offen offset:2048
  s_add_u32 s33, s43, 45056
  buffer_load_dwordx4 a[188:191], v2, s[60:63], s33 offen offset:3072
  s_add_u32 s33, s43, 49152
  buffer_load_dwordx4 a[192:195], v2, s[60:63], s33 offen offset:0
  s_add_u32 s33, s43, 49152
  buffer_load_dwordx4 a[196:199], v2, s[60:63], s33 offen offset:1024
  s_add_u32 s33, s43, 49152
  buffer_load_dwordx4 a[200:203], v2, s[60:63], s33 offen offset:2048
  s_add_u32 s33, s43, 49152
  buffer_load_dwordx4 a[204:207], v2, s[60:63], s33 offen offset:3072
  s_add_u32 s33, s43, 53248
  buffer_load_dwordx4 a[208:211], v2, s[60:63], s33 offen offset:0
  s_add_u32 s33, s43, 53248
  buffer_load_dwordx4 a[212:215], v2, s[60:63], s33 offen offset:1024
  s_add_u32 s33, s43, 53248
  buffer_load_dwordx4 a[216:219], v2, s[60:63], s33 offen offset:2048
  s_add_u32 s33, s43, 53248
  buffer_load_dwordx4 a[220:223], v2, s[60:63], s33 offen offset:3072
  s_add_u32 s33, s43, 57344
  buffer_load_dwordx4 a[224:227], v2, s[60:63], s33 offen offset:0
  s_add_u32 s33, s43, 57344
  buffer_load_dwordx4 a[228:231], v2, s[60:63], s33 offen offset:1024
  s_add_u32 s33, s43, 57344
  buffer_load_dwordx4 a[232:235], v2, s[60:63], s33 offen offset:2048
  s_add_u32 s33, s43, 57344
  buffer_load_dwordx4 a[236:239], v2, s[60:63], s33 offen offset:3072
  s_barrier
L_sp_h_8_j:
  s_mov_b32 s48, s12
  s_mov_b32 s49, s13
  s_mov_b32 s50, 0x500
  s_mov_b32 s51, 0x00020000
  s_mov_b32 s52, s4
  s_mov_b32 s53, s5
  s_mov_b32 s54, 0x1e00
  s_mov_b32 s55, 0x00020000
  s_lshl_b32 s34, s24, 4
  s_cmp_eq_u32 s24, 3
  s_cselect_b32 s34, 44, s34
  s_lshl_b32 s34, s34, 10
  s_add_u32 s33, s24, 1
  s_and_b32 s33, s33, 3
  s_add_u32 s33, s33, s69
  s_mul_i32 s33, s33, 60416
  s_add_u32 s33, s33, s68
  s_add_u32 s64, s33, s34
  s_add_u32 s33, s24, 2
  s_and_b32 s33, s33, 3
  s_add_u32 s33, s33, s69
  s_mul_i32 s33, s33, 60416
  s_add_u32 s33, s33, s68
  s_add_u32 s65, s33, s34
  s_add_u32 s33, s24, 3
  s_and_b32 s33, s33, 3
  s_add_u32 s33, s33, s69
  s_mul_i32 s33, s33, 60416
  s_add_u32 s33, s33, s68
  s_add_u32 s66, s33, s34
  s_add_u32 s33, s24, 4
  s_and_b32 s33, s33, 3
  s_add_u32 s33, s33, s69
  s_mul_i32 s33, s33, 60416
  s_add_u32 s33, s33, s68
  s_add_u32 s67, s33, s34
  s_cmp_eq_u32 s24, 2
  s_cbranch_scc1 L_k2_g4b
  buffer_load_dwordx4 v[64:67], v2, s[44:47], s64 offen offset:0 sc1
  buffer_load_dwordx4 v[68:71], v2, s[44:47], s64 offen offset:1024 sc1
  buffer_load_dwordx4 v[72:75], v2, s[44:47], s64 offen offset:2048 sc1
  buffer_load_dwordx4 v[76:79], v2, s[44:47], s64 offen offset:3072 sc1
  s_add_u32 s64, s64, 4096
  buffer_load_dwordx4 v[80:83], v2, s[44:47], s64 offen offset:0 sc1
  buffer_load_dwordx4 v[84:87], v2, s[44:47], s64 offen offset:1024 sc1
  buffer_load_dwordx4 v[88:91], v2, s[44:47], s64 offen offset:2048 sc1
  s_waitcnt vmcnt(6)
  v_mfma_f32_16x16x32_bf16 v[128:131], a[0:3], v[64:67], 0
  buffer_load_dwordx4 v[92:95], v2, s[44:47], s64 offen offset:3072 sc1
  v_mfma_f32_16x16x32_bf16 v[132:135], a[4:7], v[64:67], 0
  v_mfma_f32_16x16x32_bf16 v[136:139], a[8:11], v[64:67], 0
  v_mfma_f32_16x16x32_bf16 v[140:143], a[12:15], v[64:67], 0
  v_mfma_f32_16x16x32_bf16 v[144:147], a[16:19], v[64:67], 0
  s_waitcnt vmcnt(6)
  v_mfma_f32_16x16x32_bf16 v[128:131], a[20:23], v[68:71], v[128:131]
  s_add_u32 s64, s64, 4096
  buffer_load_dwordx4 v[96:99], v2, s[44:47], s64 offen offset:0 sc1
  v_mfma_f32_16x16x32_bf16 v[132:135], a[24:27], v[68:71], v[132:135]
  v_mfma_f32_16x16x32_bf16 v[136:139], a[28:31], v[68:71], v[136:139]
  v_mfma_f32_16x16x32_bf16 v[140:143], a[32:35], v[68:71], v[140:143]
  v_mfma_f32_16x16x32_bf16 v[144:147], a[36:39], v[68:71], v[144:147]
  s_waitcnt vmcnt(6)
  v_mfma_f32_16x16x32_bf16 v[128:131], a[40:43], v[72:75], v[128:131]
  buffer_load_dwordx4 v[64:67], v2, s[44:47], s64 offen offset:1024 sc1
  v_mfma_f32_16x16x32_bf16 v[132:135], a[44:47], v[72:75], v[132:135]
  buffer_load_dwordx2 v[168:169], v21, s[48:51], 0 offen offset:0
  v_mfma_f32_16x16x32_bf16 v[136:139], a[48:51], v[72:75], v[136:139]
  v_mfma_f32_16x16x32_bf16 v[140:143], a[52:55], v[72:75], v[140:143]
  v_mfma_f32_16x16x32_bf16 v[144:147], a[56:59], v[72:75], v[144:147]
  s_waitcnt vmcnt(7)
  v_mfma_f32_16x16x32_bf16 v[128:131], a[60:63], v[76:79], v[128:131]
  buffer_load_dwordx4 v[68:71], v2, s[44:47], s64 offen offset:2048 sc1
  v_mfma_f32_16x16x32_bf16 v[132:135], a[64:67], v[76:79], v[132:135]
  buffer_load_dwordx2 v[170:171], v21, s[48:51], 0 offen offset:32
  v_mfma_f32_16x16x32_bf16 v[136:139], a[68:71], v[76:79], v[136:139]
  v_mfma_f32_16x16x32_bf16 v[140:143], a[72:75], v[76:79], v[140:143]
  v_mfma_f32_16x16x32_bf16 v[144:147], a[76:79], v[76:79], v[144:147]
  s_waitcnt vmcnt(8)
  v_mfma_f32_16x16x32_bf16 v[128:131], a[80:83], v[80:83], v[128:131]
  buffer_load_dwordx4 v[72:75], v2, s[44:47], s64 offen offset:3072 sc1
  v_mfma_f32_16x16x32_bf16 v[132:135], a[84:87], v[80:83], v[132:135]
  buffer_load_dwordx2 v[172:173], v21, s[48:51], 0 offen offset:64
  v_mfma_f32_16x16x32_bf16 v[136:139], a[88:91], v[80:83], v[136:139]
  v_mfma_f32_16x16x32_bf16 v[140:143], a[92:95], v[80:83], v[140:143]
  v_mfma_f32_16x16x32_bf16 v[144:147], a[96:99], v[80:83], v[144:147]
  s_waitcnt vmcnt(9)
  v_mfma_f32_16x16x32_bf16 v[128:131], a[100:103], v[84:87], v[128:131]
  s_add_u32 s64, s64, 4096
  buffer_load_dwordx4 v[76:79], v2, s[44:47], s64 offen offset:0 sc1
  v_mfma_f32_16x16x32_bf16 v[132:135], a[104:107], v[84:87], v[132:135]
  buffer_load_dwordx2 v[174:175], v21, s[48:51], 0 offen offset:96
  v_mfma_f32_16x16x32_bf16 v[136:139], a[108:111], v[84:87], v[136:139]
  v_mfma_f32_16x16x32_bf16 v[140:143], a[112:115], v[84:87], v[140:143]
  v_mfma_f32_16x16x32_bf16 v[144:147], a[116:119], v[84:87], v[144:147]
  s_waitcnt vmcnt(10)
  v_mfma_f32_16x16x32_bf16 v[128:131], a[120:123], v[88:91], v[128:131]
  buffer_load_dwordx4 v[80:83], v2, s[44:47], s64 offen offset:1024 sc1
  v_mfma_f32_16x16x32_bf16 v[132:135], a[124:127], v[88:91], v[132:135]
  buffer_load_dwordx2 v[176:177], v21, s[48:51], 0 offen offset:128
  v_mfma_f32_16x16x32_bf16 v[136:139], a[128:131], v[88:91], v[136:139]
  v_mfma_f32_16x16x32_bf16 v[140:143], a[132:135], v[88:91], v[140:143]
  v_mfma_f32_16x16x32_bf16 v[144:147], a[136:139], v[88:91], v[144:147]
  s_waitcnt vmcnt(11)
  v_mfma_f32_16x16x32_bf16 v[128:131], a[140:143], v[92:95], v[128:131]
  buffer_load_dwordx4 v[84:87], v2, s[44:47], s65 offen offset:0 sc1
  v_mfma_f32_16x16x32_bf16 v[132:135], a[144:147], v[92:95], v[132:135]
  buffer_load_dwordx2 v[178:179], v22, s[52:55], 0 offen offset:2304
  v_mfma_f32_16x16x32_bf16 v[136:139], a[148:151], v[92:95], v[136:139]
  v_mfma_f32_16x16x32_bf16 v[140:143], a[152:155], v[92:95], v[140:143]
  v_mfma_f32_16x16x32_bf16 v[144:147], a[156:159], v[92:95], v[144:147]
  s_waitcnt vmcnt(12)
  v_mfma_f32_16x16x32_bf16 v[128:131], a[160:163], v[96:99], v[128:131]
  buffer_load_dwordx4 v[88:91], v2, s[44:47], s65 offen offset:1024 sc1
  v_mfma_f32_16x16x32_bf16 v[132:135], a[164:167], v[96:99], v[132:135]
  buffer_load_dwordx2 v[180:181], v22, s[52:55], 0 offen offset:2336
  v_mfma_f32_16x16x32_bf16 v[136:139], a[168:171], v[96:99], v[136:139]
  v_mfma_f32_16x16x32_bf16 v[140:143], a[172:175], v[96:99], v[140:143]
  v_mfma_f32_16x16x32_bf16 v[144:147], a[176:179], v[96:99], v[144:147]
  s_waitcnt vmcnt(13)
  v_mfma_f32_16x16x32_bf16 v[128:131], a[180:183], v[64:67], v[128:131]
  buffer_load_dwordx4 v[92:95], v2, s[44:47], s65 offen offset:2048 sc1
  v_mfma_f32_16x16x32_bf16 v[132:135], a[184:187], v[64:67], v[132:135]
  buffer_load_dwordx2 v[182:183], v22, s[52:55], 0 offen offset:2368
  v_mfma_f32_16x16x32_bf16 v[136:139], a[188:191], v[64:67], v[136:139]
  v_mfma_f32_16x16x32_bf16 v[140:143], a[192:195], v[64:67], v[140:143]
  v_mfma_f32_16x16x32_bf16 v[144:147], a[196:199], v[64:67], v[144:147]
  s_waitcnt vmcnt(13)
  v_mfma_f32_16x16x32_bf16 v[128:131], a[200:203], v[68:71], v[128:131]
  buffer_load_dwordx4 v[96:99], v2, s[44:47], s65 offen offset:3072 sc1
  v_mfma_f32_16x16x32_bf16 v[132:135], a[204:207], v[68:71], v[132:135]
  buffer_load_dwordx2 v[184:185], v22, s[52:55], 0 offen offset:2400
  v_mfma_f32_16x16x32_bf16 v[136:139], a[208:211], v[68:71], v[136:139]
  v_mfma_f32_16x16x32_bf16 v[140:143], a[212:215], v[68:71], v[140:143]
  v_mfma_f32_16x16x32_bf16 v[144:147], a[216:219], v[68:71], v[144:147]
  s_waitcnt vmcnt(13)
  v_mfma_f32_16x16x32_bf16 v[128:131], a[220:223], v[72:75], v[128:131]
  s_add_u32 s65, s65, 4096
  buffer_load_dwordx4 v[64:67], v2, s[44:47], s65 offen offset:0 sc1
  v_mfma_f32_16x16x32_bf16 v[132:135], a[224:227], v[72:75], v[132:135]
  buffer_load_dwordx2 v[186:187], v22, s[52:55], 0 offen offset:2432
  v_mfma_f32_16x16x32_bf16 v[136:139], a[228:231], v[72:75], v[136:139]
  v_mfma_f32_16x16x32_bf16 v[140:143], a[232:235], v[72:75], v[140:143]
  v_mfma_f32_16x16x32_bf16 v[144:147], a[236:239], v[72:75], v[144:147]
  s_waitcnt vmcnt(13)
  v_mfma_f32_16x16x32_bf16 v[128:131], a[240:243], v[76:79], v[128:131]
  buffer_load_dwordx4 v[68:71], v2, s[44:47], s65 offen offset:1024 sc1
  v_mfma_f32_16x16x32_bf16 v[132:135], a[244:247], v[76:79], v[132:135]
  v_mfma_f32_16x16x32_bf16 v[136:139], a[248:251], v[76:79], v[136:139]
  v_mfma_f32_16x16x32_bf16 v[140:143], a[252:255], v[76:79], v[140:143]
  v_mfma_f32_16x16x32_bf16 v[144:147], v[232:235], v[76:79], v[144:147]
  s_waitcnt vmcnt(12)
  v_mfma_f32_16x16x32_bf16 v[128:131], v[236:239], v[80:83], v[128:131]
  buffer_load_dwordx4 v[72:75], v2, s[44:47], s65 offen offset:2048 sc1
  v_mfma_f32_16x16x32_bf16 v[132:135], v[240:243], v[80:83], v[132:135]
  v_mfma_f32_16x16x32_bf16 v[136:139], v[244:247], v[80:83], v[136:139]
  v_mfma_f32_16x16x32_bf16 v[140:143], v[248:251], v[80:83], v[140:143]
  v_mfma_f32_16x16x32_bf16 v[144:147], v[252:255], v[80:83], v[144:147]
  s_waitcnt vmcnt(11)
  v_mfma_f32_16x16x32_bf16 v[148:151], a[0:3], v[84:87], 0
  buffer_load_dwordx4 v[76:79], v2, s[44:47], s65 offen offset:3072 sc1
  v_mfma_f32_16x16x32_bf16 v[152:155], a[4:7], v[84:87], 0
  v_mfma_f32_16x16x32_bf16 v[156:159], a[8:11], v[84:87], 0
  v_mfma_f32_16x16x32_bf16 v[160:163], a[12:15], v[84:87], 0
  v_mfma_f32_16x16x32_bf16 v[164:167], a[16:19], v[84:87], 0
  s_waitcnt vmcnt(10)
  v_mfma_f32_16x16x32_bf16 v[148:151], a[20:23], v[88:91], v[148:151]
  s_add_u32 s65, s65, 4096
  buffer_load_dwordx4 v[80:83], v2, s[44:47], s65 offen offset:0 sc1
  v_mfma_f32_16x16x32_bf16 v[152:155], a[24:27], v[88:91], v[152:155]
  v_mfma_f32_16x16x32_bf16 v[156:159], a[28:31], v[88:91], v[156:159]
  v_mfma_f32_16x16x32_bf16 v[160:163], a[32:35], v[88:91], v[160:163]
  v_mfma_f32_16x16x32_bf16 v[164:167], a[36:39], v[88:91], v[164:167]
  s_waitcnt vmcnt(9)
  s_add_u32 s33, s24, 1
  s_and_b32 s33, s33, 3
  s_mul_i32 s33, s33, 15360
  s_add_u32 s33, s33, 10240
  v_add_u32 v5, s33, v2
  v_mfma_f32_16x16x32_bf16 v[148:151], a[40:43], v[92:95], v[148:151]
  buffer_load_dwordx4 v[84:87], v2, s[44:47], s65 offen offset:1024 sc1
  v_mfma_f32_16x16x32_bf16 v[152:155], a[44:47], v[92:95], v[152:155]
  ds_write_b128 v5, v[128:131] offset:0
  v_mfma_f32_16x16x32_bf16 v[156:159], a[48:51], v[92:95], v[156:159]
  v_mfma_f32_16x16x32_bf16 v[160:163], a[52:55], v[92:95], v[160:163]
  v_mfma_f32_16x16x32_bf16 v[164:167], a[56:59], v[92:95], v[164:167]
  s_waitcnt vmcnt(8)
  v_mfma_f32_16x16x32_bf16 v[148:151], a[60:63], v[96:99], v[148:151]
  buffer_load_dwordx4 v[88:91], v2, s[44:47], s65 offen offset:2048 sc1
  v_mfma_f32_16x16x32_bf16 v[152:155], a[64:67], v[96:99], v[152:155]
  ds_write_b128 v5, v[132:135] offset:1024
  v_mfma_f32_16x16x32_bf16 v[156:159], a[68:71], v[96:99], v[156:159]
  v_mfma_f32_16x16x32_bf16 v[160:163], a[72:75], v[96:99], v[160:163]
  v_mfma_f32_16x16x32_bf16 v[164:167], a[76:79], v[96:99], v[164:167]
  s_waitcnt vmcnt(7)
  v_mfma_f32_16x16x32_bf16 v[148:151], a[80:83], v[64:67], v[148:151]
  buffer_load_dwordx4 v[92:95], v2, s[44:47], s65 offen offset:3072 sc1
  v_mfma_f32_16x16x32_bf16 v[152:155], a[84:87], v[64:67], v[152:155]
  ds_write_b128 v5, v[136:139] offset:2048
  v_mfma_f32_16x16x32_bf16 v[156:159], a[88:91], v[64:67], v[156:159]
  v_mfma_f32_16x16x32_bf16 v[160:163], a[92:95], v[64:67], v[160:163]
  v_mfma_f32_16x16x32_bf16 v[164:167], a[96:99], v[64:67], v[164:167]
  s_waitcnt vmcnt(6)
  v_mfma_f32_16x16x32_bf16 v[148:151], a[100:103], v[68:71], v[148:151]
  s_add_u32 s65, s65, 4096
  buffer_load_dwordx4 v[96:99], v2, s[44:47], s65 offen offset:0 sc1
  v_mfma_f32_16x16x32_bf16 v[152:155], a[104:107], v[68:71], v[152:155]
  ds_write_b128 v5, v[140:143] offset:3072
  v_mfma_f32_16x16x32_bf16 v[156:159], a[108:111], v[68:71], v[156:159]
  v_mfma_f32_16x16x32_bf16 v[160:163], a[112:115], v[68:71], v[160:163]
  v_mfma_f32_16x16x32_bf16 v[164:167], a[116:119], v[68:71], v[164:167]
  s_waitcnt vmcnt(6)
  v_mfma_f32_16x16x32_bf16 v[148:151], a[120:123], v[72:75], v[148:151]
  buffer_load_dwordx4 v[64:67], v2, s[44:47], s65 offen offset:1024 sc1
  v_mfma_f32_16x16x32_bf16 v[152:155], a[124:127], v[72:75], v[152:155]
  ds_write_b128 v5, v[144:147] offset:4096
  v_mfma_f32_16x16x32_bf16 v[156:159], a[128:131], v[72:75], v[156:159]
  v_mfma_f32_16x16x32_bf16 v[160:163], a[132:135], v[72:75], v[160:163]
  v_mfma_f32_16x16x32_bf16 v[164:167], a[136:139], v[72:75], v[164:167]
  s_waitcnt vmcnt(6)
  v_mfma_f32_16x16x32_bf16 v[148:151], a[140:143], v[76:79], v[148:151]
  buffer_load_dwordx4 v[68:71], v2, s[44:47], s66 offen offset:0 sc1
  v_mfma_f32_16x16x32_bf16 v[152:155], a[144:147], v[76:79], v[152:155]
  v_mfma_f32_16x16x32_bf16 v[156:159], a[148:151], v[76:79], v[156:159]
  v_mfma_f32_16x16x32_bf16 v[160:163], a[152:155], v[76:79], v[160:163]
  v_mfma_f32_16x16x32_bf16 v[164:167], a[156:159], v[76:79], v[164:167]
  s_waitcnt vmcnt(6)
  v_mfma_f32_16x16x32_bf16 v[148:151], a[160:163], v[80:83], v[148:151]
  buffer_load_dwordx4 v[72:75], v2, s[44:47], s66 offen offset:1024 sc1
  v_mfma_f32_16x16x32_bf16 v[152:155], a[164:167], v[80:83], v[152:155]
  v_mfma_f32_16x16x32_bf16 v[156:159], a[168:171], v[80:83], v[156:159]
  v_mfma_f32_16x16x32_bf16 v[160:163], a[172:175], v[80:83], v[160:163]
  v_mfma_f32_16x16x32_bf16 v[164:167], a[176:179], v[80:83], v[164:167]
  s_waitcnt vmcnt(6)
  v_mfma_f32_16x16x32_bf16 v[148:151], a[180:183], v[84:87], v[148:151]
  buffer_load_dwordx4 v[76:79], v2, s[44:47], s66 offen offset:2048 sc1
  v_mfma_f32_16x16x32_bf16 v[152:155], a[184:187], v[84:87], v[152:155]
  v_mfma_f32_16x16x32_bf16 v[156:159], a[188:191], v[84:87], v[156:159]
  v_mfma_f32_16x16x32_bf16 v[160:163], a[192:195], v[84:87], v[160:163]
  v_mfma_f32_16x16x32_bf16 v[164:167], a[196:199], v[84:87], v[164:167]
  s_waitcnt vmcnt(6)
  v_mfma_f32_16x16x32_bf16 v[148:151], a[200:203], v[88:91], v[148:151]
  buffer_load_dwordx4 v[80:83], v2, s[44:47], s66 offen offset:3072 sc1
  v_mfma_f32_16x16x32_bf16 v[152:155], a[204:207], v[88:91], v[152:155]
  v_mfma_f32_16x16x32_bf16 v[156:159], a[208:211], v[88:91], v[156:159]
  v_mfma_f32_16x16x32_bf16 v[160:163], a[212:215], v[88:91], v[160:163]
  v_mfma_f32_16x16x32_bf16 v[164:167], a[216:219], v[88:91], v[164:167]
  s_waitcnt vmcnt(6)
  v_mfma_f32_16x16x32_bf16 v[148:151], a[220:223], v[92:95], v[148:151]
  s_add_u32 s66, s66, 4096
  buffer_load_dwordx4 v[84:87], v2, s[44:47], s66 offen offset:0 sc1
  v_mfma_f32_16x16x32_bf16 v[152:155], a[224:227], v[92:95], v[152:155]
  v_mfma_f32_16x16x32_bf16 v[156:159], a[228:231], v[92:95], v[156:159]
  v_mfma_f32_16x16x32_bf16 v[160:163], a[232:235], v[92:95], v[160:163]
  v_mfma_f32_16x16x32_bf16 v[164:167], a[236:239], v[92:95], v[164:167]
  s_waitcnt vmcnt(6)
  v_mfma_f32_16x16x32_bf16 v[148:151], a[240:243], v[96:99], v[148:151]
  buffer_load_dwordx4 v[88:91], v2, s[44:47], s66 offen offset:1024 sc1
  v_mfma_f32_16x16x32_bf16 v[152:155], a[244:247], v[96:99], v[152:155]
  v_mfma_f32_16x16x32_bf16 v[156:159], a[248:251], v[96:99], v[156:159]
  v_mfma_f32_16x16x32_bf16 v[160:163], a[252:255], v[96:99], v[160:163]
  v_mfma_f32_16x16x32_bf16 v[164:167], v[232:235], v[96:99], v[164:167]
  s_waitcnt vmcnt(6)
  v_mfma_f32_16x16x32_bf16 v[148:151], v[236:239], v[64:67], v[148:151]
  buffer_load_dwordx4 v[92:95], v2, s[44:47], s66 offen offset:2048 sc1
  v_mfma_f32_16x16x32_bf16 v[152:155], v[240:243], v[64:67], v[152:155]
  v_mfma_f32_16x16x32_bf16 v[156:159], v[244:247], v[64:67], v[156:159]
  v_mfma_f32_16x16x32_bf16 v[160:163], v[248:251], v[64:67], v[160:163]
  v_mfma_f32_16x16x32_bf16 v[164:167], v[252:255], v[64:67], v[164:167]
  s_waitcnt vmcnt(6)
  v_mfma_f32_16x16x32_bf16 v[128:131], a[0:3], v[68:71], 0
  buffer_load_dwordx4 v[96:99], v2, s[44:47], s66 offen offset:3072 sc1
  v_mfma_f32_16x16x32_bf16 v[132:135], a[4:7], v[68:71], 0
  v_mfma_f32_16x16x32_bf16 v[136:139], a[8:11], v[68:71], 0
  v_mfma_f32_16x16x32_bf16 v[140:143], a[12:15], v[68:71], 0
  v_mfma_f32_16x16x32_bf16 v[144:147], a[16:19], v[68:71], 0
  s_waitcnt vmcnt(6)
  v_mfma_f32_16x16x32_bf16 v[128:131], a[20:23], v[72:75], v[128:131]
  s_add_u32 s66, s66, 4096
  buffer_load_dwordx4 v[64:67], v2, s[44:47], s66 offen offset:0 sc1
  v_mfma_f32_16x16x32_bf16 v[132:135], a[24:27], v[72:75], v[132:135]
  v_mfma_f32_16x16x32_bf16 v[136:139], a[28:31], v[72:75], v[136:139]
  v_mfma_f32_16x16x32_bf16 v[140:143], a[32:35], v[72:75], v[140:143]
  v_mfma_f32_16x16x32_bf16 v[144:147], a[36:39], v[72:75], v[144:147]
  s_waitcnt vmcnt(6)
  s_add_u32 s33, s24, 2
  s_and_b32 s33, s33, 3
  s_mul_i32 s33, s33, 15360
  s_add_u32 s33, s33, 5120
  v_add_u32 v5, s33, v2
  v_mfma_f32_16x16x32_bf16 v[128:131], a[40:43], v[76:79], v[128:131]
  buffer_load_dwordx4 v[68:71], v2, s[44:47], s66 offen offset:1024 sc1
  v_mfma_f32_16x16x32_bf16 v[132:135], a[44:47], v[76:79], v[132:135]
  ds_write_b128 v5, v[148:151] offset:0
  v_mfma_f32_16x16x32_bf16 v[136:139], a[48:51], v[76:79], v[136:139]
  v_mfma_f32_16x16x32_bf16 v[140:143], a[52:55], v[76:79], v[140:143]
  v_mfma_f32_16x16x32_bf16 v[144:147], a[56:59], v[76:79], v[144:147]
  s_waitcnt vmcnt(6)
  v_mfma_f32_16x16x32_bf16 v[128:131], a[60:63], v[80:83], v[128:131]
  buffer_load_dwordx4 v[72:75], v2, s[44:47], s66 offen offset:2048 sc1
  v_mfma_f32_16x16x32_bf16 v[132:135], a[64:67], v[80:83], v[132:135]
  ds_write_b128 v5, v[152:155] offset:1024
  v_mfma_f32_16x16x32_bf16 v[136:139], a[68:71], v[80:83], v[136:139]
  v_mfma_f32_16x16x32_bf16 v[140:143], a[72:75], v[80:83], v[140:143]
  v_mfma_f32_16x16x32_bf16 v[144:147], a[76:79], v[80:83], v[144:147]
  s_waitcnt vmcnt(6)
  v_mfma_f32_16x16x32_bf16 v[128:131], a[80:83], v[84:87], v[128:131]
  buffer_load_dwordx4 v[76:79], v2, s[44:47], s66 offen offset:3072 sc1
  v_mfma_f32_16x16x32_bf16 v[132:135], a[84:87], v[84:87], v[132:135]
  ds_write_b128 v5, v[156:159] offset:2048
  v_mfma_f32_16x16x32_bf16 v[136:139], a[88:91], v[84:87], v[136:139]
  v_mfma_f32_16x16x32_bf16 v[140:143], a[92:95], v[84:87], v[140:143]
  v_mfma_f32_16x16x32_bf16 v[144:147], a[96:99], v[84:87], v[144:147]
  s_waitcnt vmcnt(6)
  v_mfma_f32_16x16x32_bf16 v[128:131], a[100:103], v[88:91], v[128:131]
  s_add_u32 s66, s66, 4096
  buffer_load_dwordx4 v[80:83], v2, s[44:47], s66 offen offset:0 sc1
  v_mfma_f32_16x16x32_bf16 v[132:135], a[104:107], v[88:91], v[132:135]
  ds_write_b128 v5, v[160:163] offset:3072
  v_mfma_f32_16x16x32_bf16 v[136:139], a[108:111], v[88:91], v[136:139]
  v_mfma_f32_16x16x32_bf16 v[140:143], a[112:115], v[88:91], v[140:143]
  v_mfma_f32_16x16x32_bf16 v[144:147], a[116:119], v[88:91], v[144:147]
  s_waitcnt vmcnt(6)
  v_mfma_f32_16x16x32_bf16 v[128:131], a[120:123], v[92:95], v[128:131]
  buffer_load_dwordx4 v[84:87], v2, s[44:47], s66 offen offset:1024 sc1
  v_mfma_f32_16x16x32_bf16 v[132:135], a[124:127], v[92:95], v[132:135]
  ds_write_b128 v5, v[164:167] offset:4096
  v_mfma_f32_16x16x32_bf16 v[136:139], a[128:131], v[92:95], v[136:139]
  v_mfma_f32_16x16x32_bf16 v[140:143], a[132:135], v[92:95], v[140:143]
  v_mfma_f32_16x16x32_bf16 v[144:147], a[136:139], v[92:95], v[144:147]
  s_waitcnt vmcnt(6)
  v_mfma_f32_16x16x32_bf16 v[128:131], a[140:143], v[96:99], v[128:131]
  buffer_load_dwordx4 v[88:91], v2, s[44:47], s67 offen offset:0 sc1
  v_mfma_f32_16x16x32_bf16 v[132:135], a[144:147], v[96:99], v[132:135]
  v_mfma_f32_16x16x32_bf16 v[136:139], a[148:151], v[96:99], v[136:139]
  v_mfma_f32_16x16x32_bf16 v[140:143], a[152:155], v[96:99], v[140:143]
  v_mfma_f32_16x16x32_bf16 v[144:147], a[156:159], v[96:99], v[144:147]
  s_waitcnt vmcnt(6)
  v_mfma_f32_16x16x32_bf16 v[128:131], a[160:163], v[64:67], v[128:131]
  buffer_load_dwordx4 v[92:95], v2, s[44:47], s67 offen offset:1024 sc1
  v_mfma_f32_16x16x32_bf16 v[132:135], a[164:167], v[64:67], v[132:135]
  v_mfma_f32_16x16x32_bf16 v[136:139], a[168:171], v[64:67], v[136:139]
  v_mfma_f32_16x16x32_bf16 v[140:143], a[172:175], v[64:67], v[140:143]
  v_mfma_f32_16x16x32_bf16 v[144:147], a[176:179], v[64:67], v[144:147]
  s_waitcnt vmcnt(6)
  v_mfma_f32_16x16x32_bf16 v[128:131], a[180:183], v[68:71], v[128:131]
  buffer_load_dwordx4 v[96:99], v2, s[44:47], s67 offen offset:2048 sc1
  v_mfma_f32_16x16x32_bf16 v[132:135], a[184:187], v[68:71], v[132:135]
  v_mfma_f32_16x16x32_bf16 v[136:139], a[188:191], v[68:71], v[136:139]
  v_mfma_f32_16x16x32_bf16 v[140:143], a[192:195], v[68:71], v[140:143]
  v_mfma_f32_16x16x32_bf16 v[144:147], a[196:199], v[68:71], v[144:147]
  s_waitcnt vmcnt(6)
  v_mfma_f32_16x16x32_bf16 v[128:131], a[200:203], v[72:75], v[128:131]
  buffer_load_dwordx4 v[64:67], v2, s[44:47], s67 offen offset:3072 sc1
  v_mfma_f32_16x16x32_bf16 v[132:135], a[204:207], v[72:75], v[132:135]
  v_mfma_f32_16x16x32_bf16 v[136:139], a[208:211], v[72:75], v[136:139]
  v_mfma_f32_16x16x32_bf16 v[140:143], a[212:215], v[72:75], v[140:143]
  v_mfma_f32_16x16x32_bf16 v[144:147], a[216:219], v[72:75], v[144:147]
  s_waitcnt vmcnt(6)
  v_mfma_f32_16x16x32_bf16 v[128:131], a[220:223], v[76:79], v[128:131]
  s_add_u32 s67, s67, 4096
  buffer_load_dwordx4 v[68:71], v2, s[44:47], s67 offen offset:0 sc1
  v_mfma_f32_16x16x32_bf16 v[132:135], a[224:227], v[76:79], v[132:135]
  v_mfma_f32_16x16x32_bf16 v[136:139], a[228:231], v[76:79], v[136:139]
  v_mfma_f32_16x16x32_bf16 v[140:143], a[232:235], v[76:79], v[140:143]
  v_mfma_f32_16x16x32_bf16 v[144:147], a[236:239], v[76:79], v[144:147]
  s_waitcnt vmcnt(6)
  v_mfma_f32_16x16x32_bf16 v[128:131], a[240:243], v[80:83], v[128:131]
  buffer_load_dwordx4 v[72:75], v2, s[44:47], s67 offen offset:1024 sc1
  v_mfma_f32_16x16x32_bf16 v[132:135], a[244:247], v[80:83], v[132:135]
  v_mfma_f32_16x16x32_bf16 v[136:139], a[248:251], v[80:83], v[136:139]
  v_mfma_f32_16x16x32_bf16 v[140:143], a[252:255], v[80:83], v[140:143]
  v_mfma_f32_16x16x32_bf16 v[144:147], v[232:235], v[80:83], v[144:147]
  s_waitcnt vmcnt(6)
  v_mfma_f32_16x16x32_bf16 v[128:131], v[236:239], v[84:87], v[128:131]
  buffer_load_dwordx4 v[76:79], v2, s[44:47], s67 offen offset:2048 sc1
  v_mfma_f32_16x16x32_bf16 v[132:135], v[240:243], v[84:87], v[132:135]
  v_mfma_f32_16x16x32_bf16 v[136:139], v[244:247], v[84:87], v[136:139]
  v_mfma_f32_16x16x32_bf16 v[140:143], v[248:251], v[84:87], v[140:143]
  v_mfma_f32_16x16x32_bf16 v[144:147], v[252:255], v[84:87], v[144:147]
  s_waitcnt vmcnt(6)
  v_mfma_f32_16x16x32_bf16 v[148:151], a[0:3], v[88:91], 0
  buffer_load_dwordx4 v[80:83], v2, s[44:47], s67 offen offset:3072 sc1
  v_mfma_f32_16x16x32_bf16 v[152:155], a[4:7], v[88:91], 0
  v_mfma_f32_16x16x32_bf16 v[156:159], a[8:11], v[88:91], 0
  v_mfma_f32_16x16x32_bf16 v[160:163], a[12:15], v[88:91], 0
  v_mfma_f32_16x16x32_bf16 v[164:167], a[16:19], v[88:91], 0
  s_waitcnt vmcnt(6)
  v_mfma_f32_16x16x32_bf16 v[148:151], a[20:23], v[92:95], v[148:151]
  s_add_u32 s67, s67, 4096
  buffer_load_dwordx4 v[84:87], v2, s[44:47], s67 offen offset:0 sc1
  v_mfma_f32_16x16x32_bf16 v[152:155], a[24:27], v[92:95], v[152:155]
  v_mfma_f32_16x16x32_bf16 v[156:159], a[28:31], v[92:95], v[156:159]
  v_mfma_f32_16x16x32_bf16 v[160:163], a[32:35], v[92:95], v[160:163]
  v_mfma_f32_16x16x32_bf16 v[164:167], a[36:39], v[92:95], v[164:167]
  s_waitcnt vmcnt(6)
  s_add_u32 s33, s24, 3
  s_and_b32 s33, s33, 3
  s_mul_i32 s33, s33, 15360
  s_add_u32 s33, s33, 0
  v_add_u32 v5, s33, v2
  v_mfma_f32_16x16x32_bf16 v[148:151], a[40:43], v[96:99], v[148:151]
  buffer_load_dwordx4 v[88:91], v2, s[44:47], s67 offen offset:1024 sc1
  v_mfma_f32_16x16x32_bf16 v[152:155], a[44:47], v[96:99], v[152:155]
  ds_write_b128 v5, v[128:131] offset:0
  v_mfma_f32_16x16x32_bf16 v[156:159], a[48:51], v[96:99], v[156:159]
  v_mfma_f32_16x16x32_bf16 v[160:163], a[52:55], v[96:99], v[160:163]
  v_mfma_f32_16x16x32_bf16 v[164:167], a[56:59], v[96:99], v[164:167]
  s_waitcnt vmcnt(6)
  v_mfma_f32_16x16x32_bf16 v[148:151], a[60:63], v[64:67], v[148:151]
  buffer_load_dwordx4 v[92:95], v2, s[44:47], s67 offen offset:2048 sc1
  v_mfma_f32_16x16x32_bf16 v[152:155], a[64:67], v[64:67], v[152:155]
  ds_write_b128 v5, v[132:135] offset:1024
  v_mfma_f32_16x16x32_bf16 v[156:159], a[68:71], v[64:67], v[156:159]
  v_mfma_f32_16x16x32_bf16 v[160:163], a[72:75], v[64:67], v[160:163]
  v_mfma_f32_16x16x32_bf16 v[164:167], a[76:79], v[64:67], v[164:167]
  s_waitcnt vmcnt(6)
  v_mfma_f32_16x16x32_bf16 v[148:151], a[80:83], v[68:71], v[148:151]
  buffer_load_dwordx4 v[96:99], v2, s[44:47], s67 offen offset:3072 sc1
  v_mfma_f32_16x16x32_bf16 v[152:155], a[84:87], v[68:71], v[152:155]
  ds_write_b128 v5, v[136:139] offset:2048
  v_mfma_f32_16x16x32_bf16 v[156:159], a[88:91], v[68:71], v[156:159]
  v_mfma_f32_16x16x32_bf16 v[160:163], a[92:95], v[68:71], v[160:163]
  v_mfma_f32_16x16x32_bf16 v[164:167], a[96:99], v[68:71], v[164:167]
  s_waitcnt vmcnt(6)
  v_mfma_f32_16x16x32_bf16 v[148:151], a[100:103], v[72:75], v[148:151]
  s_add_u32 s67, s67, 4096
  buffer_load_dwordx4 v[64:67], v2, s[44:47], s67 offen offset:0 sc1
  v_mfma_f32_16x16x32_bf16 v[152:155], a[104:107], v[72:75], v[152:155]
  ds_write_b128 v5, v[140:143] offset:3072
  v_mfma_f32_16x16x32_bf16 v[156:159], a[108:111], v[72:75], v[156:159]
  v_mfma_f32_16x16x32_bf16 v[160:163], a[112:115], v[72:75], v[160:163]
  v_mfma_f32_16x16x32_bf16 v[164:167], a[116:119], v[72:75], v[164:167]
  s_waitcnt vmcnt(6)
  v_mfma_f32_16x16x32_bf16 v[148:151], a[120:123], v[76:79], v[148:151]
  buffer_load_dwordx4 v[68:71], v2, s[44:47], s67 offen offset:1024 sc1
  v_mfma_f32_16x16x32_bf16 v[152:155], a[124:127], v[76:79], v[152:155]
  ds_write_b128 v5, v[144:147] offset:4096
  v_mfma_f32_16x16x32_bf16 v[156:159], a[128:131], v[76:79], v[156:159]
  v_mfma_f32_16x16x32_bf16 v[160:163], a[132:135], v[76:79], v[160:163]
  v_mfma_f32_16x16x32_bf16 v[164:167], a[136:139], v[76:79], v[164:167]
  s_waitcnt vmcnt(6)
  v_mfma_f32_16x16x32_bf16 v[148:151], a[140:143], v[80:83], v[148:151]
  v_mfma_f32_16x16x32_bf16 v[152:155], a[144:147], v[80:83], v[152:155]
  v_mfma_f32_16x16x32_bf16 v[156:159], a[148:151], v[80:83], v[156:159]
  v_mfma_f32_16x16x32_bf16 v[160:163], a[152:155], v[80:83], v[160:163]
  v_mfma_f32_16x16x32_bf16 v[164:167], a[156:159], v[80:83], v[164:167]
  s_waitcnt vmcnt(5)
  v_mfma_f32_16x16x32_bf16 v[148:151], a[160:163], v[84:87], v[148:151]
  v_mfma_f32_16x16x32_bf16 v[152:155], a[164:167], v[84:87], v[152:155]
  v_mfma_f32_16x16x32_bf16 v[156:159], a[168:171], v[84:87], v[156:159]
  v_mfma_f32_16x16x32_bf16 v[160:163], a[172:175], v[84:87], v[160:163]
  v_mfma_f32_16x16x32_bf16 v[164:167], a[176:179], v[84:87], v[164:167]
  s_waitcnt vmcnt(4)
  v_mfma_f32_16x16x32_bf16 v[148:151], a[180:183], v[88:91], v[148:151]
  v_mfma_f32_16x16x32_bf16 v[152:155], a[184:187], v[88:91], v[152:155]
  v_mfma_f32_16x16x32_bf16 v[156:159], a[188:191], v[88:91], v[156:159]
  v_mfma_f32_16x16x32_bf16 v[160:163], a[192:195], v[88:91], v[160:163]
  v_mfma_f32_16x16x32_bf16 v[164:167], a[196:199], v[88:91], v[164:167]
  s_waitcnt vmcnt(3)
  v_mfma_f32_16x16x32_bf16 v[148:151], a[200:203], v[92:95], v[148:151]
  v_mfma_f32_16x16x32_bf16 v[152:155], a[204:207], v[92:95], v[152:155]
  v_mfma_f32_16x16x32_bf16 v[156:159], a[208:211], v[92:95], v[156:159]
  v_mfma_f32_16x16x32_bf16 v[160:163], a[212:215], v[92:95], v[160:163]
  v_mfma_f32_16x16x32_bf16 v[164:167], a[216:219], v[92:95], v[164:167]
  s_waitcnt vmcnt(2)
  v_mfma_f32_16x16x32_bf16 v[148:151], a[220:223], v[96:99], v[148:151]
  v_mfma_f32_16x16x32_bf16 v[152:155], a[224:227], v[96:99], v[152:155]
  v_mfma_f32_16x16x32_bf16 v[156:159], a[228:231], v[96:99], v[156:159]
  v_mfma_f32_16x16x32_bf16 v[160:163], a[232:235], v[96:99], v[160:163]
  v_mfma_f32_16x16x32_bf16 v[164:167], a[236:239], v[96:99], v[164:167]
  s_waitcnt vmcnt(1)
  v_mfma_f32_16x16x32_bf16 v[148:151], a[240:243], v[64:67], v[148:151]
  v_mfma_f32_16x16x32_bf16 v[152:155], a[244:247], v[64:67], v[152:155]
  v_mfma_f32_16x16x32_bf16 v[156:159], a[248:251], v[64:67], v[156:159]
  v_mfma_f32_16x16x32_bf16 v[160:163], a[252:255], v[64:67], v[160:163]
  v_mfma_f32_16x16x32_bf16 v[164:167], v[232:235], v[64:67], v[164:167]
  s_waitcnt vmcnt(0)
  v_mfma_f32_16x16x32_bf16 v[148:151], v[236:239], v[68:71], v[148:151]
  v_mfma_f32_16x16x32_bf16 v[152:155], v[240:243], v[68:71], v[152:155]
  v_mfma_f32_16x16x32_bf16 v[156:159], v[244:247], v[68:71], v[156:159]
  v_mfma_f32_16x16x32_bf16 v[160:163], v[248:251], v[68:71], v[160:163]
  v_mfma_f32_16x16x32_bf16 v[164:167], v[252:255], v[68:71], v[164:167]
  s_waitcnt lgkmcnt(0)
  s_branch L_k2_g4j
L_k2_g4b:
  buffer_load_dwordx4 v[64:67], v2, s[44:47], s64 offen offset:0 sc1
  buffer_load_dwordx4 v[68:71], v2, s[44:47], s64 offen offset:1024 sc1
  buffer_load_dwordx4 v[72:75], v2, s[44:47], s64 offen offset:2048 sc1
  buffer_load_dwordx4 v[76:79], v2, s[44:47], s64 offen offset:3072 sc1
  s_add_u32 s64, s64, 4096
  buffer_load_dwordx4 v[80:83], v2, s[44:47], s64 offen offset:0 sc1
  buffer_load_dwordx4 v[84:87], v2, s[44:47], s64 offen offset:1024 sc1
  buffer_load_dwordx4 v[88:91], v2, s[44:47], s64 offen offset:2048 sc1
  s_waitcnt vmcnt(6)
  v_mfma_f32_16x16x32_bf16 v[128:131], a[0:3], v[64:67], 0
  buffer_load_dwordx4 v[92:95], v2, s[44:47], s64 offen offset:3072 sc1
  v_mfma_f32_16x16x32_bf16 v[132:135], a[4:7], v[64:67], 0
  v_mfma_f32_16x16x32_bf16 v[136:139], a[8:11], v[64:67], 0
  v_mfma_f32_16x16x32_bf16 v[140:143], a[12:15], v[64:67], 0
  v_mfma_f32_16x16x32_bf16 v[144:147], a[16:19], v[64:67], 0
  s_waitcnt vmcnt(6)
  v_mfma_f32_16x16x32_bf16 v[128:131], a[20:23], v[68:71], v[128:131]
  s_add_u32 s64, s64, 4096
  buffer_load_dwordx4 v[96:99], v2, s[44:47], s64 offen offset:0 sc1
  v_mfma_f32_16x16x32_bf16 v[132:135], a[24:27], v[68:71], v[132:135]
  v_mfma_f32_16x16x32_bf16 v[136:139], a[28:31], v[68:71], v[136:139]
  v_mfma_f32_16x16x32_bf16 v[140:143], a[32:35], v[68:71], v[140:143]
  v_mfma_f32_16x16x32_bf16 v[144:147], a[36:39], v[68:71], v[144:147]
  s_waitcnt vmcnt(6)
  v_mfma_f32_16x16x32_bf16 v[128:131], a[40:43], v[72:75], v[128:131]
  buffer_load_dwordx4 v[64:67], v2, s[44:47], s64 offen offset:1024 sc1
  v_mfma_f32_16x16x32_bf16 v[132:135], a[44:47], v[72:75], v[132:135]
  buffer_load_dwordx2 v[168:169], v21, s[48:51], 0 offen offset:0
  v_mfma_f32_16x16x32_bf16 v[136:139], a[48:51], v[72:75], v[136:139]
  v_mfma_f32_16x16x32_bf16 v[140:143], a[52:55], v[72:75], v[140:143]
  v_mfma_f32_16x16x32_bf16 v[144:147], a[56:59], v[72:75], v[144:147]
  s_waitcnt vmcnt(7)
  v_mfma_f32_16x16x32_bf16 v[128:131], a[60:63], v[76:79], v[128:131]
  buffer_load_dwordx4 v[68:71], v2, s[44:47], s64 offen offset:2048 sc1
  v_mfma_f32_16x16x32_bf16 v[132:135], a[64:67], v[76:79], v[132:135]
  buffer_load_dwordx2 v[170:171], v21, s[48:51], 0 offen offset:32
  v_mfma_f32_16x16x32_bf16 v[136:139], a[68:71], v[76:79], v[136:139]
  v_mfma_f32_16x16x32_bf16 v[140:143], a[72:75], v[76:79], v[140:143]
  v_mfma_f32_16x16x32_bf16 v[144:147], a[76:79], v[76:79], v[144:147]
  s_waitcnt vmcnt(8)
  v_mfma_f32_16x16x32_bf16 v[128:131], a[80:83], v[80:83], v[128:131]
  buffer_load_dwordx4 v[72:75], v2, s[44:47], s64 offen offset:3072 sc1
  v_mfma_f32_16x16x32_bf16 v[132:135], a[84:87], v[80:83], v[132:135]
  buffer_load_dwordx2 v[172:173], v21, s[48:51], 0 offen offset:64
  v_mfma_f32_16x16x32_bf16 v[136:139], a[88:91], v[80:83], v[136:139]
  v_mfma_f32_16x16x32_bf16 v[140:143], a[92:95], v[80:83], v[140:143]
  v_mfma_f32_16x16x32_bf16 v[144:147], a[96:99], v[80:83], v[144:147]
  s_waitcnt vmcnt(9)
  v_mfma_f32_16x16x32_bf16 v[128:131], a[100:103], v[84:87], v[128:131]
  buffer_load_dwordx4 v[76:79], v2, s[44:47], s65 offen offset:0 sc1
  v_mfma_f32_16x16x32_bf16 v[132:135], a[104:107], v[84:87], v[132:135]
  buffer_load_dwordx2 v[174:175], v21, s[48:51], 0 offen offset:96
  v_mfma_f32_16x16x32_bf16 v[136:139], a[108:111], v[84:87], v[136:139]
  v_mfma_f32_16x16x32_bf16 v[140:143], a[112:115], v[84:87], v[140:143]
  v_mfma_f32_16x16x32_bf16 v[144:147], a[116:119], v[84:87], v[144:147]
  s_waitcnt vmcnt(10)
  v_mfma_f32_16x16x32_bf16 v[128:131], a[120:123], v[88:91], v[128:131]
  buffer_load_dwordx4 v[80:83], v2, s[44:47], s65 offen offset:1024 sc1
  v_mfma_f32_16x16x32_bf16 v[132:135], a[124:127], v[88:91], v[132:135]
  buffer_load_dwordx2 v[176:177], v21, s[48:51], 0 offen offset:128
  v_mfma_f32_16x16x32_bf16 v[136:139], a[128:131], v[88:91], v[136:139]
  v_mfma_f32_16x16x32_bf16 v[140:143], a[132:135], v[88:91], v[140:143]
  v_mfma_f32_16x16x32_bf16 v[144:147], a[136:139], v[88:91], v[144:147]
  s_waitcnt vmcnt(11)
  v_mfma_f32_16x16x32_bf16 v[128:131], a[140:143], v[92:95], v[128:131]
  buffer_load_dwordx4 v[84:87], v2, s[44:47], s65 offen offset:2048 sc1
  v_mfma_f32_16x16x32_bf16 v[132:135], a[144:147], v[92:95], v[132:135]
  buffer_load_dwordx2 v[178:179], v22, s[52:55], 0 offen offset:2304
  v_mfma_f32_16x16x32_bf16 v[136:139], a[148:151], v[92:95], v[136:139]
  v_mfma_f32_16x16x32_bf16 v[140:143], a[152:155], v[92:95], v[140:143]
  v_mfma_f32_16x16x32_bf16 v[144:147], a[156:159], v[92:95], v[144:147]
  s_waitcnt vmcnt(12)
  v_mfma_f32_16x16x32_bf16 v[128:131], a[160:163], v[96:99], v[128:131]
  buffer_load_dwordx4 v[88:91], v2, s[44:47], s65 offen offset:3072 sc1
  v_mfma_f32_16x16x32_bf16 v[132:135], a[164:167], v[96:99], v[132:135]
  buffer_load_dwordx2 v[180:181], v22, s[52:55], 0 offen offset:2336
  v_mfma_f32_16x16x32_bf16 v[136:139], a[168:171], v[96:99], v[136:139]
  v_mfma_f32_16x16x32_bf16 v[140:143], a[172:175], v[96:99], v[140:143]
  v_mfma_f32_16x16x32_bf16 v[144:147], a[176:179], v[96:99], v[144:147]
  s_waitcnt vmcnt(13)
  v_mfma_f32_16x16x32_bf16 v[128:131], a[180:183], v[64:67], v[128:131]
  s_add_u32 s65, s65, 4096
  buffer_load_dwordx4 v[92:95], v2, s[44:47], s65 offen offset:0 sc1
  v_mfma_f32_16x16x32_bf16 v[132:135], a[184:187], v[64:67], v[132:135]
  buffer_load_dwordx2 v[182:183], v22, s[52:55], 0 offen offset:2368
  v_mfma_f32_16x16x32_bf16 v[136:139], a[188:191], v[64:67], v[136:139]
  v_mfma_f32_16x16x32_bf16 v[140:143], a[192:195], v[64:67], v[140:143]
  v_mfma_f32_16x16x32_bf16 v[144:147], a[196:199], v[64:67], v[144:147]
  s_waitcnt vmcnt(13)
  v_mfma_f32_16x16x32_bf16 v[128:131], a[200:203], v[68:71], v[128:131]
  buffer_load_dwordx4 v[96:99], v2, s[44:47], s65 offen offset:1024 sc1
  v_mfma_f32_16x16x32_bf16 v[132:135], a[204:207], v[68:71], v[132:135]
  buffer_load_dwordx2 v[184:185], v22, s[52:55], 0 offen offset:2400
  v_mfma_f32_16x16x32_bf16 v[136:139], a[208:211], v[68:71], v[136:139]
  v_mfma_f32_16x16x32_bf16 v[140:143], a[212:215], v[68:71], v[140:143]
  v_mfma_f32_16x16x32_bf16 v[144:147], a[216:219], v[68:71], v[144:147]
  s_waitcnt vmcnt(13)
  v_mfma_f32_16x16x32_bf16 v[128:131], a[220:223], v[72:75], v[128:131]
  buffer_load_dwordx4 v[64:67], v2, s[44:47], s65 offen offset:2048 sc1
  v_mfma_f32_16x16x32_bf16 v[132:135], a[224:227], v[72:75], v[132:135]
  buffer_load_dwordx2 v[186:187], v22, s[52:55], 0 offen offset:2432
  v_mfma_f32_16x16x32_bf16 v[136:139], a[228:231], v[72:75], v[136:139]
  v_mfma_f32_16x16x32_bf16 v[140:143], a[232:235], v[72:75], v[140:143]
  v_mfma_f32_16x16x32_bf16 v[144:147], a[236:239], v[72:75], v[144:147]
  s_waitcnt vmcnt(13)
  v_mfma_f32_16x16x32_bf16 v[148:151], a[0:3], v[76:79], 0
  buffer_load_dwordx4 v[68:71], v2, s[44:47], s65 offen offset:3072 sc1
  v_mfma_f32_16x16x32_bf16 v[152:155], a[4:7], v[76:79], 0
  v_mfma_f32_16x16x32_bf16 v[156:159], a[8:11], v[76:79], 0
  v_mfma_f32_16x16x32_bf16 v[160:163], a[12:15], v[76:79], 0
  v_mfma_f32_16x16x32_bf16 v[164:167], a[16:19], v[76:79], 0
  s_waitcnt vmcnt(12)
  v_mfma_f32_16x16x32_bf16 v[148:151], a[20:23], v[80:83], v[148:151]
  s_add_u32 s65, s65, 4096
  buffer_load_dwordx4 v[72:75], v2, s[44:47], s65 offen offset:0 sc1
  v_mfma_f32_16x16x32_bf16 v[152:155], a[24:27], v[80:83], v[152:155]
  v_mfma_f32_16x16x32_bf16 v[156:159], a[28:31], v[80:83], v[156:159]
  v_mfma_f32_16x16x32_bf16 v[160:163], a[32:35], v[80:83], v[160:163]
  v_mfma_f32_16x16x32_bf16 v[164:167], a[36:39], v[80:83], v[164:167]
  s_waitcnt vmcnt(11)
  s_add_u32 s33, s24, 1
  s_and_b32 s33, s33, 3
  s_mul_i32 s33, s33, 15360
  s_add_u32 s33, s33, 10240
  v_add_u32 v5, s33, v2
  v_mfma_f32_16x16x32_bf16 v[148:151], a[40:43], v[84:87], v[148:151]
  buffer_load_dwordx4 v[76:79], v2, s[44:47], s65 offen offset:1024 sc1
  v_mfma_f32_16x16x32_bf16 v[152:155], a[44:47], v[84:87], v[152:155]
  ds_write_b128 v5, v[128:131] offset:0
  v_mfma_f32_16x16x32_bf16 v[156:159], a[48:51], v[84:87], v[156:159]
  v_mfma_f32_16x16x32_bf16 v[160:163], a[52:55], v[84:87], v[160:163]
  v_mfma_f32_16x16x32_bf16 v[164:167], a[56:59], v[84:87], v[164:167]
  s_waitcnt vmcnt(10)
  v_mfma_f32_16x16x32_bf16 v[148:151], a[60:63], v[88:91], v[148:151]
  buffer_load_dwordx4 v[80:83], v2, s[44:47], s65 offen offset:2048 sc1
  v_mfma_f32_16x16x32_bf16 v[152:155], a[64:67], v[88:91], v[152:155]
  ds_write_b128 v5, v[132:135] offset:1024
  v_mfma_f32_16x16x32_bf16 v[156:159], a[68:71], v[88:91], v[156:159]
  v_mfma_f32_16x16x32_bf16 v[160:163], a[72:75], v[88:91], v[160:163]
  v_mfma_f32_16x16x32_bf16 v[164:167], a[76:79], v[88:91], v[164:167]
  s_waitcnt vmcnt(9)
  v_mfma_f32_16x16x32_bf16 v[148:151], a[80:83], v[92:95], v[148:151]
  buffer_load_dwordx4 v[84:87], v2, s[44:47], s65 offen offset:3072 sc1
  v_mfma_f32_16x16x32_bf16 v[152:155], a[84:87], v[92:95], v[152:155]
  ds_write_b128 v5, v[136:139] offset:2048
  v_mfma_f32_16x16x32_bf16 v[156:159], a[88:91], v[92:95], v[156:159]
  v_mfma_f32_16x16x32_bf16 v[160:163], a[92:95], v[92:95], v[160:163]
  v_mfma_f32_16x16x32_bf16 v[164:167], a[96:99], v[92:95], v[164:167]
  s_waitcnt vmcnt(8)
  v_mfma_f32_16x16x32_bf16 v[148:151], a[100:103], v[96:99], v[148:151]
  buffer_load_dwordx4 v[88:91], v2, s[44:47], s66 offen offset:0 sc1
  v_mfma_f32_16x16x32_bf16 v[152:155], a[104:107], v[96:99], v[152:155]
  ds_write_b128 v5, v[140:143] offset:3072
  v_mfma_f32_16x16x32_bf16 v[156:159], a[108:111], v[96:99], v[156:159]
  v_mfma_f32_16x16x32_bf16 v[160:163], a[112:115], v[96:99], v[160:163]
  v_mfma_f32_16x16x32_bf16 v[164:167], a[116:119], v[96:99], v[164:167]
  s_waitcnt vmcnt(7)
  v_mfma_f32_16x16x32_bf16 v[148:151], a[120:123], v[64:67], v[148:151]
  buffer_load_dwordx4 v[92:95], v2, s[44:47], s66 offen offset:1024 sc1
  v_mfma_f32_16x16x32_bf16 v[152:155], a[124:127], v[64:67], v[152:155]
  ds_write_b128 v5, v[144:147] offset:4096
  v_mfma_f32_16x16x32_bf16 v[156:159], a[128:131], v[64:67], v[156:159]
  v_mfma_f32_16x16x32_bf16 v[160:163], a[132:135], v[64:67], v[160:163]
  v_mfma_f32_16x16x32_bf16 v[164:167], a[136:139], v[64:67], v[164:167]
  s_waitcnt vmcnt(6)
  v_mfma_f32_16x16x32_bf16 v[148:151], a[140:143], v[68:71], v[148:151]
  buffer_load_dwordx4 v[96:99], v2, s[44:47], s66 offen offset:2048 sc1
  v_mfma_f32_16x16x32_bf16 v[152:155], a[144:147], v[68:71], v[152:155]
  v_mfma_f32_16x16x32_bf16 v[156:159], a[148:151], v[68:71], v[156:159]
  v_mfma_f32_16x16x32_bf16 v[160:163], a[152:155], v[68:71], v[160:163]
  v_mfma_f32_16x16x32_bf16 v[164:167], a[156:159], v[68:71], v[164:167]
  s_waitcnt vmcnt(6)
  v_mfma_f32_16x16x32_bf16 v[148:151], a[160:163], v[72:75], v[148:151]
  buffer_load_dwordx4 v[64:67], v2, s[44:47], s66 offen offset:3072 sc1
  v_mfma_f32_16x16x32_bf16 v[152:155], a[164:167], v[72:75], v[152:155]
  v_mfma_f32_16x16x32_bf16 v[156:159], a[168:171], v[72:75], v[156:159]
  v_mfma_f32_16x16x32_bf16 v[160:163], a[172:175], v[72:75], v[160:163]
  v_mfma_f32_16x16x32_bf16 v[164:167], a[176:179], v[72:75], v[164:167]
  s_waitcnt vmcnt(6)
  v_mfma_f32_16x16x32_bf16 v[148:151], a[180:183], v[76:79], v[148:151]
  s_add_u32 s66, s66, 4096
  buffer_load_dwordx4 v[68:71], v2, s[44:47], s66 offen offset:0 sc1
  v_mfma_f32_16x16x32_bf16 v[152:155], a[184:187], v[76:79], v[152:155]
  v_mfma_f32_16x16x32_bf16 v[156:159], a[188:191], v[76:79], v[156:159]
  v_mfma_f32_16x16x32_bf16 v[160:163], a[192:195], v[76:79], v[160:163]
  v_mfma_f32_16x16x32_bf16 v[164:167], a[196:199], v[76:79], v[164:167]
  s_waitcnt vmcnt(6)
  v_mfma_f32_16x16x32_bf16 v[148:151], a[200:203], v[80:83], v[148:151]
  buffer_load_dwordx4 v[72:75], v2, s[44:47], s66 offen offset:1024 sc1
  v_mfma_f32_16x16x32_bf16 v[152:155], a[204:207], v[80:83], v[152:155]
  v_mfma_f32_16x16x32_bf16 v[156:159], a[208:211], v[80:83], v[156:159]
  v_mfma_f32_16x16x32_bf16 v[160:163], a[212:215], v[80:83], v[160:163]
  v_mfma_f32_16x16x32_bf16 v[164:167], a[216:219], v[80:83], v[164:167]
  s_waitcnt vmcnt(6)
  v_mfma_f32_16x16x32_bf16 v[148:151], a[220:223], v[84:87], v[148:151]
  buffer_load_dwordx4 v[76:79], v2, s[44:47], s66 offen offset:2048 sc1
  v_mfma_f32_16x16x32_bf16 v[152:155], a[224:227], v[84:87], v[152:155]
  v_mfma_f32_16x16x32_bf16 v[156:159], a[228:231], v[84:87], v[156:159]
  v_mfma_f32_16x16x32_bf16 v[160:163], a[232:235], v[84:87], v[160:163]
  v_mfma_f32_16x16x32_bf16 v[164:167], a[236:239], v[84:87], v[164:167]
  s_waitcnt vmcnt(6)
  v_mfma_f32_16x16x32_bf16 v[128:131], a[0:3], v[88:91], 0
  buffer_load_dwordx4 v[80:83], v2, s[44:47], s66 offen offset:3072 sc1
  v_mfma_f32_16x16x32_bf16 v[132:135], a[4:7], v[88:91], 0
  v_mfma_f32_16x16x32_bf16 v[136:139], a[8:11], v[88:91], 0
  v_mfma_f32_16x16x32_bf16 v[140:143], a[12:15], v[88:91], 0
  v_mfma_f32_16x16x32_bf16 v[144:147], a[16:19], v[88:91], 0
  s_waitcnt vmcnt(6)
  v_mfma_f32_16x16x32_bf16 v[128:131], a[20:23], v[92:95], v[128:131]
  s_add_u32 s66, s66, 4096
  buffer_load_dwordx4 v[84:87], v2, s[44:47], s66 offen offset:0 sc1
  v_mfma_f32_16x16x32_bf16 v[132:135], a[24:27], v[92:95], v[132:135]
  v_mfma_f32_16x16x32_bf16 v[136:139], a[28:31], v[92:95], v[136:139]
  v_mfma_f32_16x16x32_bf16 v[140:143], a[32:35], v[92:95], v[140:143]
  v_mfma_f32_16x16x32_bf16 v[144:147], a[36:39], v[92:95], v[144:147]
  s_waitcnt vmcnt(6)
  s_add_u32 s33, s24, 2
  s_and_b32 s33, s33, 3
  s_mul_i32 s33, s33, 15360
  s_add_u32 s33, s33, 5120
  v_add_u32 v5, s33, v2
  v_mfma_f32_16x16x32_bf16 v[128:131], a[40:43], v[96:99], v[128:131]
  buffer_load_dwordx4 v[88:91], v2, s[44:47], s66 offen offset:1024 sc1
  v_mfma_f32_16x16x32_bf16 v[132:135], a[44:47], v[96:99], v[132:135]
  ds_write_b128 v5, v[148:151] offset:0
  v_mfma_f32_16x16x32_bf16 v[136:139], a[48:51], v[96:99], v[136:139]
  v_mfma_f32_16x16x32_bf16 v[140:143], a[52:55], v[96:99], v[140:143]
  v_mfma_f32_16x16x32_bf16 v[144:147], a[56:59], v[96:99], v[144:147]
  s_waitcnt vmcnt(6)
  v_mfma_f32_16x16x32_bf16 v[128:131], a[60:63], v[64:67], v[128:131]
  buffer_load_dwordx4 v[92:95], v2, s[44:47], s66 offen offset:2048 sc1
  v_mfma_f32_16x16x32_bf16 v[132:135], a[64:67], v[64:67], v[132:135]
  ds_write_b128 v5, v[152:155] offset:1024
  v_mfma_f32_16x16x32_bf16 v[136:139], a[68:71], v[64:67], v[136:139]
  v_mfma_f32_16x16x32_bf16 v[140:143], a[72:75], v[64:67], v[140:143]
  v_mfma_f32_16x16x32_bf16 v[144:147], a[76:79], v[64:67], v[144:147]
  s_waitcnt vmcnt(6)
  v_mfma_f32_16x16x32_bf16 v[128:131], a[80:83], v[68:71], v[128:131]
  buffer_load_dwordx4 v[96:99], v2, s[44:47], s66 offen offset:3072 sc1
  v_mfma_f32_16x16x32_bf16 v[132:135], a[84:87], v[68:71], v[132:135]
  ds_write_b128 v5, v[156:159] offset:2048
  v_mfma_f32_16x16x32_bf16 v[136:139], a[88:91], v[68:71], v[136:139]
  v_mfma_f32_16x16x32_bf16 v[140:143], a[92:95], v[68:71], v[140:143]
  v_mfma_f32_16x16x32_bf16 v[144:147], a[96:99], v[68:71], v[144:147]
  s_waitcnt vmcnt(6)
  v_mfma_f32_16x16x32_bf16 v[128:131], a[100:103], v[72:75], v[128:131]
  buffer_load_dwordx4 v[64:67], v2, s[44:47], s67 offen offset:0 sc1
  v_mfma_f32_16x16x32_bf16 v[132:135], a[104:107], v[72:75], v[132:135]
  ds_write_b128 v5, v[160:163] offset:3072
  v_mfma_f32_16x16x32_bf16 v[136:139], a[108:111], v[72:75], v[136:139]
  v_mfma_f32_16x16x32_bf16 v[140:143], a[112:115], v[72:75], v[140:143]
  v_mfma_f32_16x16x32_bf16 v[144:147], a[116:119], v[72:75], v[144:147]
  s_waitcnt vmcnt(6)
  v_mfma_f32_16x16x32_bf16 v[128:131], a[120:123], v[76:79], v[128:131]
  buffer_load_dwordx4 v[68:71], v2, s[44:47], s67 offen offset:1024 sc1
  v_mfma_f32_16x16x32_bf16 v[132:135], a[124:127], v[76:79], v[132:135]
  ds_write_b128 v5, v[164:167] offset:4096
  v_mfma_f32_16x16x32_bf16 v[136:139], a[128:131], v[76:79], v[136:139]
  v_mfma_f32_16x16x32_bf16 v[140:143], a[132:135], v[76:79], v[140:143]
  v_mfma_f32_16x16x32_bf16 v[144:147], a[136:139], v[76:79], v[144:147]
  s_waitcnt vmcnt(6)
  v_mfma_f32_16x16x32_bf16 v[128:131], a[140:143], v[80:83], v[128:131]
  buffer_load_dwordx4 v[72:75], v2, s[44:47], s67 offen offset:2048 sc1
  v_mfma_f32_16x16x32_bf16 v[132:135], a[144:147], v[80:83], v[132:135]
  v_mfma_f32_16x16x32_bf16 v[136:139], a[148:151], v[80:83], v[136:139]
  v_mfma_f32_16x16x32_bf16 v[140:143], a[152:155], v[80:83], v[140:143]
  v_mfma_f32_16x16x32_bf16 v[144:147], a[156:159], v[80:83], v[144:147]
  s_waitcnt vmcnt(6)
  v_mfma_f32_16x16x32_bf16 v[128:131], a[160:163], v[84:87], v[128:131]
  buffer_load_dwordx4 v[76:79], v2, s[44:47], s67 offen offset:3072 sc1
  v_mfma_f32_16x16x32_bf16 v[132:135], a[164:167], v[84:87], v[132:135]
  v_mfma_f32_16x16x32_bf16 v[136:139], a[168:171], v[84:87], v[136:139]
  v_mfma_f32_16x16x32_bf16 v[140:143], a[172:175], v[84:87], v[140:143]
  v_mfma_f32_16x16x32_bf16 v[144:147], a[176:179], v[84:87], v[144:147]
  s_waitcnt vmcnt(6)
  v_mfma_f32_16x16x32_bf16 v[128:131], a[180:183], v[88:91], v[128:131]
  s_add_u32 s67, s67, 4096
  buffer_load_dwordx4 v[80:83], v2, s[44:47], s67 offen offset:0 sc1
  v_mfma_f32_16x16x32_bf16 v[132:135], a[184:187], v[88:91], v[132:135]
  v_mfma_f32_16x16x32_bf16 v[136:139], a[188:191], v[88:91], v[136:139]
  v_mfma_f32_16x16x32_bf16 v[140:143], a[192:195], v[88:91], v[140:143]
  v_mfma_f32_16x16x32_bf16 v[144:147], a[196:199], v[88:91], v[144:147]
  s_waitcnt vmcnt(6)
  v_mfma_f32_16x16x32_bf16 v[128:131], a[200:203], v[92:95], v[128:131]
  buffer_load_dwordx4 v[84:87], v2, s[44:47], s67 offen offset:1024 sc1
  v_mfma_f32_16x16x32_bf16 v[132:135], a[204:207], v[92:95], v[132:135]
  v_mfma_f32_16x16x32_bf16 v[136:139], a[208:211], v[92:95], v[136:139]
  v_mfma_f32_16x16x32_bf16 v[140:143], a[212:215], v[92:95], v[140:143]
  v_mfma_f32_16x16x32_bf16 v[144:147], a[216:219], v[92:95], v[144:147]
  s_waitcnt vmcnt(6)
  v_mfma_f32_16x16x32_bf16 v[128:131], a[220:223], v[96:99], v[128:131]
  buffer_load_dwordx4 v[88:91], v2, s[44:47], s67 offen offset:2048 sc1
  v_mfma_f32_16x16x32_bf16 v[132:135], a[224:227], v[96:99], v[132:135]
  v_mfma_f32_16x16x32_bf16 v[136:139], a[228:231], v[96:99], v[136:139]
  v_mfma_f32_16x16x32_bf16 v[140:143], a[232:235], v[96:99], v[140:143]
  v_mfma_f32_16x16x32_bf16 v[144:147], a[236:239], v[96:99], v[144:147]
  s_waitcnt vmcnt(6)
  v_mfma_f32_16x16x32_bf16 v[148:151], a[0:3], v[64:67], 0
  buffer_load_dwordx4 v[92:95], v2, s[44:47], s67 offen offset:3072 sc1
  v_mfma_f32_16x16x32_bf16 v[152:155], a[4:7], v[64:67], 0
  v_mfma_f32_16x16x32_bf16 v[156:159], a[8:11], v[64:67], 0
  v_mfma_f32_16x16x32_bf16 v[160:163], a[12:15], v[64:67], 0
  v_mfma_f32_16x16x32_bf16 v[164:167], a[16:19], v[64:67], 0
  s_waitcnt vmcnt(6)
  v_mfma_f32_16x16x32_bf16 v[148:151], a[20:23], v[68:71], v[148:151]
  s_add_u32 s67, s67, 4096
  buffer_load_dwordx4 v[96:99], v2, s[44:47], s67 offen offset:0 sc1
  v_mfma_f32_16x16x32_bf16 v[152:155], a[24:27], v[68:71], v[152:155]
  v_mfma_f32_16x16x32_bf16 v[156:159], a[28:31], v[68:71], v[156:159]
  v_mfma_f32_16x16x32_bf16 v[160:163], a[32:35], v[68:71], v[160:163]
  v_mfma_f32_16x16x32_bf16 v[164:167], a[36:39], v[68:71], v[164:167]
  s_waitcnt vmcnt(6)
  s_add_u32 s33, s24, 3
  s_and_b32 s33, s33, 3
  s_mul_i32 s33, s33, 15360
  s_add_u32 s33, s33, 0
  v_add_u32 v5, s33, v2
  v_mfma_f32_16x16x32_bf16 v[148:151], a[40:43], v[72:75], v[148:151]
  buffer_load_dwordx4 v[64:67], v2, s[44:47], s67 offen offset:1024 sc1
  v_mfma_f32_16x16x32_bf16 v[152:155], a[44:47], v[72:75], v[152:155]
  ds_write_b128 v5, v[128:131] offset:0
  v_mfma_f32_16x16x32_bf16 v[156:159], a[48:51], v[72:75], v[156:159]
  v_mfma_f32_16x16x32_bf16 v[160:163], a[52:55], v[72:75], v[160:163]
  v_mfma_f32_16x16x32_bf16 v[164:167], a[56:59], v[72:75], v[164:167]
  s_waitcnt vmcnt(6)
  v_mfma_f32_16x16x32_bf16 v[148:151], a[60:63], v[76:79], v[148:151]
  buffer_load_dwordx4 v[68:71], v2, s[44:47], s67 offen offset:2048 sc1
  v_mfma_f32_16x16x32_bf16 v[152:155], a[64:67], v[76:79], v[152:155]
  ds_write_b128 v5, v[132:135] offset:1024
  v_mfma_f32_16x16x32_bf16 v[156:159], a[68:71], v[76:79], v[156:159]
  v_mfma_f32_16x16x32_bf16 v[160:163], a[72:75], v[76:79], v[160:163]
  v_mfma_f32_16x16x32_bf16 v[164:167], a[76:79], v[76:79], v[164:167]
  s_waitcnt vmcnt(6)
  v_mfma_f32_16x16x32_bf16 v[148:151], a[80:83], v[80:83], v[148:151]
  buffer_load_dwordx4 v[72:75], v2, s[44:47], s67 offen offset:3072 sc1
  v_mfma_f32_16x16x32_bf16 v[152:155], a[84:87], v[80:83], v[152:155]
  ds_write_b128 v5, v[136:139] offset:2048
  v_mfma_f32_16x16x32_bf16 v[156:159], a[88:91], v[80:83], v[156:159]
  v_mfma_f32_16x16x32_bf16 v[160:163], a[92:95], v[80:83], v[160:163]
  v_mfma_f32_16x16x32_bf16 v[164:167], a[96:99], v[80:83], v[164:167]
  s_waitcnt vmcnt(6)
  v_mfma_f32_16x16x32_bf16 v[148:151], a[100:103], v[84:87], v[148:151]
  ds_write_b128 v5, v[140:143] offset:3072
  v_mfma_f32_16x16x32_bf16 v[152:155], a[104:107], v[84:87], v[152:155]
  v_mfma_f32_16x16x32_bf16 v[156:159], a[108:111], v[84:87], v[156:159]
  v_mfma_f32_16x16x32_bf16 v[160:163], a[112:115], v[84:87], v[160:163]
  v_mfma_f32_16x16x32_bf16 v[164:167], a[116:119], v[84:87], v[164:167]
  s_waitcnt vmcnt(5)
  v_mfma_f32_16x16x32_bf16 v[148:151], a[120:123], v[88:91], v[148:151]
  ds_write_b128 v5, v[144:147] offset:4096
  v_mfma_f32_16x16x32_bf16 v[152:155], a[124:127], v[88:91], v[152:155]
  v_mfma_f32_16x16x32_bf16 v[156:159], a[128:131], v[88:91], v[156:159]
  v_mfma_f32_16x16x32_bf16 v[160:163], a[132:135], v[88:91], v[160:163]
  v_mfma_f32_16x16x32_bf16 v[164:167], a[136:139], v[88:91], v[164:167]
  s_waitcnt vmcnt(4)
  v_mfma_f32_16x16x32_bf16 v[148:151], a[140:143], v[92:95], v[148:151]
  v_mfma_f32_16x16x32_bf16 v[152:155], a[144:147], v[92:95], v[152:155]
  v_mfma_f32_16x16x32_bf16 v[156:159], a[148:151], v[92:95], v[156:159]
  v_mfma_f32_16x16x32_bf16 v[160:163], a[152:155], v[92:95], v[160:163]
  v_mfma_f32_16x16x32_bf16 v[164:167], a[156:159], v[92:95], v[164:167]
  s_waitcnt vmcnt(3)
  v_mfma_f32_16x16x32_bf16 v[148:151], a[160:163], v[96:99], v[148:151]
  v_mfma_f32_16x16x32_bf16 v[152:155], a[164:167], v[96:99], v[152:155]
  v_mfma_f32_16x16x32_bf16 v[156:159], a[168:171], v[96:99], v[156:159]
  v_mfma_f32_16x16x32_bf16 v[160:163], a[172:175], v[96:99], v[160:163]
  v_mfma_f32_16x16x32_bf16 v[164:167], a[176:179], v[96:99], v[164:167]
  s_waitcnt vmcnt(2)
  v_mfma_f32_16x16x32_bf16 v[148:151], a[180:183], v[64:67], v[148:151]
  v_mfma_f32_16x16x32_bf16 v[152:155], a[184:187], v[64:67], v[152:155]
  v_mfma_f32_16x16x32_bf16 v[156:159], a[188:191], v[64:67], v[156:159]
  v_mfma_f32_16x16x32_bf16 v[160:163], a[192:195], v[64:67], v[160:163]
  v_mfma_f32_16x16x32_bf16 v[164:167], a[196:199], v[64:67], v[164:167]
  s_waitcnt vmcnt(1)
  v_mfma_f32_16x16x32_bf16 v[148:151], a[200:203], v[68:71], v[148:151]
  v_mfma_f32_16x16x32_bf16 v[152:155], a[204:207], v[68:71], v[152:155]
  v_mfma_f32_16x16x32_bf16 v[156:159], a[208:211], v[68:71], v[156:159]
  v_mfma_f32_16x16x32_bf16 v[160:163], a[212:215], v[68:71], v[160:163]
  v_mfma_f32_16x16x32_bf16 v[164:167], a[216:219], v[68:71], v[164:167]
  s_waitcnt vmcnt(0)
  v_mfma_f32_16x16x32_bf16 v[148:151], a[220:223], v[72:75], v[148:151]
  v_mfma_f32_16x16x32_bf16 v[152:155], a[224:227], v[72:75], v[152:155]
  v_mfma_f32_16x16x32_bf16 v[156:159], a[228:231], v[72:75], v[156:159]
  v_mfma_f32_16x16x32_bf16 v[160:163], a[232:235], v[72:75], v[160:163]
  v_mfma_f32_16x16x32_bf16 v[164:167], a[236:239], v[72:75], v[164:167]
  s_waitcnt lgkmcnt(0)
L_k2_g4j:
  s_barrier
  s_mul_i32 s33, s24, 15360
  s_add_u32 s33, s33, 0
  v_add_u32 v5, s33, v2
  ds_read_b128 v[64:67], v5 offset:0
  ds_read_b128 v[68:71], v5 offset:1024
  ds_read_b128 v[72:75], v5 offset:2048
  ds_read_b128 v[76:79], v5 offset:3072
  ds_read_b128 v[80:83], v5 offset:4096
  ds_read_b128 v[84:87], v5 offset:5120
  ds_read_b128 v[88:91], v5 offset:6144
  ds_read_b128 v[92:95], v5 offset:7168
  ds_read_b128 v[96:99], v5 offset:8192
  ds_read_b128 v[100:103], v5 offset:9216
  ds_read_b128 v[104:107], v5 offset:10240
  ds_read_b128 v[108:111], v5 offset:11264
  ds_read_b128 v[112:115], v5 offset:12288
  ds_read_b128 v[116:119], v5 offset:13312
  ds_read_b128 v[120:123], v5 offset:14336
  s_waitcnt lgkmcnt(10)
  v_pk_add_f32 v[148:149], v[148:149], v[64:65]
  v_pk_add_f32 v[150:151], v[150:151], v[66:67]
  v_pk_add_f32 v[152:153], v[152:153], v[68:69]
  v_pk_add_f32 v[154:155], v[154:155], v[70:71]
  v_pk_add_f32 v[156:157], v[156:157], v[72:73]
  v_pk_add_f32 v[158:159], v[158:159], v[74:75]
  v_pk_add_f32 v[160:161], v[160:161], v[76:77]
  v_pk_add_f32 v[162:163], v[162:163], v[78:79]
  v_pk_add_f32 v[164:165], v[164:165], v[80:81]
  v_pk_add_f32 v[166:167], v[166:167], v[82:83]
  s_waitcnt lgkmcnt(5)
  v_pk_add_f32 v[148:149], v[148:149], v[84:85]
  v_pk_add_f32 v[150:151], v[150:151], v[86:87]
  v_pk_add_f32 v[152:153], v[152:153], v[88:89]
  v_pk_add_f32 v[154:155], v[154:155], v[90:91]
  v_pk_add_f32 v[156:157], v[156:157], v[92:93]
  v_pk_add_f32 v[158:159], v[158:159], v[94:95]
  v_pk_add_f32 v[160:161], v[160:161], v[96:97]
  v_pk_add_f32 v[162:163], v[162:163], v[98:99]
  v_pk_add_f32 v[164:165], v[164:165], v[100:101]
  v_pk_add_f32 v[166:167], v[166:167], v[102:103]
  s_waitcnt lgkmcnt(0)
  v_pk_add_f32 v[148:149], v[148:149], v[104:105]
  v_pk_add_f32 v[150:151], v[150:151], v[106:107]
  v_pk_add_f32 v[152:153], v[152:153], v[108:109]
  v_pk_add_f32 v[154:155], v[154:155], v[110:111]
  v_pk_add_f32 v[156:157], v[156:157], v[112:113]
  v_pk_add_f32 v[158:159], v[158:159], v[114:115]
  v_pk_add_f32 v[160:161], v[160:161], v[116:117]
  v_pk_add_f32 v[162:163], v[162:163], v[118:119]
  v_pk_add_f32 v[164:165], v[164:165], v[120:121]
  v_pk_add_f32 v[166:167], v[166:167], v[122:123]
  s_waitcnt vmcnt(0)
  s_mov_b32 s44, s8
  s_mov_b32 s45, s9
  s_mov_b32 s46, 0x280000
  s_mov_b32 s47, 0x00020000
  s_mov_b32 s35, 0xffff0000
  v_lshlrev_b32 v12, 16, v168
  v_and_b32 v13, s35, v168
  v_lshlrev_b32 v14, 16, v178
  v_and_b32 v15, s35, v178
  v_pk_add_f32 v[12:13], v[12:13], v[148:149]
  v_pk_fma_f32 v[12:13], v[12:13], v[14:15], v[32:33]
  v_cvt_pk_bf16_f32 v64, v12, v13
  v_lshlrev_b32 v12, 16, v169
  v_and_b32 v13, s35, v169
  v_lshlrev_b32 v14, 16, v179
  v_and_b32 v15, s35, v179
  v_pk_add_f32 v[12:13], v[12:13], v[150:151]
  v_pk_fma_f32 v[12:13], v[12:13], v[14:15], v[34:35]
  v_cvt_pk_bf16_f32 v65, v12, v13
  v_lshlrev_b32 v12, 16, v170
  v_and_b32 v13, s35, v170
  v_lshlrev_b32 v14, 16, v180
  v_and_b32 v15, s35, v180
  v_pk_add_f32 v[12:13], v[12:13], v[152:153]
  v_pk_fma_f32 v[12:13], v[12:13], v[14:15], v[36:37]
  v_cvt_pk_bf16_f32 v66, v12, v13
  v_lshlrev_b32 v12, 16, v171
  v_and_b32 v13, s35, v171
  v_lshlrev_b32 v14, 16, v181
  v_and_b32 v15, s35, v181
  v_pk_add_f32 v[12:13], v[12:13], v[154:155]
  v_pk_fma_f32 v[12:13], v[12:13], v[14:15], v[38:39]
  v_cvt_pk_bf16_f32 v67, v12, v13
  v_lshlrev_b32 v12, 16, v172
  v_and_b32 v13, s35, v172
  v_lshlrev_b32 v14, 16, v182
  v_and_b32 v15, s35, v182
  v_pk_add_f32 v[12:13], v[12:13], v[156:157]
  v_pk_fma_f32 v[12:13], v[12:13], v[14:15], v[40:41]
  v_cvt_pk_bf16_f32 v68, v12, v13
  v_lshlrev_b32 v12, 16, v173
  v_and_b32 v13, s35, v173
  v_lshlrev_b32 v14, 16, v183
  v_and_b32 v15, s35, v183
  v_pk_add_f32 v[12:13], v[12:13], v[158:159]
  v_pk_fma_f32 v[12:13], v[12:13], v[14:15], v[42:43]
  v_cvt_pk_bf16_f32 v69, v12, v13
  v_lshlrev_b32 v12, 16, v174
  v_and_b32 v13, s35, v174
  v_lshlrev_b32 v14, 16, v184
  v_and_b32 v15, s35, v184
  v_pk_add_f32 v[12:13], v[12:13], v[160:161]
  v_pk_fma_f32 v[12:13], v[12:13], v[14:15], v[44:45]
  v_cvt_pk_bf16_f32 v70, v12, v13
  v_lshlrev_b32 v12, 16, v175
  v_and_b32 v13, s35, v175
  v_lshlrev_b32 v14, 16, v185
  v_and_b32 v15, s35, v185
  v_pk_add_f32 v[12:13], v[12:13], v[162:163]
  v_pk_fma_f32 v[12:13], v[12:13], v[14:15], v[46:47]
  v_cvt_pk_bf16_f32 v71, v12, v13
  v_lshlrev_b32 v12, 16, v176
  v_and_b32 v13, s35, v176
  v_lshlrev_b32 v14, 16, v186
  v_and_b32 v15, s35, v186
  v_pk_add_f32 v[12:13], v[12:13], v[164:165]
  v_pk_fma_f32 v[12:13], v[12:13], v[14:15], v[48:49]
  v_cvt_pk_bf16_f32 v72, v12, v13
  v_lshlrev_b32 v12, 16, v177
  v_and_b32 v13, s35, v177
  v_lshlrev_b32 v14, 16, v187
  v_and_b32 v15, s35, v187
  v_pk_add_f32 v[12:13], v[12:13], v[166:167]
  v_pk_fma_f32 v[12:13], v[12:13], v[14:15], v[50:51]
  v_cvt_pk_bf16_f32 v73, v12, v13
  buffer_store_dwordx2 v[64:65], v20, s[44:47], 0 offen offset:0
  buffer_store_dwordx2 v[66:67], v20, s[44:47], 0 offen offset:32
  buffer_store_dwordx2 v[68:69], v20, s[44:47], 0 offen offset:64
  buffer_store_dwordx2 v[70:71], v20, s[44:47], 0 offen offset:96
  buffer_store_dwordx2 v[72:73], v20, s[44:47], 0 offen offset:128
L_k2_end:
  s_endpgm
L_code_end:
.section .rodata,"a"
.p2align 6
.amdhsa_kernel prep_kernel
  .amdhsa_next_free_vgpr 128
  .amdhsa_next_free_sgpr 72
  .amdhsa_accum_offset 128
  .amdhsa_group_segment_fixed_size 0
  .amdhsa_kernarg_size 112
  .amdhsa_user_sgpr_count 2
  .amdhsa_user_sgpr_kernarg_segment_ptr 1
  .amdhsa_system_sgpr_workgroup_id_x 1
  .amdhsa_float_denorm_mode_32 3
.end_amdhsa_kernel

.p2align 6
.amdhsa_kernel qkv_kernel
  .amdhsa_next_free_vgpr 416
  .amdhsa_next_free_sgpr 64
  .amdhsa_accum_offset 256
  .amdhsa_group_segment_fixed_size 0
  .amdhsa_kernarg_size 112
  .amdhsa_user_sgpr_count 2
  .amdhsa_user_sgpr_kernarg_segment_ptr 1
  .amdhsa_system_sgpr_workgroup_id_x 1
  .amdhsa_float_denorm_mode_32 3
.end_amdhsa_kernel

.p2align 6
.amdhsa_kernel tail_kernel
  .amdhsa_next_free_vgpr 512
  .amdhsa_next_free_sgpr 88
  .amdhsa_accum_offset 256
  .amdhsa_group_segment_fixed_size 0
  .amdhsa_kernarg_size 112
  .amdhsa_user_sgpr_count 2
  .amdhsa_user_sgpr_kernarg_segment_ptr 1
  .amdhsa_system_sgpr_workgroup_id_x 1
  .amdhsa_float_denorm_mode_32 3
.end_amdhsa_kernel
```
